```python
import torch

def _softmax(x, axis=-1):
    return torch.softmax(x, dim=axis)
def _gelu(x):
    return torch.nn.functional.gelu(x, approximate="tanh")
def _silu(x):
    return torch.nn.functional.silu(x)
def _sigmoid(x):
    return torch.sigmoid(x)
def _layernorm(x, axis=-1, eps=1e-5):
    m = x.mean(dim=axis, keepdim=True)
    v = x.var(dim=axis, keepdim=True, unbiased=False)
    return (x - m) / torch.sqrt(v + eps)
def _scatter_add(tgt, idx, src, axis=0):
    return tgt.clone().index_add_(axis, idx, src)
def _segment_sum(src, seg, n):
    out = torch.zeros((n,) + src.shape[1:], dtype=src.dtype)
    return out.index_add_(0, seg, src)
def _pad(x, pw):
    flat = tuple(v for pair in reversed(pw) for v in pair)
    return torch.nn.functional.pad(x, flat)

kernel_name = 'concat_heads__gqa_block_cached__gqa_block_cached__near_ridge'

def setup_inputs():

    _w = (lambda a: (lambda t: t.to(torch.bfloat16) if t.is_floating_point() else t)(torch.as_tensor(a)))
    def _A_setup():
        B, Sq, D = 16, 32, 1024
        Hq, Hkv, Sk, Dh = 32, 4, 512, 128
        assert Hq % Hkv == 0, (Hq, Hkv)
        return {
            "x": _w((lambda *s: torch.randn(*s, dtype=torch.bfloat16) * 0.8)(B, Sq, D)),
            "k_cache": _w((lambda *s: torch.randn(*s, dtype=torch.bfloat16) * 0.8)(B, Hkv, Sk, Dh)),
            "v_cache": _w((lambda *s: torch.randn(*s, dtype=torch.bfloat16) * 0.05)(B, Hkv, Sk, Dh)),
            "wq": _w((lambda *s: torch.randn(*s, dtype=torch.bfloat16) * 0.8)(D, Hq * Dh) * (D ** -0.5)),
            "wo": _w((lambda *s: torch.randn(*s, dtype=torch.bfloat16) * 0.05)(Hq * Dh, D) * ((Hq * Dh) ** -0.5)),
        }
    _A_in = _A_setup()

    def _B_setup():
        B, Sq, D = 16, 32, 1024
        Hq, Hkv, Sk, Dh = 32, 4, 512, 128
        assert Hq % Hkv == 0, (Hq, Hkv)
        return {
            "x": _w((lambda *s: torch.randn(*s, dtype=torch.bfloat16) * 0.8)(B, Sq, D)),
            "k_cache": _w((lambda *s: torch.randn(*s, dtype=torch.bfloat16) * 0.8)(B, Hkv, Sk, Dh)),
            "v_cache": _w((lambda *s: torch.randn(*s, dtype=torch.bfloat16) * 0.05)(B, Hkv, Sk, Dh)),
            "wq": _w((lambda *s: torch.randn(*s, dtype=torch.bfloat16) * 0.8)(D, Hq * Dh) * (D ** -0.5)),
            "wo": _w((lambda *s: torch.randn(*s, dtype=torch.bfloat16) * 0.05)(Hq * Dh, D) * ((Hq * Dh) ** -0.5)),
        }
    _B_in = _B_setup()

    return {
        "A_x": _A_in["x"],
        "A_k_cache": _A_in["k_cache"],
        "A_v_cache": _A_in["v_cache"],
        "A_wq": _A_in["wq"],
        "A_wo": _A_in["wo"],
        "B_x": _B_in["x"],
        "B_k_cache": _B_in["k_cache"],
        "B_v_cache": _B_in["v_cache"],
        "B_wq": _B_in["wq"],
        "B_wo": _B_in["wo"],
    }

def reference(A_x, A_k_cache, A_v_cache, A_wq, A_wo, B_x, B_k_cache, B_v_cache, B_wq, B_wo):
    def _A_ref(x, k_cache, v_cache, wq, wo):
        B, Sq, D = x.shape
        Hq, Dh = 32, 128
        Hkv = k_cache.shape[1]
        rep = Hq // Hkv
        q = (lambda x, *d: x.permute(*d))((x @ wq).reshape(B, Sq, Hq, Dh), 0, 2, 1, 3)
        k = (lambda x, n, axis: torch.repeat_interleave(x, n, dim=axis))(k_cache, rep, axis=1)
        v = (lambda x, n, axis: torch.repeat_interleave(x, n, dim=axis))(v_cache, rep, axis=1)
        scores = torch.einsum("bhqd,bhkd->bhqk", q, k) * (Dh ** -0.5)
        p = _softmax(scores, axis=-1)
        o = torch.einsum("bhqk,bhkd->bhqd", p, v)
        return (lambda x, *d: x.permute(*d))(o, 0, 2, 1, 3).reshape(B, Sq, Hq * Dh) @ wo

    def _B_ref(x, k_cache, v_cache, wq, wo):
        B, Sq, D = x.shape
        Hq, Dh = 32, 128
        Hkv = k_cache.shape[1]
        rep = Hq // Hkv
        q = (lambda x, *d: x.permute(*d))((x @ wq).reshape(B, Sq, Hq, Dh), 0, 2, 1, 3)
        k = (lambda x, n, axis: torch.repeat_interleave(x, n, dim=axis))(k_cache, rep, axis=1)
        v = (lambda x, n, axis: torch.repeat_interleave(x, n, dim=axis))(v_cache, rep, axis=1)
        scores = torch.einsum("bhqd,bhkd->bhqk", q, k) * (Dh ** -0.5)
        p = _softmax(scores, axis=-1)
        o = torch.einsum("bhqk,bhkd->bhqd", p, v)
        return (lambda x, *d: x.permute(*d))(o, 0, 2, 1, 3).reshape(B, Sq, Hq * Dh) @ wo

    a = _A_ref(A_x, A_k_cache, A_v_cache, A_wq, A_wo)
    b = _B_ref(B_x, B_k_cache, B_v_cache, B_wq, B_wo)
    return torch.concatenate([a, b], axis=-1)
```

```asm
; @launch grid=(256,1,1) block=(256,1,1) lds=163840
.amdgcn_target "amdgcn-amd-amdhsa--gfx950"
.text
.globl concat_heads__gqa_block_cached__gqa_block_cached__near_ridge_kernel
.p2align 12
.p2align 8
.type concat_heads__gqa_block_cached__gqa_block_cached__near_ridge_kernel,@function
concat_heads__gqa_block_cached__gqa_block_cached__near_ridge_kernel:
    s_cmp_ge_u32 s2, 256
    s_cbranch_scc1 K_end
    s_load_dwordx8 s[32:39], s[0:1], 0
    s_load_dwordx8 s[40:47], s[0:1], 40
    s_load_dwordx2 s[24:25], s[0:1], 96
    s_load_dwordx2 s[96:97], s[0:1], 32
    s_load_dwordx2 s[98:99], s[0:1], 72
    v_lshrrev_b32 v2, 6, v0
    v_and_b32 v1, 63, v0
    v_readfirstlane_b32 s5, v2
    s_bfe_u32 s29, s2, 0x10002
    s_and_b32 s6, s2, 3
    s_bfe_u32 s7, s2, 0x30003
    s_lshr_b32 s28, s2, 6
    v_lshrrev_b32 v30, 3, v1
    v_and_b32 v31, 7, v1
    v_lshrrev_b32 v32, 4, v1
    v_and_b32 v33, 1, v32
    v_lshlrev_b32 v33, 1, v33
    v_xor_b32 v33, v31, v33
    v_lshlrev_b32 v33, 4, v33
    v_xor_b32 v34, v31, v32
    v_lshlrev_b32 v34, 4, v34
    v_xor_b32 v35, 64, v34
    v_lshl_add_u32 v4, v30, 13, v33
    v_xor_b32 v5, 64, v4
    v_add_u32 v5, 64512, v5
    v_add_u32 v6, 129024, v4
    v_add_u32 v7, 129024, v5
    v_lshl_add_u32 v8, v30, 11, v34
    v_lshl_add_u32 v9, v30, 11, v35
    v_add_u32 v9, 15360, v9
    v_add_u32 v10, 30720, v8
    v_add_u32 v11, 30720, v9
    s_lshr_b32 s3, s5, 1
    s_lshl_b32 s30, s3, 18
    s_lshl_b32 s3, s6, 11
    s_add_u32 s30, s30, s3
    s_lshl_b32 s3, s7, 8
    s_add_u32 s30, s30, s3
    s_and_b32 s3, s5, 1
    s_lshl_b32 s3, s3, 7
    s_add_u32 s30, s30, s3
    s_lshl_b32 s3, s28, 2
    s_add_u32 s4, s3, s5
    s_lshl_b32 s31, s4, 16
    s_add_u32 s3, s28, s7
    s_and_b32 s3, s3, 3
    s_mov_b32 s68, 0x65832140
    s_mov_b32 s69, 0xfedba9c7
    s_cmp_eq_u32 s3, 1
    s_cselect_b32 s68, 0x69432501, s68
    s_cselect_b32 s69, 0xfecbad87, s69
    s_cmp_eq_u32 s3, 2
    s_cselect_b32 s68, 0xa5436102, s68
    s_cselect_b32 s69, 0xfdcbe987, s69
    s_cmp_eq_u32 s3, 3
    s_cselect_b32 s68, 0x65472103, s68
    s_cselect_b32 s69, 0xedcfa98b, s69
    s_and_b32 s3, s2, 7
    s_mul_i32 s3, s3, 0x22222222
    s_xor_b32 s68, s68, s3
    s_xor_b32 s69, s69, s3
    s_lshl_b32 s49, s5, 15
    s_mov_b32 s14, 1048576
    s_mov_b32 s15, 0x20000
    s_mov_b32 s10, 8388608
    s_mov_b32 s11, 0x20000
    s_mov_b32 s26, 25165824
    s_mov_b32 s27, 0x20000
    s_lshl_b32 s3, s2, 9
    s_lshl_b32 s4, s5, 7
    s_add_u32 s3, s3, s4
    s_add_u32 s75, s3, 15728640
    v_lshrrev_b32 v36, 4, v0
    v_lshlrev_b32 v36, 26, v36
    v_bfe_u32 v37, v0, 2, 2
    v_lshl_add_u32 v36, v37, 17, v36
    v_and_b32 v37, 3, v0
    v_lshl_add_u32 v36, v37, 7, v36
    v_mov_b32 v240, 0
    s_waitcnt lgkmcnt(0)
    s_cmp_eq_u32 s29, 0
    s_cselect_b64 s[12:13], s[32:33], s[40:41]
    s_cselect_b64 s[8:9], s[38:39], s[46:47]
    s_cselect_b64 s[16:17], s[34:35], s[42:43]
    s_cselect_b64 s[20:21], s[36:37], s[44:45]
    s_cselect_b64 s[96:97], s[96:97], s[98:99]
    s_load_dwordx2 s[32:33], s[0:1], 80
    s_load_dwordx2 s[36:37], s[0:1], 88
    buffer_store_dword v240, v36, s[24:27], s75 offen sc1
    s_and_b32 s50, s68, 15
    s_lshr_b64 s[68:69], s[68:69], 4
    s_lshl_b32 s51, s50, 19
    s_lshl_b32 s52, s50, 7
    s_add_u32 s51, s51, s30
    s_add_u32 s52, s52, s31
    s_add_u32 m0, s49, 0
    s_nop 0
    buffer_load_dwordx4 v4, s[8:11], s51 offen offset:0 lds
    buffer_load_dwordx4 v5, s[8:11], s51 offen offset:1024 lds
    buffer_load_dwordx4 v6, s[8:11], s51 offen offset:2048 lds
    buffer_load_dwordx4 v7, s[8:11], s51 offen offset:3072 lds
    s_add_u32 m0, s49, 4096
    s_nop 0
    buffer_load_dwordx4 v8, s[12:15], s52 offen offset:0 lds
    buffer_load_dwordx4 v9, s[12:15], s52 offen offset:1024 lds
    buffer_load_dwordx4 v10, s[12:15], s52 offen offset:2048 lds
    buffer_load_dwordx4 v11, s[12:15], s52 offen offset:3072 lds
    s_mov_b32 s18, 8388608
    s_mov_b32 s19, 0x20000
    s_mov_b32 s22, 8388608
    s_mov_b32 s23, 0x20000
    s_mov_b32 s98, 8388608
    s_mov_b32 s99, 0x20000
    v_lshlrev_b32 v37, 21, v1
    v_lshlrev_b32 v38, 25, v1
    s_lshl_b32 s3, s28, 21
    s_lshl_b32 s4, s6, 21
    s_cmp_lg_u32 s5, 1
    s_cbranch_scc1 M_notlb
    buffer_load_dword v45, v37, s[8:11], 0 offen
    buffer_load_dword v45, v38, s[16:19], s3 offen
    buffer_load_dword v45, v38, s[20:23], s3 offen
    buffer_load_dword v45, v38, s[96:99], s4 offen
    buffer_load_dword v45, v37, s[24:27], 0 offen sc1
M_notlb:
    s_and_b32 s50, s68, 15
    s_lshr_b64 s[68:69], s[68:69], 4
    s_lshl_b32 s51, s50, 19
    s_lshl_b32 s52, s50, 7
    s_add_u32 s51, s51, s30
    s_add_u32 s52, s52, s31
    s_add_u32 m0, s49, 8192
    s_nop 0
    buffer_load_dwordx4 v4, s[8:11], s51 offen offset:0 lds
    buffer_load_dwordx4 v5, s[8:11], s51 offen offset:1024 lds
    buffer_load_dwordx4 v6, s[8:11], s51 offen offset:2048 lds
    buffer_load_dwordx4 v7, s[8:11], s51 offen offset:3072 lds
    s_cmp_eq_u32 s5, 0
    s_cbranch_scc1 IP_pg1
    s_cmp_eq_u32 s5, 1
    s_cbranch_scc1 IP_pg2
    s_cmp_eq_u32 s5, 2
    s_cbranch_scc1 IP_pg3
    s_branch IP_pg4
IP_ret1:
    s_getreg_b32 s92, hwreg(HW_REG_XCC_ID)
    s_and_b32 s92, s92, 7
    s_lshl_b32 s92, s92, 2
    s_and_b32 s3, s2, 7
    s_lshl_b32 s93, s28, 3
    s_add_u32 s93, s93, s3
    v_lshlrev_b32 v36, 24, v0
    s_lshl_b32 s3, 1, s92
    v_mov_b32 v38, s3
    v_mov_b32 v39, 1
    s_lshl_b32 s3, s93, 3
    s_waitcnt lgkmcnt(0)
    s_mov_b32 s34, 2097152
    s_mov_b32 s35, 0x20000
    s_mov_b32 s38, 256
    s_mov_b32 s39, 0x20000
    s_cmp_lg_u32 s5, 0
    s_cbranch_scc1 M_nocnt
    s_waitcnt vmcnt(12)
    buffer_atomic_add_x2 v[38:39], v36, s[36:39], s3 offen sc1
    buffer_load_dword v45, v36, s[32:35], 0 offen sc1
M_nocnt:
    s_mov_b32 s18, 8388608
    s_mov_b32 s19, 0x20000
    s_mov_b32 s22, 8388608
    s_mov_b32 s23, 0x20000
    s_mov_b32 s98, 8388608
    s_mov_b32 s99, 0x20000
    v_lshlrev_b32 v47, 4, v1
    v_lshl_add_u32 v248, v30, 11, v33
    v_xor_b32 v249, 64, v248
    v_add_u32 v249, 15360, v249
    v_add_u32 v250, 30720, v248
    v_add_u32 v251, 30720, v249
    v_and_b32 v36, 15, v1
    v_xor_b32 v37, v36, v32
    v_lshlrev_b32 v37, 4, v37
    v_lshl_add_u32 v20, v32, 8, v37
    v_xor_b32 v21, 64, v20
    v_xor_b32 v22, 128, v20
    v_xor_b32 v23, 192, v20
    v_lshlrev_b32 v37, 1, v32
    v_xor_b32 v37, v36, v37
    v_lshlrev_b32 v37, 4, v37
    v_lshl_add_u32 v24, v32, 8, v37
    v_xor_b32 v25, 128, v24
    s_lshl_b32 s3, s28, 2
    s_lshr_b32 s4, s7, 1
    s_add_u32 s55, s3, s4
    s_lshl_b32 s46, s55, 19
    s_lshl_b32 s3, s6, 17
    s_add_u32 s46, s46, s3
    s_lshr_b32 s3, s5, 1
    s_lshl_b32 s62, s3, 16
    s_add_u32 s46, s46, s62
    s_and_b32 s3, s5, 1
    s_lshl_b32 s3, s3, 12
    s_add_u32 s46, s46, s3
    s_and_b32 s3, s7, 1
    s_mul_i32 s3, s3, 8192
    s_or_b32 s46, s46, s3
    s_and_b32 s3, s5, 2
    s_add_u32 s3, s3, s55
    s_add_u32 s3, s3, s6
    s_and_b32 s3, s3, 3
    s_lshl_b32 s3, s3, 14
    s_xor_b32 s46, s46, s3
    s_lshl_b32 s3, s29, 4
    s_add_u32 s3, s3, s55
    s_lshl_b32 s74, s3, 18
    s_lshl_b32 s3, s6, 16
    s_add_u32 s74, s74, s3
    s_and_b32 s3, s7, 1
    s_lshl_b32 s3, s3, 15
    s_add_u32 s74, s74, s3
    s_and_b32 s3, s5, 1
    s_lshl_b32 s3, s3, 14
    s_add_u32 s74, s74, s3
    s_lshr_b32 s3, s5, 1
    s_lshl_b32 s3, s3, 13
    s_add_u32 s74, s74, s3
    s_add_u32 s64, s74, 0
    s_add_u32 s65, s64, 4096
    s_lshl_b32 s40, s6, 21
    s_add_u32 s40, s40, s62
    s_lshl_b32 s3, s7, 8
    s_add_u32 s40, s40, s3
    s_and_b32 s3, s5, 1
    s_lshl_b32 s3, s3, 7
    s_add_u32 s40, s40, s3
    s_lshl_b32 s41, s29, 22
    s_lshl_b32 s3, s31, 2
    s_add_u32 s41, s41, s3
    s_lshl_b32 s3, s6, 16
    s_add_u32 s41, s41, s3
    s_mov_b32 s59, 0x44000000
    s_add_u32 s3, s28, s7
    s_and_b32 s3, s3, 3
    s_mov_b32 s100, 0xc5328140
    s_mov_b32 s101, 0xfedba976
    s_cmp_eq_u32 s3, 1
    s_cselect_b32 s100, 0x64392051, s100
    s_cselect_b32 s101, 0xfecba87d, s101
    s_cmp_eq_u32 s3, 2
    s_cselect_b32 s100, 0x54a31062, s100
    s_cselect_b32 s101, 0xfdcb98e7, s101
    s_cmp_eq_u32 s3, 3
    s_cselect_b32 s100, 0x5b421703, s100
    s_cselect_b32 s101, 0xedca9f86, s101
    s_add_u32 s3, s28, s7
    s_add_u32 s3, s3, 0
    s_and_b32 s3, s3, 3
    s_add_u32 s58, s3, 0
    v_lshrrev_b32 v36, 5, v1
    v_bfe_u32 v37, v1, 2, 2
    v_bfe_u32 v38, v1, 4, 1
    v_bfe_u32 v40, v1, 1, 1
    v_bfe_u32 v41, v1, 3, 2
    v_lshlrev_b32 v41, 1, v41
    v_xor_b32 v41, v40, v41
    v_lshlrev_b32 v41, 4, v41
    v_and_b32 v42, 1, v1
    v_lshl_add_u32 v41, v42, 3, v41
    v_lshl_add_u32 v41, v37, 7, v41
    v_lshl_add_u32 v41, v32, 10, v41
    s_and_b32 s3, s5, 1
    s_lshl_b32 s3, s3, 15
    v_add_u32 v12, s3, v41
    v_xor_b32 v13, 32, v12
    v_xor_b32 v14, 64, v12
    v_xor_b32 v15, 96, v12
    v_add_u32 v16, 0x10000, v12
    v_add_u32 v17, 0x10000, v13
    v_add_u32 v18, 0x10000, v14
    v_add_u32 v19, 0x10000, v15
    v_bfe_u32 v41, v1, 2, 3
    v_lshlrev_b32 v41, 1, v41
    v_xor_b32 v41, v40, v41
    v_lshlrev_b32 v41, 4, v41
    v_lshl_add_u32 v41, v42, 3, v41
    v_lshrrev_b32 v39, 2, v1
    v_lshl_add_u32 v41, v39, 8, v41
    v_add_u32 v26, s62, v41
    v_xor_b32 v27, 32, v26
    v_xor_b32 v28, 64, v26
    v_xor_b32 v29, 96, v26
    v_and_b32 v40, 15, v1
    v_bfe_u32 v41, v1, 1, 3
    v_xor_b32 v41, v41, v32
    v_lshlrev_b32 v41, 4, v41
    v_lshl_add_u32 v41, v40, 7, v41
    v_add_u32 v42, s62, v41
    v_xor_b32 v43, 64, v42
    v_lshlrev_b32 v41, 4, v40
    v_lshl_add_u32 v41, v38, 10, v41
    v_lshl_add_u32 v44, v36, 9, v41
    v_lshlrev_b32 v3, 2, v1
    v_lshlrev_b32 v246, 7, v1
    s_and_b32 s3, s2, 7
    s_lshl_b32 s3, s3, 9
    s_lshl_b32 s4, s28, 15
    s_add_u32 s55, s3, s4
    s_add_u32 s55, s55, 15728640
    s_and_b32 s3, s7, 1
    s_lshl_b32 s3, s3, 14
    s_add_u32 s56, s55, s3
    s_and_b32 s3, s5, 1
    s_lshl_b32 s3, s3, 13
    s_add_u32 s56, s56, s3
    s_lshr_b32 s3, s7, 2
    s_lshl_b32 s3, s3, 8
    s_add_u32 s56, s56, s3
    s_lshr_b32 s3, s62, 4
    s_add_u32 s56, s56, s3
    v_lshrrev_b32 v31, 1, v1
    v_lshlrev_b32 v31, 26, v31
    v_lshl_add_u32 v30, v1, 7, v31
    v_lshrrev_b32 v247, 2, v1
    v_lshlrev_b32 v247, 12, v247
    v_and_b32 v31, 3, v1
    v_lshl_add_u32 v247, v31, 7, v247
    v_lshrrev_b32 v31, 3, v1
    v_lshl_add_u32 v247, v31, 27, v247
    s_lshl_b32 s3, s5, 13
    s_add_u32 s55, s55, s3
    s_add_u32 s55, s55, 131072
    v_lshlrev_b32 v32, 26, v1
    v_mov_b32 v33, 1
    s_add_u32 m0, s49, 12288
    s_nop 0
    buffer_load_dwordx4 v8, s[12:15], s52 offen offset:0 lds
    buffer_load_dwordx4 v9, s[12:15], s52 offen offset:1024 lds
    buffer_load_dwordx4 v10, s[12:15], s52 offen offset:2048 lds
    buffer_load_dwordx4 v11, s[12:15], s52 offen offset:3072 lds
    s_waitcnt vmcnt(8)
    s_barrier
    ds_read_b128 a[144:147], v42 offset:4096
    ds_read_b64_tr_b16 a[128:129], v12 offset:0
    ds_read_b64_tr_b16 a[130:131], v12 offset:512
    ds_read_b128 a[148:151], v42 offset:6144
    ds_read_b64_tr_b16 a[132:133], v13 offset:0
    ds_read_b64_tr_b16 a[134:135], v13 offset:512
    ds_read_b128 a[152:155], v42 offset:36864
    ds_read_b64_tr_b16 a[136:137], v14 offset:0
    ds_read_b64_tr_b16 a[138:139], v14 offset:512
    ds_read_b128 a[156:159], v42 offset:38912
    ds_read_b64_tr_b16 a[140:141], v15 offset:0
    ds_read_b64_tr_b16 a[142:143], v15 offset:512
    s_waitcnt lgkmcnt(0)
    v_mfma_f32_16x16x32_bf16 v[48:51], a[128:131], a[144:147], 0
    ds_read_b128 a[176:179], v43 offset:4096
    ds_read_b64_tr_b16 a[160:161], v16 offset:0
    ds_read_b64_tr_b16 a[162:163], v16 offset:512
    v_mfma_f32_16x16x32_bf16 v[56:59], a[128:131], a[148:151], 0
    s_and_b32 s50, s68, 15
    s_lshr_b64 s[68:69], s[68:69], 4
    s_lshl_b32 s51, s50, 19
    v_mfma_f32_16x16x32_bf16 v[64:67], a[128:131], a[152:155], 0
    s_lshl_b32 s52, s50, 7
    s_add_u32 s51, s51, s30
    s_add_u32 s52, s52, s31
    v_mfma_f32_16x16x32_bf16 v[72:75], a[128:131], a[156:159], 0
    s_add_u32 m0, s49, 16384
    s_nop 0
    v_mfma_f32_16x16x32_bf16 v[52:55], a[132:135], a[144:147], 0
    buffer_load_dwordx4 v4, s[8:11], s51 offen offset:0 lds
    v_mfma_f32_16x16x32_bf16 v[60:63], a[132:135], a[148:151], 0
    ds_read_b128 a[180:183], v43 offset:6144
    ds_read_b64_tr_b16 a[164:165], v17 offset:0
    ds_read_b64_tr_b16 a[166:167], v17 offset:512
    v_mfma_f32_16x16x32_bf16 v[68:71], a[132:135], a[152:155], 0
    buffer_load_dwordx4 v5, s[8:11], s51 offen offset:1024 lds
    v_mfma_f32_16x16x32_bf16 v[76:79], a[132:135], a[156:159], 0
    ds_read_b128 a[184:187], v43 offset:36864
    ds_read_b64_tr_b16 a[168:169], v18 offset:0
    ds_read_b64_tr_b16 a[170:171], v18 offset:512
    v_mfma_f32_16x16x32_bf16 v[80:83], a[136:139], a[144:147], 0
    buffer_load_dwordx4 v6, s[8:11], s51 offen offset:2048 lds
    v_mfma_f32_16x16x32_bf16 v[88:91], a[136:139], a[148:151], 0
    ds_read_b128 a[188:191], v43 offset:38912
    ds_read_b64_tr_b16 a[172:173], v19 offset:0
    ds_read_b64_tr_b16 a[174:175], v19 offset:512
    v_mfma_f32_16x16x32_bf16 v[96:99], a[136:139], a[152:155], 0
    buffer_load_dwordx4 v7, s[8:11], s51 offen offset:3072 lds
    v_mfma_f32_16x16x32_bf16 v[104:107], a[136:139], a[156:159], 0
    s_add_u32 m0, s49, 20480
    s_nop 0
    v_mfma_f32_16x16x32_bf16 v[84:87], a[140:143], a[144:147], 0
    buffer_load_dwordx4 v8, s[12:15], s52 offen offset:0 lds
    v_mfma_f32_16x16x32_bf16 v[92:95], a[140:143], a[148:151], 0
    buffer_load_dwordx4 v9, s[12:15], s52 offen offset:1024 lds
    v_mfma_f32_16x16x32_bf16 v[100:103], a[140:143], a[152:155], 0
    buffer_load_dwordx4 v10, s[12:15], s52 offen offset:2048 lds
    v_mfma_f32_16x16x32_bf16 v[108:111], a[140:143], a[156:159], 0
    buffer_load_dwordx4 v11, s[12:15], s52 offen offset:3072 lds
    s_waitcnt vmcnt(8) lgkmcnt(0)
    s_barrier
    v_mfma_f32_16x16x32_bf16 v[48:51], a[160:163], a[176:179], v[48:51]
    ds_read_b128 a[144:147], v42 offset:12288
    ds_read_b64_tr_b16 a[128:129], v12 offset:8192
    v_mfma_f32_16x16x32_bf16 v[56:59], a[160:163], a[180:183], v[56:59]
    ds_read_b64_tr_b16 a[130:131], v12 offset:8704
    s_and_b32 s50, s68, 15
    v_mfma_f32_16x16x32_bf16 v[64:67], a[160:163], a[184:187], v[64:67]
    s_lshr_b64 s[68:69], s[68:69], 4
    ds_read_b128 a[148:151], v42 offset:14336
    v_mfma_f32_16x16x32_bf16 v[72:75], a[160:163], a[188:191], v[72:75]
    ds_read_b64_tr_b16 a[132:133], v13 offset:8192
    ds_read_b64_tr_b16 a[134:135], v13 offset:8704
    v_mfma_f32_16x16x32_bf16 v[52:55], a[164:167], a[176:179], v[52:55]
    s_lshl_b32 s51, s50, 19
    s_lshl_b32 s52, s50, 7
    v_mfma_f32_16x16x32_bf16 v[60:63], a[164:167], a[180:183], v[60:63]
    ds_read_b128 a[152:155], v42 offset:45056
    ds_read_b64_tr_b16 a[136:137], v14 offset:8192
    v_mfma_f32_16x16x32_bf16 v[68:71], a[164:167], a[184:187], v[68:71]
    ds_read_b64_tr_b16 a[138:139], v14 offset:8704
    s_add_u32 s51, s51, s30
    v_mfma_f32_16x16x32_bf16 v[76:79], a[164:167], a[188:191], v[76:79]
    s_add_u32 s52, s52, s31
    ds_read_b128 a[156:159], v42 offset:47104
    v_mfma_f32_16x16x32_bf16 v[80:83], a[168:171], a[176:179], v[80:83]
    ds_read_b64_tr_b16 a[140:141], v15 offset:8192
    v_mfma_f32_16x16x32_bf16 v[88:91], a[168:171], a[180:183], v[88:91]
    ds_read_b64_tr_b16 a[142:143], v15 offset:8704
    s_add_u32 m0, s49, 24576
    v_mfma_f32_16x16x32_bf16 v[96:99], a[168:171], a[184:187], v[96:99]
    buffer_load_dwordx4 v4, s[8:11], s51 offen offset:0 lds
    v_mfma_f32_16x16x32_bf16 v[104:107], a[168:171], a[188:191], v[104:107]
    v_mfma_f32_16x16x32_bf16 v[84:87], a[172:175], a[176:179], v[84:87]
    buffer_load_dwordx4 v5, s[8:11], s51 offen offset:1024 lds
    v_mfma_f32_16x16x32_bf16 v[92:95], a[172:175], a[180:183], v[92:95]
    buffer_load_dwordx4 v6, s[8:11], s51 offen offset:2048 lds
    v_mfma_f32_16x16x32_bf16 v[100:103], a[172:175], a[184:187], v[100:103]
    v_mfma_f32_16x16x32_bf16 v[108:111], a[172:175], a[188:191], v[108:111]
    buffer_load_dwordx4 v7, s[8:11], s51 offen offset:3072 lds
    s_waitcnt lgkmcnt(0)
    v_mfma_f32_16x16x32_bf16 v[48:51], a[128:131], a[144:147], v[48:51]
    ds_read_b128 a[176:179], v43 offset:12288
    ds_read_b64_tr_b16 a[160:161], v16 offset:8192
    v_mfma_f32_16x16x32_bf16 v[56:59], a[128:131], a[148:151], v[56:59]
    ds_read_b64_tr_b16 a[162:163], v16 offset:8704
    v_mfma_f32_16x16x32_bf16 v[64:67], a[128:131], a[152:155], v[64:67]
    ds_read_b128 a[180:183], v43 offset:14336
    ds_read_b64_tr_b16 a[164:165], v17 offset:8192
    v_mfma_f32_16x16x32_bf16 v[72:75], a[128:131], a[156:159], v[72:75]
    ds_read_b64_tr_b16 a[166:167], v17 offset:8704
    v_mfma_f32_16x16x32_bf16 v[52:55], a[132:135], a[144:147], v[52:55]
    ds_read_b128 a[184:187], v43 offset:45056
    ds_read_b64_tr_b16 a[168:169], v18 offset:8192
    v_mfma_f32_16x16x32_bf16 v[60:63], a[132:135], a[148:151], v[60:63]
    ds_read_b64_tr_b16 a[170:171], v18 offset:8704
    v_mfma_f32_16x16x32_bf16 v[68:71], a[132:135], a[152:155], v[68:71]
    ds_read_b128 a[188:191], v43 offset:47104
    ds_read_b64_tr_b16 a[172:173], v19 offset:8192
    v_mfma_f32_16x16x32_bf16 v[76:79], a[132:135], a[156:159], v[76:79]
    ds_read_b64_tr_b16 a[174:175], v19 offset:8704
    s_add_u32 m0, s49, 28672
    v_mfma_f32_16x16x32_bf16 v[80:83], a[136:139], a[144:147], v[80:83]
    v_mfma_f32_16x16x32_bf16 v[88:91], a[136:139], a[148:151], v[88:91]
    buffer_load_dwordx4 v8, s[12:15], s52 offen offset:0 lds
    v_mfma_f32_16x16x32_bf16 v[96:99], a[136:139], a[152:155], v[96:99]
    v_mfma_f32_16x16x32_bf16 v[104:107], a[136:139], a[156:159], v[104:107]
    buffer_load_dwordx4 v9, s[12:15], s52 offen offset:1024 lds
    v_mfma_f32_16x16x32_bf16 v[84:87], a[140:143], a[144:147], v[84:87]
    v_mfma_f32_16x16x32_bf16 v[92:95], a[140:143], a[148:151], v[92:95]
    buffer_load_dwordx4 v10, s[12:15], s52 offen offset:2048 lds
    v_mfma_f32_16x16x32_bf16 v[100:103], a[140:143], a[152:155], v[100:103]
    v_mfma_f32_16x16x32_bf16 v[108:111], a[140:143], a[156:159], v[108:111]
    buffer_load_dwordx4 v11, s[12:15], s52 offen offset:3072 lds
    s_waitcnt vmcnt(8) lgkmcnt(0)
    s_barrier
    v_mfma_f32_16x16x32_bf16 v[48:51], a[160:163], a[176:179], v[48:51]
    ds_read_b128 a[144:147], v42 offset:20480
    ds_read_b64_tr_b16 a[128:129], v12 offset:16384
    v_mfma_f32_16x16x32_bf16 v[56:59], a[160:163], a[180:183], v[56:59]
    ds_read_b64_tr_b16 a[130:131], v12 offset:16896
    s_and_b32 s50, s68, 15
    v_mfma_f32_16x16x32_bf16 v[64:67], a[160:163], a[184:187], v[64:67]
    s_lshr_b64 s[68:69], s[68:69], 4
    ds_read_b128 a[148:151], v42 offset:22528
    v_mfma_f32_16x16x32_bf16 v[72:75], a[160:163], a[188:191], v[72:75]
    ds_read_b64_tr_b16 a[132:133], v13 offset:16384
    ds_read_b64_tr_b16 a[134:135], v13 offset:16896
    v_mfma_f32_16x16x32_bf16 v[52:55], a[164:167], a[176:179], v[52:55]
    s_lshl_b32 s51, s50, 19
    s_lshl_b32 s52, s50, 7
    v_mfma_f32_16x16x32_bf16 v[60:63], a[164:167], a[180:183], v[60:63]
    ds_read_b128 a[152:155], v42 offset:53248
    ds_read_b64_tr_b16 a[136:137], v14 offset:16384
    v_mfma_f32_16x16x32_bf16 v[68:71], a[164:167], a[184:187], v[68:71]
    ds_read_b64_tr_b16 a[138:139], v14 offset:16896
    s_add_u32 s51, s51, s30
    v_mfma_f32_16x16x32_bf16 v[76:79], a[164:167], a[188:191], v[76:79]
    s_add_u32 s52, s52, s31
    ds_read_b128 a[156:159], v42 offset:55296
    v_mfma_f32_16x16x32_bf16 v[80:83], a[168:171], a[176:179], v[80:83]
    ds_read_b64_tr_b16 a[140:141], v15 offset:16384
    v_mfma_f32_16x16x32_bf16 v[88:91], a[168:171], a[180:183], v[88:91]
    ds_read_b64_tr_b16 a[142:143], v15 offset:16896
    s_add_u32 m0, s49, 0
    v_mfma_f32_16x16x32_bf16 v[96:99], a[168:171], a[184:187], v[96:99]
    buffer_load_dwordx4 v4, s[8:11], s51 offen offset:0 lds
    v_mfma_f32_16x16x32_bf16 v[104:107], a[168:171], a[188:191], v[104:107]
    v_mfma_f32_16x16x32_bf16 v[84:87], a[172:175], a[176:179], v[84:87]
    buffer_load_dwordx4 v5, s[8:11], s51 offen offset:1024 lds
    v_mfma_f32_16x16x32_bf16 v[92:95], a[172:175], a[180:183], v[92:95]
    buffer_load_dwordx4 v6, s[8:11], s51 offen offset:2048 lds
    v_mfma_f32_16x16x32_bf16 v[100:103], a[172:175], a[184:187], v[100:103]
    v_mfma_f32_16x16x32_bf16 v[108:111], a[172:175], a[188:191], v[108:111]
    buffer_load_dwordx4 v7, s[8:11], s51 offen offset:3072 lds
    s_waitcnt lgkmcnt(0)
    v_mfma_f32_16x16x32_bf16 v[48:51], a[128:131], a[144:147], v[48:51]
    ds_read_b128 a[176:179], v43 offset:20480
    ds_read_b64_tr_b16 a[160:161], v16 offset:16384
    v_mfma_f32_16x16x32_bf16 v[56:59], a[128:131], a[148:151], v[56:59]
    ds_read_b64_tr_b16 a[162:163], v16 offset:16896
    v_mfma_f32_16x16x32_bf16 v[64:67], a[128:131], a[152:155], v[64:67]
    ds_read_b128 a[180:183], v43 offset:22528
    ds_read_b64_tr_b16 a[164:165], v17 offset:16384
    v_mfma_f32_16x16x32_bf16 v[72:75], a[128:131], a[156:159], v[72:75]
    ds_read_b64_tr_b16 a[166:167], v17 offset:16896
    v_mfma_f32_16x16x32_bf16 v[52:55], a[132:135], a[144:147], v[52:55]
    ds_read_b128 a[184:187], v43 offset:53248
    ds_read_b64_tr_b16 a[168:169], v18 offset:16384
    v_mfma_f32_16x16x32_bf16 v[60:63], a[132:135], a[148:151], v[60:63]
    ds_read_b64_tr_b16 a[170:171], v18 offset:16896
    v_mfma_f32_16x16x32_bf16 v[68:71], a[132:135], a[152:155], v[68:71]
    ds_read_b128 a[188:191], v43 offset:55296
    ds_read_b64_tr_b16 a[172:173], v19 offset:16384
    v_mfma_f32_16x16x32_bf16 v[76:79], a[132:135], a[156:159], v[76:79]
    ds_read_b64_tr_b16 a[174:175], v19 offset:16896
    s_add_u32 m0, s49, 4096
    v_mfma_f32_16x16x32_bf16 v[80:83], a[136:139], a[144:147], v[80:83]
    v_mfma_f32_16x16x32_bf16 v[88:91], a[136:139], a[148:151], v[88:91]
    buffer_load_dwordx4 v8, s[12:15], s52 offen offset:0 lds
    v_mfma_f32_16x16x32_bf16 v[96:99], a[136:139], a[152:155], v[96:99]
    v_mfma_f32_16x16x32_bf16 v[104:107], a[136:139], a[156:159], v[104:107]
    buffer_load_dwordx4 v9, s[12:15], s52 offen offset:1024 lds
    v_mfma_f32_16x16x32_bf16 v[84:87], a[140:143], a[144:147], v[84:87]
    v_mfma_f32_16x16x32_bf16 v[92:95], a[140:143], a[148:151], v[92:95]
    buffer_load_dwordx4 v10, s[12:15], s52 offen offset:2048 lds
    v_mfma_f32_16x16x32_bf16 v[100:103], a[140:143], a[152:155], v[100:103]
    v_mfma_f32_16x16x32_bf16 v[108:111], a[140:143], a[156:159], v[108:111]
    buffer_load_dwordx4 v11, s[12:15], s52 offen offset:3072 lds
    s_waitcnt vmcnt(8) lgkmcnt(0)
    s_barrier
    v_mfma_f32_16x16x32_bf16 v[48:51], a[160:163], a[176:179], v[48:51]
    ds_read_b128 a[144:147], v42 offset:28672
    ds_read_b64_tr_b16 a[128:129], v12 offset:24576
    v_mfma_f32_16x16x32_bf16 v[56:59], a[160:163], a[180:183], v[56:59]
    ds_read_b64_tr_b16 a[130:131], v12 offset:25088
    s_and_b32 s50, s68, 15
    v_mfma_f32_16x16x32_bf16 v[64:67], a[160:163], a[184:187], v[64:67]
    s_lshr_b64 s[68:69], s[68:69], 4
    ds_read_b128 a[148:151], v42 offset:30720
    v_mfma_f32_16x16x32_bf16 v[72:75], a[160:163], a[188:191], v[72:75]
    ds_read_b64_tr_b16 a[132:133], v13 offset:24576
    ds_read_b64_tr_b16 a[134:135], v13 offset:25088
    v_mfma_f32_16x16x32_bf16 v[52:55], a[164:167], a[176:179], v[52:55]
    s_lshl_b32 s51, s50, 19
    s_lshl_b32 s52, s50, 7
    v_mfma_f32_16x16x32_bf16 v[60:63], a[164:167], a[180:183], v[60:63]
    ds_read_b128 a[152:155], v42 offset:61440
    ds_read_b64_tr_b16 a[136:137], v14 offset:24576
    v_mfma_f32_16x16x32_bf16 v[68:71], a[164:167], a[184:187], v[68:71]
    ds_read_b64_tr_b16 a[138:139], v14 offset:25088
    s_add_u32 s51, s51, s30
    v_mfma_f32_16x16x32_bf16 v[76:79], a[164:167], a[188:191], v[76:79]
    s_add_u32 s52, s52, s31
    ds_read_b128 a[156:159], v42 offset:63488
    v_mfma_f32_16x16x32_bf16 v[80:83], a[168:171], a[176:179], v[80:83]
    ds_read_b64_tr_b16 a[140:141], v15 offset:24576
    v_mfma_f32_16x16x32_bf16 v[88:91], a[168:171], a[180:183], v[88:91]
    ds_read_b64_tr_b16 a[142:143], v15 offset:25088
    s_add_u32 m0, s49, 8192
    v_mfma_f32_16x16x32_bf16 v[96:99], a[168:171], a[184:187], v[96:99]
    buffer_load_dwordx4 v4, s[8:11], s51 offen offset:0 lds
    v_mfma_f32_16x16x32_bf16 v[104:107], a[168:171], a[188:191], v[104:107]
    v_mfma_f32_16x16x32_bf16 v[84:87], a[172:175], a[176:179], v[84:87]
    buffer_load_dwordx4 v5, s[8:11], s51 offen offset:1024 lds
    v_mfma_f32_16x16x32_bf16 v[92:95], a[172:175], a[180:183], v[92:95]
    buffer_load_dwordx4 v6, s[8:11], s51 offen offset:2048 lds
    v_mfma_f32_16x16x32_bf16 v[100:103], a[172:175], a[184:187], v[100:103]
    v_mfma_f32_16x16x32_bf16 v[108:111], a[172:175], a[188:191], v[108:111]
    buffer_load_dwordx4 v7, s[8:11], s51 offen offset:3072 lds
    s_waitcnt lgkmcnt(0)
    v_mfma_f32_16x16x32_bf16 v[48:51], a[128:131], a[144:147], v[48:51]
    ds_read_b128 a[176:179], v43 offset:28672
    ds_read_b64_tr_b16 a[160:161], v16 offset:24576
    v_mfma_f32_16x16x32_bf16 v[56:59], a[128:131], a[148:151], v[56:59]
    ds_read_b64_tr_b16 a[162:163], v16 offset:25088
    v_mfma_f32_16x16x32_bf16 v[64:67], a[128:131], a[152:155], v[64:67]
    ds_read_b128 a[180:183], v43 offset:30720
    ds_read_b64_tr_b16 a[164:165], v17 offset:24576
    v_mfma_f32_16x16x32_bf16 v[72:75], a[128:131], a[156:159], v[72:75]
    ds_read_b64_tr_b16 a[166:167], v17 offset:25088
    v_mfma_f32_16x16x32_bf16 v[52:55], a[132:135], a[144:147], v[52:55]
    ds_read_b128 a[184:187], v43 offset:61440
    ds_read_b64_tr_b16 a[168:169], v18 offset:24576
    v_mfma_f32_16x16x32_bf16 v[60:63], a[132:135], a[148:151], v[60:63]
    ds_read_b64_tr_b16 a[170:171], v18 offset:25088
    v_mfma_f32_16x16x32_bf16 v[68:71], a[132:135], a[152:155], v[68:71]
    ds_read_b128 a[188:191], v43 offset:63488
    ds_read_b64_tr_b16 a[172:173], v19 offset:24576
    v_mfma_f32_16x16x32_bf16 v[76:79], a[132:135], a[156:159], v[76:79]
    ds_read_b64_tr_b16 a[174:175], v19 offset:25088
    s_add_u32 m0, s49, 12288
    v_mfma_f32_16x16x32_bf16 v[80:83], a[136:139], a[144:147], v[80:83]
    v_mfma_f32_16x16x32_bf16 v[88:91], a[136:139], a[148:151], v[88:91]
    buffer_load_dwordx4 v8, s[12:15], s52 offen offset:0 lds
    v_mfma_f32_16x16x32_bf16 v[96:99], a[136:139], a[152:155], v[96:99]
    v_mfma_f32_16x16x32_bf16 v[104:107], a[136:139], a[156:159], v[104:107]
    buffer_load_dwordx4 v9, s[12:15], s52 offen offset:1024 lds
    v_mfma_f32_16x16x32_bf16 v[84:87], a[140:143], a[144:147], v[84:87]
    v_mfma_f32_16x16x32_bf16 v[92:95], a[140:143], a[148:151], v[92:95]
    buffer_load_dwordx4 v10, s[12:15], s52 offen offset:2048 lds
    v_mfma_f32_16x16x32_bf16 v[100:103], a[140:143], a[152:155], v[100:103]
    v_mfma_f32_16x16x32_bf16 v[108:111], a[140:143], a[156:159], v[108:111]
    buffer_load_dwordx4 v11, s[12:15], s52 offen offset:3072 lds
    s_waitcnt vmcnt(8) lgkmcnt(0)
    s_barrier
    v_mfma_f32_16x16x32_bf16 v[48:51], a[160:163], a[176:179], v[48:51]
    ds_read_b128 a[144:147], v42 offset:4096
    ds_read_b64_tr_b16 a[128:129], v12 offset:0
    v_mfma_f32_16x16x32_bf16 v[56:59], a[160:163], a[180:183], v[56:59]
    ds_read_b64_tr_b16 a[130:131], v12 offset:512
    s_and_b32 s50, s68, 15
    v_mfma_f32_16x16x32_bf16 v[64:67], a[160:163], a[184:187], v[64:67]
    s_lshr_b64 s[68:69], s[68:69], 4
    ds_read_b128 a[148:151], v42 offset:6144
    v_mfma_f32_16x16x32_bf16 v[72:75], a[160:163], a[188:191], v[72:75]
    ds_read_b64_tr_b16 a[132:133], v13 offset:0
    ds_read_b64_tr_b16 a[134:135], v13 offset:512
    v_mfma_f32_16x16x32_bf16 v[52:55], a[164:167], a[176:179], v[52:55]
    s_branch IP_sk1
IP_pg1:
    s_branch IP_ret1
IP_sk1:
    s_lshl_b32 s51, s50, 19
    s_lshl_b32 s52, s50, 7
    v_mfma_f32_16x16x32_bf16 v[60:63], a[164:167], a[180:183], v[60:63]
    ds_read_b128 a[152:155], v42 offset:36864
    ds_read_b64_tr_b16 a[136:137], v14 offset:0
    v_mfma_f32_16x16x32_bf16 v[68:71], a[164:167], a[184:187], v[68:71]
    ds_read_b64_tr_b16 a[138:139], v14 offset:512
    s_add_u32 s51, s51, s30
    v_mfma_f32_16x16x32_bf16 v[76:79], a[164:167], a[188:191], v[76:79]
    s_add_u32 s52, s52, s31
    ds_read_b128 a[156:159], v42 offset:38912
    v_mfma_f32_16x16x32_bf16 v[80:83], a[168:171], a[176:179], v[80:83]
    ds_read_b64_tr_b16 a[140:141], v15 offset:0
    v_mfma_f32_16x16x32_bf16 v[88:91], a[168:171], a[180:183], v[88:91]
    ds_read_b64_tr_b16 a[142:143], v15 offset:512
    s_add_u32 m0, s49, 16384
    v_mfma_f32_16x16x32_bf16 v[96:99], a[168:171], a[184:187], v[96:99]
    buffer_load_dwordx4 v4, s[8:11], s51 offen offset:0 lds
    v_mfma_f32_16x16x32_bf16 v[104:107], a[168:171], a[188:191], v[104:107]
    v_mfma_f32_16x16x32_bf16 v[84:87], a[172:175], a[176:179], v[84:87]
    buffer_load_dwordx4 v5, s[8:11], s51 offen offset:1024 lds
    v_mfma_f32_16x16x32_bf16 v[92:95], a[172:175], a[180:183], v[92:95]
    buffer_load_dwordx4 v6, s[8:11], s51 offen offset:2048 lds
    v_mfma_f32_16x16x32_bf16 v[100:103], a[172:175], a[184:187], v[100:103]
    v_mfma_f32_16x16x32_bf16 v[108:111], a[172:175], a[188:191], v[108:111]
    buffer_load_dwordx4 v7, s[8:11], s51 offen offset:3072 lds
    s_waitcnt lgkmcnt(0)
    v_mfma_f32_16x16x32_bf16 v[48:51], a[128:131], a[144:147], v[48:51]
    ds_read_b128 a[176:179], v43 offset:4096
    ds_read_b64_tr_b16 a[160:161], v16 offset:0
    v_mfma_f32_16x16x32_bf16 v[56:59], a[128:131], a[148:151], v[56:59]
    ds_read_b64_tr_b16 a[162:163], v16 offset:512
    v_mfma_f32_16x16x32_bf16 v[64:67], a[128:131], a[152:155], v[64:67]
    ds_read_b128 a[180:183], v43 offset:6144
    ds_read_b64_tr_b16 a[164:165], v17 offset:0
    v_mfma_f32_16x16x32_bf16 v[72:75], a[128:131], a[156:159], v[72:75]
    ds_read_b64_tr_b16 a[166:167], v17 offset:512
    v_mfma_f32_16x16x32_bf16 v[52:55], a[132:135], a[144:147], v[52:55]
    ds_read_b128 a[184:187], v43 offset:36864
    ds_read_b64_tr_b16 a[168:169], v18 offset:0
    v_mfma_f32_16x16x32_bf16 v[60:63], a[132:135], a[148:151], v[60:63]
    ds_read_b64_tr_b16 a[170:171], v18 offset:512
    v_mfma_f32_16x16x32_bf16 v[68:71], a[132:135], a[152:155], v[68:71]
    ds_read_b128 a[188:191], v43 offset:38912
    ds_read_b64_tr_b16 a[172:173], v19 offset:0
    v_mfma_f32_16x16x32_bf16 v[76:79], a[132:135], a[156:159], v[76:79]
    ds_read_b64_tr_b16 a[174:175], v19 offset:512
    s_add_u32 m0, s49, 20480
    v_mfma_f32_16x16x32_bf16 v[80:83], a[136:139], a[144:147], v[80:83]
    v_mfma_f32_16x16x32_bf16 v[88:91], a[136:139], a[148:151], v[88:91]
    buffer_load_dwordx4 v8, s[12:15], s52 offen offset:0 lds
    v_mfma_f32_16x16x32_bf16 v[96:99], a[136:139], a[152:155], v[96:99]
    v_mfma_f32_16x16x32_bf16 v[104:107], a[136:139], a[156:159], v[104:107]
    buffer_load_dwordx4 v9, s[12:15], s52 offen offset:1024 lds
    v_mfma_f32_16x16x32_bf16 v[84:87], a[140:143], a[144:147], v[84:87]
    v_mfma_f32_16x16x32_bf16 v[92:95], a[140:143], a[148:151], v[92:95]
    buffer_load_dwordx4 v10, s[12:15], s52 offen offset:2048 lds
    v_mfma_f32_16x16x32_bf16 v[100:103], a[140:143], a[152:155], v[100:103]
    v_mfma_f32_16x16x32_bf16 v[108:111], a[140:143], a[156:159], v[108:111]
    buffer_load_dwordx4 v11, s[12:15], s52 offen offset:3072 lds
    s_waitcnt vmcnt(8) lgkmcnt(0)
    s_barrier
    v_mfma_f32_16x16x32_bf16 v[48:51], a[160:163], a[176:179], v[48:51]
    ds_read_b128 a[144:147], v42 offset:12288
    ds_read_b64_tr_b16 a[128:129], v12 offset:8192
    v_mfma_f32_16x16x32_bf16 v[56:59], a[160:163], a[180:183], v[56:59]
    ds_read_b64_tr_b16 a[130:131], v12 offset:8704
    s_and_b32 s50, s68, 15
    v_mfma_f32_16x16x32_bf16 v[64:67], a[160:163], a[184:187], v[64:67]
    s_lshr_b64 s[68:69], s[68:69], 4
    ds_read_b128 a[148:151], v42 offset:14336
    v_mfma_f32_16x16x32_bf16 v[72:75], a[160:163], a[188:191], v[72:75]
    ds_read_b64_tr_b16 a[132:133], v13 offset:8192
    ds_read_b64_tr_b16 a[134:135], v13 offset:8704
    v_mfma_f32_16x16x32_bf16 v[52:55], a[164:167], a[176:179], v[52:55]
    s_lshl_b32 s51, s50, 19
    s_lshl_b32 s52, s50, 7
    v_mfma_f32_16x16x32_bf16 v[60:63], a[164:167], a[180:183], v[60:63]
    ds_read_b128 a[152:155], v42 offset:45056
    ds_read_b64_tr_b16 a[136:137], v14 offset:8192
    v_mfma_f32_16x16x32_bf16 v[68:71], a[164:167], a[184:187], v[68:71]
    ds_read_b64_tr_b16 a[138:139], v14 offset:8704
    s_add_u32 s51, s51, s30
    v_mfma_f32_16x16x32_bf16 v[76:79], a[164:167], a[188:191], v[76:79]
    s_add_u32 s52, s52, s31
    ds_read_b128 a[156:159], v42 offset:47104
    v_mfma_f32_16x16x32_bf16 v[80:83], a[168:171], a[176:179], v[80:83]
    ds_read_b64_tr_b16 a[140:141], v15 offset:8192
    v_mfma_f32_16x16x32_bf16 v[88:91], a[168:171], a[180:183], v[88:91]
    ds_read_b64_tr_b16 a[142:143], v15 offset:8704
    s_add_u32 m0, s49, 24576
    v_mfma_f32_16x16x32_bf16 v[96:99], a[168:171], a[184:187], v[96:99]
    buffer_load_dwordx4 v4, s[8:11], s51 offen offset:0 lds
    v_mfma_f32_16x16x32_bf16 v[104:107], a[168:171], a[188:191], v[104:107]
    v_mfma_f32_16x16x32_bf16 v[84:87], a[172:175], a[176:179], v[84:87]
    buffer_load_dwordx4 v5, s[8:11], s51 offen offset:1024 lds
    v_mfma_f32_16x16x32_bf16 v[92:95], a[172:175], a[180:183], v[92:95]
    buffer_load_dwordx4 v6, s[8:11], s51 offen offset:2048 lds
    v_mfma_f32_16x16x32_bf16 v[100:103], a[172:175], a[184:187], v[100:103]
    v_mfma_f32_16x16x32_bf16 v[108:111], a[172:175], a[188:191], v[108:111]
    buffer_load_dwordx4 v7, s[8:11], s51 offen offset:3072 lds
    s_waitcnt lgkmcnt(0)
    v_mfma_f32_16x16x32_bf16 v[48:51], a[128:131], a[144:147], v[48:51]
    ds_read_b128 a[176:179], v43 offset:12288
    ds_read_b64_tr_b16 a[160:161], v16 offset:8192
    v_mfma_f32_16x16x32_bf16 v[56:59], a[128:131], a[148:151], v[56:59]
    ds_read_b64_tr_b16 a[162:163], v16 offset:8704
    v_mfma_f32_16x16x32_bf16 v[64:67], a[128:131], a[152:155], v[64:67]
    ds_read_b128 a[180:183], v43 offset:14336
    ds_read_b64_tr_b16 a[164:165], v17 offset:8192
    v_mfma_f32_16x16x32_bf16 v[72:75], a[128:131], a[156:159], v[72:75]
    ds_read_b64_tr_b16 a[166:167], v17 offset:8704
    v_mfma_f32_16x16x32_bf16 v[52:55], a[132:135], a[144:147], v[52:55]
    ds_read_b128 a[184:187], v43 offset:45056
    ds_read_b64_tr_b16 a[168:169], v18 offset:8192
    v_mfma_f32_16x16x32_bf16 v[60:63], a[132:135], a[148:151], v[60:63]
    ds_read_b64_tr_b16 a[170:171], v18 offset:8704
    v_mfma_f32_16x16x32_bf16 v[68:71], a[132:135], a[152:155], v[68:71]
    ds_read_b128 a[188:191], v43 offset:47104
    ds_read_b64_tr_b16 a[172:173], v19 offset:8192
    v_mfma_f32_16x16x32_bf16 v[76:79], a[132:135], a[156:159], v[76:79]
    ds_read_b64_tr_b16 a[174:175], v19 offset:8704
    s_add_u32 m0, s49, 28672
    v_mfma_f32_16x16x32_bf16 v[80:83], a[136:139], a[144:147], v[80:83]
    v_mfma_f32_16x16x32_bf16 v[88:91], a[136:139], a[148:151], v[88:91]
    buffer_load_dwordx4 v8, s[12:15], s52 offen offset:0 lds
    v_mfma_f32_16x16x32_bf16 v[96:99], a[136:139], a[152:155], v[96:99]
    v_mfma_f32_16x16x32_bf16 v[104:107], a[136:139], a[156:159], v[104:107]
    buffer_load_dwordx4 v9, s[12:15], s52 offen offset:1024 lds
    v_mfma_f32_16x16x32_bf16 v[84:87], a[140:143], a[144:147], v[84:87]
    v_mfma_f32_16x16x32_bf16 v[92:95], a[140:143], a[148:151], v[92:95]
    buffer_load_dwordx4 v10, s[12:15], s52 offen offset:2048 lds
    v_mfma_f32_16x16x32_bf16 v[100:103], a[140:143], a[152:155], v[100:103]
    v_mfma_f32_16x16x32_bf16 v[108:111], a[140:143], a[156:159], v[108:111]
    buffer_load_dwordx4 v11, s[12:15], s52 offen offset:3072 lds
    s_waitcnt vmcnt(8) lgkmcnt(0)
    s_barrier
    v_mfma_f32_16x16x32_bf16 v[48:51], a[160:163], a[176:179], v[48:51]
    ds_read_b128 a[144:147], v42 offset:20480
    ds_read_b64_tr_b16 a[128:129], v12 offset:16384
    v_mfma_f32_16x16x32_bf16 v[56:59], a[160:163], a[180:183], v[56:59]
    ds_read_b64_tr_b16 a[130:131], v12 offset:16896
    s_and_b32 s50, s68, 15
    v_mfma_f32_16x16x32_bf16 v[64:67], a[160:163], a[184:187], v[64:67]
    s_lshr_b64 s[68:69], s[68:69], 4
    ds_read_b128 a[148:151], v42 offset:22528
    v_mfma_f32_16x16x32_bf16 v[72:75], a[160:163], a[188:191], v[72:75]
    ds_read_b64_tr_b16 a[132:133], v13 offset:16384
    ds_read_b64_tr_b16 a[134:135], v13 offset:16896
    v_mfma_f32_16x16x32_bf16 v[52:55], a[164:167], a[176:179], v[52:55]
    s_lshl_b32 s51, s50, 19
    s_lshl_b32 s52, s50, 7
    v_mfma_f32_16x16x32_bf16 v[60:63], a[164:167], a[180:183], v[60:63]
    ds_read_b128 a[152:155], v42 offset:53248
    ds_read_b64_tr_b16 a[136:137], v14 offset:16384
    v_mfma_f32_16x16x32_bf16 v[68:71], a[164:167], a[184:187], v[68:71]
    ds_read_b64_tr_b16 a[138:139], v14 offset:16896
    s_add_u32 s51, s51, s30
    v_mfma_f32_16x16x32_bf16 v[76:79], a[164:167], a[188:191], v[76:79]
    s_add_u32 s52, s52, s31
    ds_read_b128 a[156:159], v42 offset:55296
    v_mfma_f32_16x16x32_bf16 v[80:83], a[168:171], a[176:179], v[80:83]
    ds_read_b64_tr_b16 a[140:141], v15 offset:16384
    v_mfma_f32_16x16x32_bf16 v[88:91], a[168:171], a[180:183], v[88:91]
    ds_read_b64_tr_b16 a[142:143], v15 offset:16896
    s_add_u32 m0, s49, 0
    v_mfma_f32_16x16x32_bf16 v[96:99], a[168:171], a[184:187], v[96:99]
    buffer_load_dwordx4 v4, s[8:11], s51 offen offset:0 lds
    v_mfma_f32_16x16x32_bf16 v[104:107], a[168:171], a[188:191], v[104:107]
    v_mfma_f32_16x16x32_bf16 v[84:87], a[172:175], a[176:179], v[84:87]
    buffer_load_dwordx4 v5, s[8:11], s51 offen offset:1024 lds
    v_mfma_f32_16x16x32_bf16 v[92:95], a[172:175], a[180:183], v[92:95]
    buffer_load_dwordx4 v6, s[8:11], s51 offen offset:2048 lds
    v_mfma_f32_16x16x32_bf16 v[100:103], a[172:175], a[184:187], v[100:103]
    v_mfma_f32_16x16x32_bf16 v[108:111], a[172:175], a[188:191], v[108:111]
    buffer_load_dwordx4 v7, s[8:11], s51 offen offset:3072 lds
    s_waitcnt lgkmcnt(0)
    v_mfma_f32_16x16x32_bf16 v[48:51], a[128:131], a[144:147], v[48:51]
    ds_read_b128 a[176:179], v43 offset:20480
    ds_read_b64_tr_b16 a[160:161], v16 offset:16384
    v_mfma_f32_16x16x32_bf16 v[56:59], a[128:131], a[148:151], v[56:59]
    ds_read_b64_tr_b16 a[162:163], v16 offset:16896
    v_mfma_f32_16x16x32_bf16 v[64:67], a[128:131], a[152:155], v[64:67]
    ds_read_b128 a[180:183], v43 offset:22528
    ds_read_b64_tr_b16 a[164:165], v17 offset:16384
    v_mfma_f32_16x16x32_bf16 v[72:75], a[128:131], a[156:159], v[72:75]
    ds_read_b64_tr_b16 a[166:167], v17 offset:16896
    v_mfma_f32_16x16x32_bf16 v[52:55], a[132:135], a[144:147], v[52:55]
    ds_read_b128 a[184:187], v43 offset:53248
    ds_read_b64_tr_b16 a[168:169], v18 offset:16384
    v_mfma_f32_16x16x32_bf16 v[60:63], a[132:135], a[148:151], v[60:63]
    ds_read_b64_tr_b16 a[170:171], v18 offset:16896
    v_mfma_f32_16x16x32_bf16 v[68:71], a[132:135], a[152:155], v[68:71]
    ds_read_b128 a[188:191], v43 offset:55296
    ds_read_b64_tr_b16 a[172:173], v19 offset:16384
    v_mfma_f32_16x16x32_bf16 v[76:79], a[132:135], a[156:159], v[76:79]
    ds_read_b64_tr_b16 a[174:175], v19 offset:16896
    s_add_u32 m0, s49, 4096
    v_mfma_f32_16x16x32_bf16 v[80:83], a[136:139], a[144:147], v[80:83]
    v_mfma_f32_16x16x32_bf16 v[88:91], a[136:139], a[148:151], v[88:91]
    buffer_load_dwordx4 v8, s[12:15], s52 offen offset:0 lds
    v_mfma_f32_16x16x32_bf16 v[96:99], a[136:139], a[152:155], v[96:99]
    v_mfma_f32_16x16x32_bf16 v[104:107], a[136:139], a[156:159], v[104:107]
    buffer_load_dwordx4 v9, s[12:15], s52 offen offset:1024 lds
    v_mfma_f32_16x16x32_bf16 v[84:87], a[140:143], a[144:147], v[84:87]
    v_mfma_f32_16x16x32_bf16 v[92:95], a[140:143], a[148:151], v[92:95]
    buffer_load_dwordx4 v10, s[12:15], s52 offen offset:2048 lds
    v_mfma_f32_16x16x32_bf16 v[100:103], a[140:143], a[152:155], v[100:103]
    v_mfma_f32_16x16x32_bf16 v[108:111], a[140:143], a[156:159], v[108:111]
    buffer_load_dwordx4 v11, s[12:15], s52 offen offset:3072 lds
    s_sub_u32 s58, s58, 1
    s_cbranch_scc0 Q_t_1
    buffer_load_dword v2, v3, s[36:39], 0 offen sc1
    buffer_load_dword v31, v30, s[24:27], s56 offen sc1
    buffer_load_dword v31, v246, s[24:27], s64 offen sc1
Q_t_1:
    s_waitcnt vmcnt(8) lgkmcnt(0)
    s_barrier
    v_mfma_f32_16x16x32_bf16 v[48:51], a[160:163], a[176:179], v[48:51]
    ds_read_b128 a[144:147], v42 offset:28672
    ds_read_b64_tr_b16 a[128:129], v12 offset:24576
    v_mfma_f32_16x16x32_bf16 v[56:59], a[160:163], a[180:183], v[56:59]
    ds_read_b64_tr_b16 a[130:131], v12 offset:25088
    s_and_b32 s50, s68, 15
    v_mfma_f32_16x16x32_bf16 v[64:67], a[160:163], a[184:187], v[64:67]
    s_lshr_b64 s[68:69], s[68:69], 4
    ds_read_b128 a[148:151], v42 offset:30720
    v_mfma_f32_16x16x32_bf16 v[72:75], a[160:163], a[188:191], v[72:75]
    ds_read_b64_tr_b16 a[132:133], v13 offset:24576
    ds_read_b64_tr_b16 a[134:135], v13 offset:25088
    v_mfma_f32_16x16x32_bf16 v[52:55], a[164:167], a[176:179], v[52:55]
    s_lshl_b32 s51, s50, 19
    s_lshl_b32 s52, s50, 7
    v_mfma_f32_16x16x32_bf16 v[60:63], a[164:167], a[180:183], v[60:63]
    ds_read_b128 a[152:155], v42 offset:61440
    ds_read_b64_tr_b16 a[136:137], v14 offset:24576
    v_mfma_f32_16x16x32_bf16 v[68:71], a[164:167], a[184:187], v[68:71]
    ds_read_b64_tr_b16 a[138:139], v14 offset:25088
    s_add_u32 s51, s51, s30
    v_mfma_f32_16x16x32_bf16 v[76:79], a[164:167], a[188:191], v[76:79]
    s_add_u32 s52, s52, s31
    ds_read_b128 a[156:159], v42 offset:63488
    v_mfma_f32_16x16x32_bf16 v[80:83], a[168:171], a[176:179], v[80:83]
    ds_read_b64_tr_b16 a[140:141], v15 offset:24576
    v_mfma_f32_16x16x32_bf16 v[88:91], a[168:171], a[180:183], v[88:91]
    ds_read_b64_tr_b16 a[142:143], v15 offset:25088
    s_add_u32 m0, s49, 8192
    v_mfma_f32_16x16x32_bf16 v[96:99], a[168:171], a[184:187], v[96:99]
    buffer_load_dwordx4 v4, s[8:11], s51 offen offset:0 lds
    v_mfma_f32_16x16x32_bf16 v[104:107], a[168:171], a[188:191], v[104:107]
    v_mfma_f32_16x16x32_bf16 v[84:87], a[172:175], a[176:179], v[84:87]
    buffer_load_dwordx4 v5, s[8:11], s51 offen offset:1024 lds
    v_mfma_f32_16x16x32_bf16 v[92:95], a[172:175], a[180:183], v[92:95]
    buffer_load_dwordx4 v6, s[8:11], s51 offen offset:2048 lds
    v_mfma_f32_16x16x32_bf16 v[100:103], a[172:175], a[184:187], v[100:103]
    v_mfma_f32_16x16x32_bf16 v[108:111], a[172:175], a[188:191], v[108:111]
    buffer_load_dwordx4 v7, s[8:11], s51 offen offset:3072 lds
    s_waitcnt lgkmcnt(0)
    v_mfma_f32_16x16x32_bf16 v[48:51], a[128:131], a[144:147], v[48:51]
    ds_read_b128 a[176:179], v43 offset:28672
    ds_read_b64_tr_b16 a[160:161], v16 offset:24576
    v_mfma_f32_16x16x32_bf16 v[56:59], a[128:131], a[148:151], v[56:59]
    ds_read_b64_tr_b16 a[162:163], v16 offset:25088
    v_mfma_f32_16x16x32_bf16 v[64:67], a[128:131], a[152:155], v[64:67]
    ds_read_b128 a[180:183], v43 offset:30720
    ds_read_b64_tr_b16 a[164:165], v17 offset:24576
    v_mfma_f32_16x16x32_bf16 v[72:75], a[128:131], a[156:159], v[72:75]
    ds_read_b64_tr_b16 a[166:167], v17 offset:25088
    v_mfma_f32_16x16x32_bf16 v[52:55], a[132:135], a[144:147], v[52:55]
    ds_read_b128 a[184:187], v43 offset:61440
    ds_read_b64_tr_b16 a[168:169], v18 offset:24576
    v_mfma_f32_16x16x32_bf16 v[60:63], a[132:135], a[148:151], v[60:63]
    ds_read_b64_tr_b16 a[170:171], v18 offset:25088
    v_mfma_f32_16x16x32_bf16 v[68:71], a[132:135], a[152:155], v[68:71]
    ds_read_b128 a[188:191], v43 offset:63488
    ds_read_b64_tr_b16 a[172:173], v19 offset:24576
    v_mfma_f32_16x16x32_bf16 v[76:79], a[132:135], a[156:159], v[76:79]
    ds_read_b64_tr_b16 a[174:175], v19 offset:25088
    s_add_u32 m0, s49, 12288
    v_mfma_f32_16x16x32_bf16 v[80:83], a[136:139], a[144:147], v[80:83]
    v_mfma_f32_16x16x32_bf16 v[88:91], a[136:139], a[148:151], v[88:91]
    buffer_load_dwordx4 v8, s[12:15], s52 offen offset:0 lds
    v_mfma_f32_16x16x32_bf16 v[96:99], a[136:139], a[152:155], v[96:99]
    v_mfma_f32_16x16x32_bf16 v[104:107], a[136:139], a[156:159], v[104:107]
    buffer_load_dwordx4 v9, s[12:15], s52 offen offset:1024 lds
    v_mfma_f32_16x16x32_bf16 v[84:87], a[140:143], a[144:147], v[84:87]
    v_mfma_f32_16x16x32_bf16 v[92:95], a[140:143], a[148:151], v[92:95]
    buffer_load_dwordx4 v10, s[12:15], s52 offen offset:2048 lds
    v_mfma_f32_16x16x32_bf16 v[100:103], a[140:143], a[152:155], v[100:103]
    v_mfma_f32_16x16x32_bf16 v[108:111], a[140:143], a[156:159], v[108:111]
    buffer_load_dwordx4 v11, s[12:15], s52 offen offset:3072 lds
    s_sub_u32 s58, s58, 1
    s_cbranch_scc0 Q_t_2
    buffer_load_dword v2, v3, s[36:39], 0 offen sc1
    buffer_load_dword v31, v30, s[24:27], s56 offen sc1
    buffer_load_dword v31, v246, s[24:27], s64 offen sc1
Q_t_2:
    s_waitcnt vmcnt(8) lgkmcnt(0)
    s_barrier
    v_mfma_f32_16x16x32_bf16 v[48:51], a[160:163], a[176:179], v[48:51]
    ds_read_b128 a[144:147], v42 offset:4096
    ds_read_b64_tr_b16 a[128:129], v12 offset:0
    v_mfma_f32_16x16x32_bf16 v[56:59], a[160:163], a[180:183], v[56:59]
    ds_read_b64_tr_b16 a[130:131], v12 offset:512
    s_and_b32 s50, s68, 15
    v_mfma_f32_16x16x32_bf16 v[64:67], a[160:163], a[184:187], v[64:67]
    s_lshr_b64 s[68:69], s[68:69], 4
    ds_read_b128 a[148:151], v42 offset:6144
    v_mfma_f32_16x16x32_bf16 v[72:75], a[160:163], a[188:191], v[72:75]
    ds_read_b64_tr_b16 a[132:133], v13 offset:0
    ds_read_b64_tr_b16 a[134:135], v13 offset:512
    v_mfma_f32_16x16x32_bf16 v[52:55], a[164:167], a[176:179], v[52:55]
    s_lshl_b32 s51, s50, 19
    s_lshl_b32 s52, s50, 7
    v_mfma_f32_16x16x32_bf16 v[60:63], a[164:167], a[180:183], v[60:63]
    ds_read_b128 a[152:155], v42 offset:36864
    ds_read_b64_tr_b16 a[136:137], v14 offset:0
    v_mfma_f32_16x16x32_bf16 v[68:71], a[164:167], a[184:187], v[68:71]
    ds_read_b64_tr_b16 a[138:139], v14 offset:512
    s_add_u32 s51, s51, s30
    v_mfma_f32_16x16x32_bf16 v[76:79], a[164:167], a[188:191], v[76:79]
    s_add_u32 s52, s52, s31
    ds_read_b128 a[156:159], v42 offset:38912
    v_mfma_f32_16x16x32_bf16 v[80:83], a[168:171], a[176:179], v[80:83]
    ds_read_b64_tr_b16 a[140:141], v15 offset:0
    v_mfma_f32_16x16x32_bf16 v[88:91], a[168:171], a[180:183], v[88:91]
    ds_read_b64_tr_b16 a[142:143], v15 offset:512
    s_add_u32 m0, s49, 16384
    v_mfma_f32_16x16x32_bf16 v[96:99], a[168:171], a[184:187], v[96:99]
    buffer_load_dwordx4 v4, s[8:11], s51 offen offset:0 lds
    v_mfma_f32_16x16x32_bf16 v[104:107], a[168:171], a[188:191], v[104:107]
    v_mfma_f32_16x16x32_bf16 v[84:87], a[172:175], a[176:179], v[84:87]
    buffer_load_dwordx4 v5, s[8:11], s51 offen offset:1024 lds
    v_mfma_f32_16x16x32_bf16 v[92:95], a[172:175], a[180:183], v[92:95]
    buffer_load_dwordx4 v6, s[8:11], s51 offen offset:2048 lds
    v_mfma_f32_16x16x32_bf16 v[100:103], a[172:175], a[184:187], v[100:103]
    v_mfma_f32_16x16x32_bf16 v[108:111], a[172:175], a[188:191], v[108:111]
    buffer_load_dwordx4 v7, s[8:11], s51 offen offset:3072 lds
    s_waitcnt lgkmcnt(0)
    v_mfma_f32_16x16x32_bf16 v[48:51], a[128:131], a[144:147], v[48:51]
    ds_read_b128 a[176:179], v43 offset:4096
    ds_read_b64_tr_b16 a[160:161], v16 offset:0
    v_mfma_f32_16x16x32_bf16 v[56:59], a[128:131], a[148:151], v[56:59]
    ds_read_b64_tr_b16 a[162:163], v16 offset:512
    v_mfma_f32_16x16x32_bf16 v[64:67], a[128:131], a[152:155], v[64:67]
    ds_read_b128 a[180:183], v43 offset:6144
    ds_read_b64_tr_b16 a[164:165], v17 offset:0
    v_mfma_f32_16x16x32_bf16 v[72:75], a[128:131], a[156:159], v[72:75]
    ds_read_b64_tr_b16 a[166:167], v17 offset:512
    v_mfma_f32_16x16x32_bf16 v[52:55], a[132:135], a[144:147], v[52:55]
    ds_read_b128 a[184:187], v43 offset:36864
    ds_read_b64_tr_b16 a[168:169], v18 offset:0
    v_mfma_f32_16x16x32_bf16 v[60:63], a[132:135], a[148:151], v[60:63]
    ds_read_b64_tr_b16 a[170:171], v18 offset:512
    v_mfma_f32_16x16x32_bf16 v[68:71], a[132:135], a[152:155], v[68:71]
    ds_read_b128 a[188:191], v43 offset:38912
    ds_read_b64_tr_b16 a[172:173], v19 offset:0
    v_mfma_f32_16x16x32_bf16 v[76:79], a[132:135], a[156:159], v[76:79]
    ds_read_b64_tr_b16 a[174:175], v19 offset:512
    s_add_u32 m0, s49, 20480
    v_mfma_f32_16x16x32_bf16 v[80:83], a[136:139], a[144:147], v[80:83]
    v_mfma_f32_16x16x32_bf16 v[88:91], a[136:139], a[148:151], v[88:91]
    buffer_load_dwordx4 v8, s[12:15], s52 offen offset:0 lds
    v_mfma_f32_16x16x32_bf16 v[96:99], a[136:139], a[152:155], v[96:99]
    v_mfma_f32_16x16x32_bf16 v[104:107], a[136:139], a[156:159], v[104:107]
    buffer_load_dwordx4 v9, s[12:15], s52 offen offset:1024 lds
    v_mfma_f32_16x16x32_bf16 v[84:87], a[140:143], a[144:147], v[84:87]
    v_mfma_f32_16x16x32_bf16 v[92:95], a[140:143], a[148:151], v[92:95]
    buffer_load_dwordx4 v10, s[12:15], s52 offen offset:2048 lds
    v_mfma_f32_16x16x32_bf16 v[100:103], a[140:143], a[152:155], v[100:103]
    v_mfma_f32_16x16x32_bf16 v[108:111], a[140:143], a[156:159], v[108:111]
    buffer_load_dwordx4 v11, s[12:15], s52 offen offset:3072 lds
    s_sub_u32 s58, s58, 1
    s_cbranch_scc0 Q_t_3
    buffer_load_dword v2, v3, s[36:39], 0 offen sc1
    buffer_load_dword v31, v30, s[24:27], s56 offen sc1
    buffer_load_dword v31, v246, s[24:27], s64 offen sc1
Q_t_3:
    s_waitcnt vmcnt(8) lgkmcnt(0)
    s_barrier
    v_mfma_f32_16x16x32_bf16 v[48:51], a[160:163], a[176:179], v[48:51]
    ds_read_b128 a[144:147], v42 offset:12288
    ds_read_b64_tr_b16 a[128:129], v12 offset:8192
    v_mfma_f32_16x16x32_bf16 v[56:59], a[160:163], a[180:183], v[56:59]
    ds_read_b64_tr_b16 a[130:131], v12 offset:8704
    s_and_b32 s50, s68, 15
    v_mfma_f32_16x16x32_bf16 v[64:67], a[160:163], a[184:187], v[64:67]
    s_lshr_b64 s[68:69], s[68:69], 4
    ds_read_b128 a[148:151], v42 offset:14336
    v_mfma_f32_16x16x32_bf16 v[72:75], a[160:163], a[188:191], v[72:75]
    ds_read_b64_tr_b16 a[132:133], v13 offset:8192
    ds_read_b64_tr_b16 a[134:135], v13 offset:8704
    v_mfma_f32_16x16x32_bf16 v[52:55], a[164:167], a[176:179], v[52:55]
    s_lshl_b32 s51, s50, 19
    s_lshl_b32 s52, s50, 7
    v_mfma_f32_16x16x32_bf16 v[60:63], a[164:167], a[180:183], v[60:63]
    ds_read_b128 a[152:155], v42 offset:45056
    ds_read_b64_tr_b16 a[136:137], v14 offset:8192
    v_mfma_f32_16x16x32_bf16 v[68:71], a[164:167], a[184:187], v[68:71]
    ds_read_b64_tr_b16 a[138:139], v14 offset:8704
    s_add_u32 s51, s51, s30
    v_mfma_f32_16x16x32_bf16 v[76:79], a[164:167], a[188:191], v[76:79]
    s_add_u32 s52, s52, s31
    ds_read_b128 a[156:159], v42 offset:47104
    v_mfma_f32_16x16x32_bf16 v[80:83], a[168:171], a[176:179], v[80:83]
    ds_read_b64_tr_b16 a[140:141], v15 offset:8192
    v_mfma_f32_16x16x32_bf16 v[88:91], a[168:171], a[180:183], v[88:91]
    ds_read_b64_tr_b16 a[142:143], v15 offset:8704
    s_add_u32 m0, s49, 24576
    v_mfma_f32_16x16x32_bf16 v[96:99], a[168:171], a[184:187], v[96:99]
    buffer_load_dwordx4 v4, s[8:11], s51 offen offset:0 lds
    v_mfma_f32_16x16x32_bf16 v[104:107], a[168:171], a[188:191], v[104:107]
    v_mfma_f32_16x16x32_bf16 v[84:87], a[172:175], a[176:179], v[84:87]
    buffer_load_dwordx4 v5, s[8:11], s51 offen offset:1024 lds
    v_mfma_f32_16x16x32_bf16 v[92:95], a[172:175], a[180:183], v[92:95]
    buffer_load_dwordx4 v6, s[8:11], s51 offen offset:2048 lds
    v_mfma_f32_16x16x32_bf16 v[100:103], a[172:175], a[184:187], v[100:103]
    v_mfma_f32_16x16x32_bf16 v[108:111], a[172:175], a[188:191], v[108:111]
    buffer_load_dwordx4 v7, s[8:11], s51 offen offset:3072 lds
    s_waitcnt lgkmcnt(0)
    v_mfma_f32_16x16x32_bf16 v[48:51], a[128:131], a[144:147], v[48:51]
    ds_read_b128 a[176:179], v43 offset:12288
    ds_read_b64_tr_b16 a[160:161], v16 offset:8192
    v_mfma_f32_16x16x32_bf16 v[56:59], a[128:131], a[148:151], v[56:59]
    ds_read_b64_tr_b16 a[162:163], v16 offset:8704
    v_mfma_f32_16x16x32_bf16 v[64:67], a[128:131], a[152:155], v[64:67]
    ds_read_b128 a[180:183], v43 offset:14336
    ds_read_b64_tr_b16 a[164:165], v17 offset:8192
    v_mfma_f32_16x16x32_bf16 v[72:75], a[128:131], a[156:159], v[72:75]
    ds_read_b64_tr_b16 a[166:167], v17 offset:8704
    v_mfma_f32_16x16x32_bf16 v[52:55], a[132:135], a[144:147], v[52:55]
    ds_read_b128 a[184:187], v43 offset:45056
    ds_read_b64_tr_b16 a[168:169], v18 offset:8192
    v_mfma_f32_16x16x32_bf16 v[60:63], a[132:135], a[148:151], v[60:63]
    ds_read_b64_tr_b16 a[170:171], v18 offset:8704
    v_mfma_f32_16x16x32_bf16 v[68:71], a[132:135], a[152:155], v[68:71]
    ds_read_b128 a[188:191], v43 offset:47104
    ds_read_b64_tr_b16 a[172:173], v19 offset:8192
    v_mfma_f32_16x16x32_bf16 v[76:79], a[132:135], a[156:159], v[76:79]
    ds_read_b64_tr_b16 a[174:175], v19 offset:8704
    s_add_u32 m0, s49, 28672
    v_mfma_f32_16x16x32_bf16 v[80:83], a[136:139], a[144:147], v[80:83]
    v_mfma_f32_16x16x32_bf16 v[88:91], a[136:139], a[148:151], v[88:91]
    buffer_load_dwordx4 v8, s[12:15], s52 offen offset:0 lds
    v_mfma_f32_16x16x32_bf16 v[96:99], a[136:139], a[152:155], v[96:99]
    v_mfma_f32_16x16x32_bf16 v[104:107], a[136:139], a[156:159], v[104:107]
    buffer_load_dwordx4 v9, s[12:15], s52 offen offset:1024 lds
    v_mfma_f32_16x16x32_bf16 v[84:87], a[140:143], a[144:147], v[84:87]
    v_mfma_f32_16x16x32_bf16 v[92:95], a[140:143], a[148:151], v[92:95]
    buffer_load_dwordx4 v10, s[12:15], s52 offen offset:2048 lds
    v_mfma_f32_16x16x32_bf16 v[100:103], a[140:143], a[152:155], v[100:103]
    v_mfma_f32_16x16x32_bf16 v[108:111], a[140:143], a[156:159], v[108:111]
    buffer_load_dwordx4 v11, s[12:15], s52 offen offset:3072 lds
    s_sub_u32 s58, s58, 1
    s_cbranch_scc0 Q_t_4
    buffer_load_dword v2, v3, s[36:39], 0 offen sc1
    buffer_load_dword v31, v30, s[24:27], s56 offen sc1
    buffer_load_dword v31, v246, s[24:27], s64 offen sc1
Q_t_4:
    s_waitcnt vmcnt(8) lgkmcnt(0)
    s_barrier
    v_mfma_f32_16x16x32_bf16 v[48:51], a[160:163], a[176:179], v[48:51]
    ds_read_b128 a[144:147], v42 offset:20480
    ds_read_b64_tr_b16 a[128:129], v12 offset:16384
    v_mfma_f32_16x16x32_bf16 v[56:59], a[160:163], a[180:183], v[56:59]
    ds_read_b64_tr_b16 a[130:131], v12 offset:16896
    s_and_b32 s50, s68, 15
    v_mfma_f32_16x16x32_bf16 v[64:67], a[160:163], a[184:187], v[64:67]
    s_lshr_b64 s[68:69], s[68:69], 4
    ds_read_b128 a[148:151], v42 offset:22528
    v_mfma_f32_16x16x32_bf16 v[72:75], a[160:163], a[188:191], v[72:75]
    ds_read_b64_tr_b16 a[132:133], v13 offset:16384
    ds_read_b64_tr_b16 a[134:135], v13 offset:16896
    v_mfma_f32_16x16x32_bf16 v[52:55], a[164:167], a[176:179], v[52:55]
    s_lshl_b32 s51, s50, 19
    s_lshl_b32 s52, s50, 7
    v_mfma_f32_16x16x32_bf16 v[60:63], a[164:167], a[180:183], v[60:63]
    ds_read_b128 a[152:155], v42 offset:53248
    ds_read_b64_tr_b16 a[136:137], v14 offset:16384
    v_mfma_f32_16x16x32_bf16 v[68:71], a[164:167], a[184:187], v[68:71]
    ds_read_b64_tr_b16 a[138:139], v14 offset:16896
    s_add_u32 s51, s51, s30
    v_mfma_f32_16x16x32_bf16 v[76:79], a[164:167], a[188:191], v[76:79]
    s_add_u32 s52, s52, s31
    ds_read_b128 a[156:159], v42 offset:55296
    v_mfma_f32_16x16x32_bf16 v[80:83], a[168:171], a[176:179], v[80:83]
    ds_read_b64_tr_b16 a[140:141], v15 offset:16384
    v_mfma_f32_16x16x32_bf16 v[88:91], a[168:171], a[180:183], v[88:91]
    ds_read_b64_tr_b16 a[142:143], v15 offset:16896
    s_add_u32 m0, s49, 0
    v_mfma_f32_16x16x32_bf16 v[96:99], a[168:171], a[184:187], v[96:99]
    buffer_load_dwordx4 v4, s[8:11], s51 offen offset:0 lds
    v_mfma_f32_16x16x32_bf16 v[104:107], a[168:171], a[188:191], v[104:107]
    v_mfma_f32_16x16x32_bf16 v[84:87], a[172:175], a[176:179], v[84:87]
    buffer_load_dwordx4 v5, s[8:11], s51 offen offset:1024 lds
    v_mfma_f32_16x16x32_bf16 v[92:95], a[172:175], a[180:183], v[92:95]
    buffer_load_dwordx4 v6, s[8:11], s51 offen offset:2048 lds
    v_mfma_f32_16x16x32_bf16 v[100:103], a[172:175], a[184:187], v[100:103]
    v_mfma_f32_16x16x32_bf16 v[108:111], a[172:175], a[188:191], v[108:111]
    buffer_load_dwordx4 v7, s[8:11], s51 offen offset:3072 lds
    s_waitcnt lgkmcnt(0)
    v_mfma_f32_16x16x32_bf16 v[48:51], a[128:131], a[144:147], v[48:51]
    ds_read_b128 a[176:179], v43 offset:20480
    ds_read_b64_tr_b16 a[160:161], v16 offset:16384
    v_mfma_f32_16x16x32_bf16 v[56:59], a[128:131], a[148:151], v[56:59]
    ds_read_b64_tr_b16 a[162:163], v16 offset:16896
    v_mfma_f32_16x16x32_bf16 v[64:67], a[128:131], a[152:155], v[64:67]
    ds_read_b128 a[180:183], v43 offset:22528
    ds_read_b64_tr_b16 a[164:165], v17 offset:16384
    v_mfma_f32_16x16x32_bf16 v[72:75], a[128:131], a[156:159], v[72:75]
    ds_read_b64_tr_b16 a[166:167], v17 offset:16896
    v_mfma_f32_16x16x32_bf16 v[52:55], a[132:135], a[144:147], v[52:55]
    ds_read_b128 a[184:187], v43 offset:53248
    ds_read_b64_tr_b16 a[168:169], v18 offset:16384
    v_mfma_f32_16x16x32_bf16 v[60:63], a[132:135], a[148:151], v[60:63]
    ds_read_b64_tr_b16 a[170:171], v18 offset:16896
    v_mfma_f32_16x16x32_bf16 v[68:71], a[132:135], a[152:155], v[68:71]
    ds_read_b128 a[188:191], v43 offset:55296
    ds_read_b64_tr_b16 a[172:173], v19 offset:16384
    v_mfma_f32_16x16x32_bf16 v[76:79], a[132:135], a[156:159], v[76:79]
    ds_read_b64_tr_b16 a[174:175], v19 offset:16896
    s_add_u32 m0, s49, 4096
    v_mfma_f32_16x16x32_bf16 v[80:83], a[136:139], a[144:147], v[80:83]
    v_mfma_f32_16x16x32_bf16 v[88:91], a[136:139], a[148:151], v[88:91]
    buffer_load_dwordx4 v8, s[12:15], s52 offen offset:0 lds
    v_mfma_f32_16x16x32_bf16 v[96:99], a[136:139], a[152:155], v[96:99]
    v_mfma_f32_16x16x32_bf16 v[104:107], a[136:139], a[156:159], v[104:107]
    buffer_load_dwordx4 v9, s[12:15], s52 offen offset:1024 lds
    v_mfma_f32_16x16x32_bf16 v[84:87], a[140:143], a[144:147], v[84:87]
    v_mfma_f32_16x16x32_bf16 v[92:95], a[140:143], a[148:151], v[92:95]
    buffer_load_dwordx4 v10, s[12:15], s52 offen offset:2048 lds
    v_mfma_f32_16x16x32_bf16 v[100:103], a[140:143], a[152:155], v[100:103]
    v_mfma_f32_16x16x32_bf16 v[108:111], a[140:143], a[156:159], v[108:111]
    buffer_load_dwordx4 v11, s[12:15], s52 offen offset:3072 lds
    s_waitcnt vmcnt(8) lgkmcnt(0)
    s_barrier
    v_mfma_f32_16x16x32_bf16 v[48:51], a[160:163], a[176:179], v[48:51]
    ds_read_b128 a[144:147], v42 offset:28672
    ds_read_b64_tr_b16 a[128:129], v12 offset:24576
    v_mfma_f32_16x16x32_bf16 v[56:59], a[160:163], a[180:183], v[56:59]
    ds_read_b64_tr_b16 a[130:131], v12 offset:25088
    s_and_b32 s50, s68, 15
    v_mfma_f32_16x16x32_bf16 v[64:67], a[160:163], a[184:187], v[64:67]
    s_lshr_b64 s[68:69], s[68:69], 4
    ds_read_b128 a[148:151], v42 offset:30720
    v_mfma_f32_16x16x32_bf16 v[72:75], a[160:163], a[188:191], v[72:75]
    ds_read_b64_tr_b16 a[132:133], v13 offset:24576
    ds_read_b64_tr_b16 a[134:135], v13 offset:25088
    v_mfma_f32_16x16x32_bf16 v[52:55], a[164:167], a[176:179], v[52:55]
    s_lshl_b32 s51, s50, 19
    s_lshl_b32 s52, s50, 7
    v_mfma_f32_16x16x32_bf16 v[60:63], a[164:167], a[180:183], v[60:63]
    ds_read_b128 a[152:155], v42 offset:61440
    s_branch IP_sk2
IP_pg2:
    s_branch IP_ret1
IP_sk2:
    ds_read_b64_tr_b16 a[136:137], v14 offset:24576
    v_mfma_f32_16x16x32_bf16 v[68:71], a[164:167], a[184:187], v[68:71]
    ds_read_b64_tr_b16 a[138:139], v14 offset:25088
    s_add_u32 s51, s51, s30
    v_mfma_f32_16x16x32_bf16 v[76:79], a[164:167], a[188:191], v[76:79]
    s_add_u32 s52, s52, s31
    ds_read_b128 a[156:159], v42 offset:63488
    v_mfma_f32_16x16x32_bf16 v[80:83], a[168:171], a[176:179], v[80:83]
    ds_read_b64_tr_b16 a[140:141], v15 offset:24576
    v_mfma_f32_16x16x32_bf16 v[88:91], a[168:171], a[180:183], v[88:91]
    ds_read_b64_tr_b16 a[142:143], v15 offset:25088
    s_add_u32 m0, s49, 8192
    v_mfma_f32_16x16x32_bf16 v[96:99], a[168:171], a[184:187], v[96:99]
    buffer_load_dwordx4 v4, s[8:11], s51 offen offset:0 lds
    v_mfma_f32_16x16x32_bf16 v[104:107], a[168:171], a[188:191], v[104:107]
    v_mfma_f32_16x16x32_bf16 v[84:87], a[172:175], a[176:179], v[84:87]
    buffer_load_dwordx4 v5, s[8:11], s51 offen offset:1024 lds
    v_mfma_f32_16x16x32_bf16 v[92:95], a[172:175], a[180:183], v[92:95]
    buffer_load_dwordx4 v6, s[8:11], s51 offen offset:2048 lds
    v_mfma_f32_16x16x32_bf16 v[100:103], a[172:175], a[184:187], v[100:103]
    v_mfma_f32_16x16x32_bf16 v[108:111], a[172:175], a[188:191], v[108:111]
    buffer_load_dwordx4 v7, s[8:11], s51 offen offset:3072 lds
    s_waitcnt lgkmcnt(0)
    v_mfma_f32_16x16x32_bf16 v[48:51], a[128:131], a[144:147], v[48:51]
    ds_read_b128 a[176:179], v43 offset:28672
    ds_read_b64_tr_b16 a[160:161], v16 offset:24576
    v_mfma_f32_16x16x32_bf16 v[56:59], a[128:131], a[148:151], v[56:59]
    ds_read_b64_tr_b16 a[162:163], v16 offset:25088
    v_mfma_f32_16x16x32_bf16 v[64:67], a[128:131], a[152:155], v[64:67]
    ds_read_b128 a[180:183], v43 offset:30720
    ds_read_b64_tr_b16 a[164:165], v17 offset:24576
    v_mfma_f32_16x16x32_bf16 v[72:75], a[128:131], a[156:159], v[72:75]
    ds_read_b64_tr_b16 a[166:167], v17 offset:25088
    v_mfma_f32_16x16x32_bf16 v[52:55], a[132:135], a[144:147], v[52:55]
    ds_read_b128 a[184:187], v43 offset:61440
    ds_read_b64_tr_b16 a[168:169], v18 offset:24576
    v_mfma_f32_16x16x32_bf16 v[60:63], a[132:135], a[148:151], v[60:63]
    ds_read_b64_tr_b16 a[170:171], v18 offset:25088
    v_mfma_f32_16x16x32_bf16 v[68:71], a[132:135], a[152:155], v[68:71]
    ds_read_b128 a[188:191], v43 offset:63488
    ds_read_b64_tr_b16 a[172:173], v19 offset:24576
    v_mfma_f32_16x16x32_bf16 v[76:79], a[132:135], a[156:159], v[76:79]
    ds_read_b64_tr_b16 a[174:175], v19 offset:25088
    s_add_u32 m0, s49, 12288
    v_mfma_f32_16x16x32_bf16 v[80:83], a[136:139], a[144:147], v[80:83]
    v_mfma_f32_16x16x32_bf16 v[88:91], a[136:139], a[148:151], v[88:91]
    buffer_load_dwordx4 v8, s[12:15], s52 offen offset:0 lds
    v_mfma_f32_16x16x32_bf16 v[96:99], a[136:139], a[152:155], v[96:99]
    v_mfma_f32_16x16x32_bf16 v[104:107], a[136:139], a[156:159], v[104:107]
    buffer_load_dwordx4 v9, s[12:15], s52 offen offset:1024 lds
    v_mfma_f32_16x16x32_bf16 v[84:87], a[140:143], a[144:147], v[84:87]
    v_mfma_f32_16x16x32_bf16 v[92:95], a[140:143], a[148:151], v[92:95]
    buffer_load_dwordx4 v10, s[12:15], s52 offen offset:2048 lds
    v_mfma_f32_16x16x32_bf16 v[100:103], a[140:143], a[152:155], v[100:103]
    v_mfma_f32_16x16x32_bf16 v[108:111], a[140:143], a[156:159], v[108:111]
    buffer_load_dwordx4 v11, s[12:15], s52 offen offset:3072 lds
    s_waitcnt vmcnt(8) lgkmcnt(0)
    s_barrier
    v_mfma_f32_16x16x32_bf16 v[48:51], a[160:163], a[176:179], v[48:51]
    ds_read_b128 a[144:147], v42 offset:4096
    ds_read_b64_tr_b16 a[128:129], v12 offset:0
    v_mfma_f32_16x16x32_bf16 v[56:59], a[160:163], a[180:183], v[56:59]
    ds_read_b64_tr_b16 a[130:131], v12 offset:512
    s_and_b32 s50, s68, 15
    v_mfma_f32_16x16x32_bf16 v[64:67], a[160:163], a[184:187], v[64:67]
    s_lshr_b64 s[68:69], s[68:69], 4
    ds_read_b128 a[148:151], v42 offset:6144
    v_mfma_f32_16x16x32_bf16 v[72:75], a[160:163], a[188:191], v[72:75]
    ds_read_b64_tr_b16 a[132:133], v13 offset:0
    ds_read_b64_tr_b16 a[134:135], v13 offset:512
    v_mfma_f32_16x16x32_bf16 v[52:55], a[164:167], a[176:179], v[52:55]
    s_lshl_b32 s51, s50, 19
    s_lshl_b32 s52, s50, 7
    v_mfma_f32_16x16x32_bf16 v[60:63], a[164:167], a[180:183], v[60:63]
    ds_read_b128 a[152:155], v42 offset:36864
    ds_read_b64_tr_b16 a[136:137], v14 offset:0
    v_mfma_f32_16x16x32_bf16 v[68:71], a[164:167], a[184:187], v[68:71]
    ds_read_b64_tr_b16 a[138:139], v14 offset:512
    s_add_u32 s51, s51, s30
    v_mfma_f32_16x16x32_bf16 v[76:79], a[164:167], a[188:191], v[76:79]
    s_add_u32 s52, s52, s31
    ds_read_b128 a[156:159], v42 offset:38912
    v_mfma_f32_16x16x32_bf16 v[80:83], a[168:171], a[176:179], v[80:83]
    ds_read_b64_tr_b16 a[140:141], v15 offset:0
    v_mfma_f32_16x16x32_bf16 v[88:91], a[168:171], a[180:183], v[88:91]
    ds_read_b64_tr_b16 a[142:143], v15 offset:512
    s_add_u32 m0, s49, 16384
    v_mfma_f32_16x16x32_bf16 v[96:99], a[168:171], a[184:187], v[96:99]
    buffer_load_dwordx4 v4, s[8:11], s51 offen offset:0 lds
    v_mfma_f32_16x16x32_bf16 v[104:107], a[168:171], a[188:191], v[104:107]
    v_mfma_f32_16x16x32_bf16 v[84:87], a[172:175], a[176:179], v[84:87]
    buffer_load_dwordx4 v5, s[8:11], s51 offen offset:1024 lds
    v_mfma_f32_16x16x32_bf16 v[92:95], a[172:175], a[180:183], v[92:95]
    buffer_load_dwordx4 v6, s[8:11], s51 offen offset:2048 lds
    v_mfma_f32_16x16x32_bf16 v[100:103], a[172:175], a[184:187], v[100:103]
    v_mfma_f32_16x16x32_bf16 v[108:111], a[172:175], a[188:191], v[108:111]
    buffer_load_dwordx4 v7, s[8:11], s51 offen offset:3072 lds
    s_waitcnt lgkmcnt(0)
    v_mfma_f32_16x16x32_bf16 v[48:51], a[128:131], a[144:147], v[48:51]
    ds_read_b128 a[176:179], v43 offset:4096
    ds_read_b64_tr_b16 a[160:161], v16 offset:0
    v_mfma_f32_16x16x32_bf16 v[56:59], a[128:131], a[148:151], v[56:59]
    ds_read_b64_tr_b16 a[162:163], v16 offset:512
    v_mfma_f32_16x16x32_bf16 v[64:67], a[128:131], a[152:155], v[64:67]
    ds_read_b128 a[180:183], v43 offset:6144
    ds_read_b64_tr_b16 a[164:165], v17 offset:0
    v_mfma_f32_16x16x32_bf16 v[72:75], a[128:131], a[156:159], v[72:75]
    ds_read_b64_tr_b16 a[166:167], v17 offset:512
    v_mfma_f32_16x16x32_bf16 v[52:55], a[132:135], a[144:147], v[52:55]
    ds_read_b128 a[184:187], v43 offset:36864
    ds_read_b64_tr_b16 a[168:169], v18 offset:0
    v_mfma_f32_16x16x32_bf16 v[60:63], a[132:135], a[148:151], v[60:63]
    ds_read_b64_tr_b16 a[170:171], v18 offset:512
    v_mfma_f32_16x16x32_bf16 v[68:71], a[132:135], a[152:155], v[68:71]
    ds_read_b128 a[188:191], v43 offset:38912
    ds_read_b64_tr_b16 a[172:173], v19 offset:0
    v_mfma_f32_16x16x32_bf16 v[76:79], a[132:135], a[156:159], v[76:79]
    ds_read_b64_tr_b16 a[174:175], v19 offset:512
    s_add_u32 m0, s49, 20480
    v_mfma_f32_16x16x32_bf16 v[80:83], a[136:139], a[144:147], v[80:83]
    v_mfma_f32_16x16x32_bf16 v[88:91], a[136:139], a[148:151], v[88:91]
    buffer_load_dwordx4 v8, s[12:15], s52 offen offset:0 lds
    v_mfma_f32_16x16x32_bf16 v[96:99], a[136:139], a[152:155], v[96:99]
    v_mfma_f32_16x16x32_bf16 v[104:107], a[136:139], a[156:159], v[104:107]
    buffer_load_dwordx4 v9, s[12:15], s52 offen offset:1024 lds
    v_mfma_f32_16x16x32_bf16 v[84:87], a[140:143], a[144:147], v[84:87]
    v_mfma_f32_16x16x32_bf16 v[92:95], a[140:143], a[148:151], v[92:95]
    buffer_load_dwordx4 v10, s[12:15], s52 offen offset:2048 lds
    v_mfma_f32_16x16x32_bf16 v[100:103], a[140:143], a[152:155], v[100:103]
    v_mfma_f32_16x16x32_bf16 v[108:111], a[140:143], a[156:159], v[108:111]
    buffer_load_dwordx4 v11, s[12:15], s52 offen offset:3072 lds
    s_waitcnt vmcnt(8) lgkmcnt(0)
    s_barrier
    v_mfma_f32_16x16x32_bf16 v[48:51], a[160:163], a[176:179], v[48:51]
    ds_read_b128 a[144:147], v42 offset:12288
    ds_read_b64_tr_b16 a[128:129], v12 offset:8192
    v_mfma_f32_16x16x32_bf16 v[56:59], a[160:163], a[180:183], v[56:59]
    ds_read_b64_tr_b16 a[130:131], v12 offset:8704
    s_and_b32 s50, s68, 15
    v_mfma_f32_16x16x32_bf16 v[64:67], a[160:163], a[184:187], v[64:67]
    s_lshr_b64 s[68:69], s[68:69], 4
    ds_read_b128 a[148:151], v42 offset:14336
    v_mfma_f32_16x16x32_bf16 v[72:75], a[160:163], a[188:191], v[72:75]
    ds_read_b64_tr_b16 a[132:133], v13 offset:8192
    ds_read_b64_tr_b16 a[134:135], v13 offset:8704
    v_mfma_f32_16x16x32_bf16 v[52:55], a[164:167], a[176:179], v[52:55]
    s_lshl_b32 s51, s50, 19
    s_lshl_b32 s52, s50, 7
    v_mfma_f32_16x16x32_bf16 v[60:63], a[164:167], a[180:183], v[60:63]
    ds_read_b128 a[152:155], v42 offset:45056
    ds_read_b64_tr_b16 a[136:137], v14 offset:8192
    v_mfma_f32_16x16x32_bf16 v[68:71], a[164:167], a[184:187], v[68:71]
    ds_read_b64_tr_b16 a[138:139], v14 offset:8704
    s_add_u32 s51, s51, s30
    v_mfma_f32_16x16x32_bf16 v[76:79], a[164:167], a[188:191], v[76:79]
    s_add_u32 s52, s52, s31
    ds_read_b128 a[156:159], v42 offset:47104
    v_mfma_f32_16x16x32_bf16 v[80:83], a[168:171], a[176:179], v[80:83]
    ds_read_b64_tr_b16 a[140:141], v15 offset:8192
    v_mfma_f32_16x16x32_bf16 v[88:91], a[168:171], a[180:183], v[88:91]
    ds_read_b64_tr_b16 a[142:143], v15 offset:8704
    s_add_u32 m0, s49, 24576
    v_mfma_f32_16x16x32_bf16 v[96:99], a[168:171], a[184:187], v[96:99]
    buffer_load_dwordx4 v4, s[8:11], s51 offen offset:0 lds
    v_mfma_f32_16x16x32_bf16 v[104:107], a[168:171], a[188:191], v[104:107]
    v_mfma_f32_16x16x32_bf16 v[84:87], a[172:175], a[176:179], v[84:87]
    buffer_load_dwordx4 v5, s[8:11], s51 offen offset:1024 lds
    v_mfma_f32_16x16x32_bf16 v[92:95], a[172:175], a[180:183], v[92:95]
    buffer_load_dwordx4 v6, s[8:11], s51 offen offset:2048 lds
    v_mfma_f32_16x16x32_bf16 v[100:103], a[172:175], a[184:187], v[100:103]
    v_mfma_f32_16x16x32_bf16 v[108:111], a[172:175], a[188:191], v[108:111]
    buffer_load_dwordx4 v7, s[8:11], s51 offen offset:3072 lds
    s_mov_b32 s58, 0x40000
M_rdy:
    v_cmp_le_u32 vcc, 8, v2
    s_lshl_b32 s4, s93, 1
    s_and_b32 s3, vcc_lo, vcc_hi
    s_and_b32 s3, s3, 0xaaaaaaaa
    s_cmp_eq_u32 s3, 0xaaaaaaaa
    s_cbranch_scc0 M_rdy2
M_rdy3:
    v_readlane_b32 s3, v2, s4
    s_add_u32 s4, s4, 1
    s_lshl_b32 s63, 8, s92
    v_readlane_b32 s4, v2, s4
    s_xor_b32 s63, s63, s3
    s_xor_b32 s4, s4, 8
    s_or_b32 s63, s63, s4
    s_waitcnt lgkmcnt(0)
    v_mfma_f32_16x16x32_bf16 v[48:51], a[128:131], a[144:147], v[48:51]
    ds_read_b128 a[176:179], v43 offset:12288
    ds_read_b64_tr_b16 a[160:161], v16 offset:8192
    v_mfma_f32_16x16x32_bf16 v[56:59], a[128:131], a[148:151], v[56:59]
    ds_read_b64_tr_b16 a[162:163], v16 offset:8704
    v_mfma_f32_16x16x32_bf16 v[64:67], a[128:131], a[152:155], v[64:67]
    ds_read_b128 a[180:183], v43 offset:14336
    ds_read_b64_tr_b16 a[164:165], v17 offset:8192
    v_mfma_f32_16x16x32_bf16 v[72:75], a[128:131], a[156:159], v[72:75]
    ds_read_b64_tr_b16 a[166:167], v17 offset:8704
    v_mfma_f32_16x16x32_bf16 v[52:55], a[132:135], a[144:147], v[52:55]
    ds_read_b128 a[184:187], v43 offset:45056
    ds_read_b64_tr_b16 a[168:169], v18 offset:8192
    v_mfma_f32_16x16x32_bf16 v[60:63], a[132:135], a[148:151], v[60:63]
    ds_read_b64_tr_b16 a[170:171], v18 offset:8704
    v_mfma_f32_16x16x32_bf16 v[68:71], a[132:135], a[152:155], v[68:71]
    ds_read_b128 a[188:191], v43 offset:47104
    ds_read_b64_tr_b16 a[172:173], v19 offset:8192
    v_mfma_f32_16x16x32_bf16 v[76:79], a[132:135], a[156:159], v[76:79]
    ds_read_b64_tr_b16 a[174:175], v19 offset:8704
    s_add_u32 m0, s49, 28672
    v_mfma_f32_16x16x32_bf16 v[80:83], a[136:139], a[144:147], v[80:83]
    v_mfma_f32_16x16x32_bf16 v[88:91], a[136:139], a[148:151], v[88:91]
    buffer_load_dwordx4 v8, s[12:15], s52 offen offset:0 lds
    v_mfma_f32_16x16x32_bf16 v[96:99], a[136:139], a[152:155], v[96:99]
    v_mfma_f32_16x16x32_bf16 v[104:107], a[136:139], a[156:159], v[104:107]
    buffer_load_dwordx4 v9, s[12:15], s52 offen offset:1024 lds
    v_mfma_f32_16x16x32_bf16 v[84:87], a[140:143], a[144:147], v[84:87]
    v_mfma_f32_16x16x32_bf16 v[92:95], a[140:143], a[148:151], v[92:95]
    buffer_load_dwordx4 v10, s[12:15], s52 offen offset:2048 lds
    v_mfma_f32_16x16x32_bf16 v[100:103], a[140:143], a[152:155], v[100:103]
    v_mfma_f32_16x16x32_bf16 v[108:111], a[140:143], a[156:159], v[108:111]
    buffer_load_dwordx4 v11, s[12:15], s52 offen offset:3072 lds
    s_waitcnt vmcnt(8) lgkmcnt(0)
    s_barrier
    v_mfma_f32_16x16x32_bf16 v[48:51], a[160:163], a[176:179], v[48:51]
    ds_read_b128 a[144:147], v42 offset:20480
    ds_read_b64_tr_b16 a[128:129], v12 offset:16384
    v_mfma_f32_16x16x32_bf16 v[56:59], a[160:163], a[180:183], v[56:59]
    ds_read_b64_tr_b16 a[130:131], v12 offset:16896
    v_mfma_f32_16x16x32_bf16 v[64:67], a[160:163], a[184:187], v[64:67]
    ds_read_b128 a[148:151], v42 offset:22528
    ds_read_b64_tr_b16 a[132:133], v13 offset:16384
    v_mfma_f32_16x16x32_bf16 v[72:75], a[160:163], a[188:191], v[72:75]
    ds_read_b64_tr_b16 a[134:135], v13 offset:16896
    ds_read_b128 a[152:155], v42 offset:53248
    v_mfma_f32_16x16x32_bf16 v[52:55], a[164:167], a[176:179], v[52:55]
    ds_read_b64_tr_b16 a[136:137], v14 offset:16384
    v_mfma_f32_16x16x32_bf16 v[60:63], a[164:167], a[180:183], v[60:63]
    ds_read_b64_tr_b16 a[138:139], v14 offset:16896
    s_xor_b32 s48, s46, 0
    v_mfma_f32_16x16x32_bf16 v[68:71], a[164:167], a[184:187], v[68:71]
    s_add_u32 m0, s49, 0
    v_mfma_f32_16x16x32_bf16 v[76:79], a[164:167], a[188:191], v[76:79]
    ds_read_b128 a[156:159], v42 offset:55296
    ds_read_b64_tr_b16 a[140:141], v15 offset:16384
    v_mfma_f32_16x16x32_bf16 v[80:83], a[168:171], a[176:179], v[80:83]
    ds_read_b64_tr_b16 a[142:143], v15 offset:16896
    v_mfma_f32_16x16x32_bf16 v[88:91], a[168:171], a[180:183], v[88:91]
    buffer_load_dwordx4 v20, s[16:19], s48 offen offset:0 lds
    v_mfma_f32_16x16x32_bf16 v[96:99], a[168:171], a[184:187], v[96:99]
    v_mfma_f32_16x16x32_bf16 v[104:107], a[168:171], a[188:191], v[104:107]
    buffer_load_dwordx4 v21, s[16:19], s48 offen offset:1024 lds
    v_mfma_f32_16x16x32_bf16 v[84:87], a[172:175], a[176:179], v[84:87]
    v_mfma_f32_16x16x32_bf16 v[92:95], a[172:175], a[180:183], v[92:95]
    buffer_load_dwordx4 v22, s[16:19], s48 offen offset:2048 lds
    v_mfma_f32_16x16x32_bf16 v[100:103], a[172:175], a[184:187], v[100:103]
    v_mfma_f32_16x16x32_bf16 v[108:111], a[172:175], a[188:191], v[108:111]
    buffer_load_dwordx4 v23, s[16:19], s48 offen offset:3072 lds
    s_waitcnt lgkmcnt(0)
    v_mfma_f32_16x16x32_bf16 v[48:51], a[128:131], a[144:147], v[48:51]
    ds_read_b128 a[176:179], v43 offset:20480
    ds_read_b64_tr_b16 a[160:161], v16 offset:16384
    ds_read_b64_tr_b16 a[162:163], v16 offset:16896
    v_and_b32 v36, 15, v1
    v_mfma_f32_16x16x32_bf16 v[56:59], a[128:131], a[148:151], v[56:59]
    v_lshrrev_b32 v37, 4, v1
    v_xor_b32 v37, v36, v37
    v_lshlrev_b32 v37, 4, v37
    v_mfma_f32_16x16x32_bf16 v[64:67], a[128:131], a[152:155], v[64:67]
    ds_read_b128 a[180:183], v43 offset:22528
    ds_read_b64_tr_b16 a[164:165], v17 offset:16384
    ds_read_b64_tr_b16 a[166:167], v17 offset:16896
    v_lshl_add_u32 v37, v36, 8, v37
    v_mfma_f32_16x16x32_bf16 v[72:75], a[128:131], a[156:159], v[72:75]
    v_add_u32 v4, s62, v37
    v_xor_b32 v5, 64, v4
    v_xor_b32 v6, 128, v4
    v_mfma_f32_16x16x32_bf16 v[52:55], a[132:135], a[144:147], v[52:55]
    ds_read_b128 a[184:187], v43 offset:53248
    ds_read_b64_tr_b16 a[168:169], v18 offset:16384
    ds_read_b64_tr_b16 a[170:171], v18 offset:16896
    s_xor_b32 s48, s46, 8192
    v_mfma_f32_16x16x32_bf16 v[60:63], a[132:135], a[148:151], v[60:63]
    s_add_u32 m0, s49, 4096
    v_xor_b32 v7, 192, v4
    v_xor_b32 v8, 128, v26
    v_mfma_f32_16x16x32_bf16 v[68:71], a[132:135], a[152:155], v[68:71]
    v_xor_b32 v9, 160, v26
    v_xor_b32 v10, 192, v26
    ds_read_b128 a[188:191], v43 offset:55296
    ds_read_b64_tr_b16 a[172:173], v19 offset:16384
    v_mfma_f32_16x16x32_bf16 v[76:79], a[132:135], a[156:159], v[76:79]
    ds_read_b64_tr_b16 a[174:175], v19 offset:16896
    v_xor_b32 v11, 224, v26
    s_mov_b32 s3, 0x3e0293ee
    v_mfma_f32_16x16x32_bf16 v[80:83], a[136:139], a[144:147], v[80:83]
    v_mov_b32 v34, s3
    buffer_load_dwordx4 v20, s[16:19], s48 offen offset:0 lds
    v_mfma_f32_16x16x32_bf16 v[88:91], a[136:139], a[148:151], v[88:91]
    v_mov_b32 v35, s3
    s_lshl_b32 s3, s29, 22
    s_lshl_b32 s4, s28, 20
    v_mfma_f32_16x16x32_bf16 v[96:99], a[136:139], a[152:155], v[96:99]
    s_add_u32 s3, s3, s4
    buffer_load_dwordx4 v21, s[16:19], s48 offen offset:1024 lds
    v_mfma_f32_16x16x32_bf16 v[104:107], a[136:139], a[156:159], v[104:107]
    s_lshl_b32 s4, s62, 3
    s_add_u32 s3, s3, s4
    s_lshl_b32 s4, s6, 16
    v_mfma_f32_16x16x32_bf16 v[84:87], a[140:143], a[144:147], v[84:87]
    s_add_u32 s3, s3, s4
    buffer_load_dwordx4 v22, s[16:19], s48 offen offset:2048 lds
    v_mfma_f32_16x16x32_bf16 v[92:95], a[140:143], a[148:151], v[92:95]
    s_lshl_b32 s4, s7, 13
    s_add_u32 s3, s3, s4
    s_and_b32 s4, s5, 1
    v_mfma_f32_16x16x32_bf16 v[100:103], a[140:143], a[152:155], v[100:103]
    s_lshl_b32 s4, s4, 12
    buffer_load_dwordx4 v23, s[16:19], s48 offen offset:3072 lds
    v_mfma_f32_16x16x32_bf16 v[108:111], a[140:143], a[156:159], v[108:111]
    s_add_u32 s3, s3, s4
    s_add_u32 s68, s3, 0
    s_add_u32 s69, s68, 262144
    s_waitcnt vmcnt(8) lgkmcnt(0)
    s_barrier
    v_mfma_f32_16x16x32_bf16 v[48:51], a[160:163], a[176:179], v[48:51]
    ds_read_b64_tr_b16 a[64:65], v12 offset:24576
    ds_read_b64_tr_b16 a[66:67], v12 offset:25088
    v_mfma_f32_16x16x32_bf16 v[56:59], a[160:163], a[180:183], v[56:59]
    ds_read_b128 a[80:83], v42 offset:28672
    v_mfma_f32_16x16x32_bf16 v[64:67], a[160:163], a[184:187], v[64:67]
    ds_read_b128 a[84:87], v42 offset:30720
    ds_read_b64_tr_b16 a[68:69], v13 offset:24576
    v_mfma_f32_16x16x32_bf16 v[72:75], a[160:163], a[188:191], v[72:75]
    ds_read_b64_tr_b16 a[70:71], v13 offset:25088
    ds_read_b64_tr_b16 a[96:97], v16 offset:24576
    v_mfma_f32_16x16x32_bf16 v[52:55], a[164:167], a[176:179], v[52:55]
    ds_read_b64_tr_b16 a[98:99], v16 offset:25088
    v_mfma_f32_16x16x32_bf16 v[60:63], a[164:167], a[180:183], v[60:63]
    ds_read_b128 a[112:115], v43 offset:28672
    s_xor_b32 s48, s46, 0
    v_mfma_f32_16x16x32_bf16 v[68:71], a[164:167], a[184:187], v[68:71]
    s_add_u32 m0, s49, 8192
    v_mfma_f32_16x16x32_bf16 v[76:79], a[164:167], a[188:191], v[76:79]
    ds_read_b128 a[116:119], v43 offset:30720
    ds_read_b64_tr_b16 a[100:101], v17 offset:24576
    v_mfma_f32_16x16x32_bf16 v[80:83], a[168:171], a[176:179], v[80:83]
    ds_read_b64_tr_b16 a[102:103], v17 offset:25088
    v_mfma_f32_16x16x32_bf16 v[88:91], a[168:171], a[180:183], v[88:91]
    buffer_load_dwordx4 v24, s[20:23], s48 offen offset:0 lds
    v_mfma_f32_16x16x32_bf16 v[96:99], a[168:171], a[184:187], v[96:99]
    v_mfma_f32_16x16x32_bf16 v[104:107], a[168:171], a[188:191], v[104:107]
    buffer_load_dwordx4 v25, s[20:23], s48 offen offset:1024 lds
    v_mfma_f32_16x16x32_bf16 v[84:87], a[172:175], a[176:179], v[84:87]
    v_mfma_f32_16x16x32_bf16 v[92:95], a[172:175], a[180:183], v[92:95]
    buffer_load_dwordx4 v24, s[20:23], s48 offen offset:2048 lds
    v_mfma_f32_16x16x32_bf16 v[100:103], a[172:175], a[184:187], v[100:103]
    v_mfma_f32_16x16x32_bf16 v[108:111], a[172:175], a[188:191], v[108:111]
    buffer_load_dwordx4 v25, s[20:23], s48 offen offset:3072 lds
    s_cmp_lg_u32 s63, 0
    s_waitcnt lgkmcnt(0)
    v_mfma_f32_16x16x32_bf16 v[48:51], a[64:67], a[80:83], v[48:51]
    ds_read_b128 a[88:91], v42 offset:61440
    ds_read_b128 a[92:95], v42 offset:63488
    v_mfma_f32_16x16x32_bf16 v[56:59], a[64:67], a[84:87], v[56:59]
    ds_read_b128 a[120:123], v43 offset:61440
    ds_read_b128 a[124:127], v43 offset:63488
    v_mfma_f32_16x16x32_bf16 v[60:63], a[68:71], a[84:87], v[60:63]
    ds_read_b64_tr_b16 a[72:73], v14 offset:24576
    ds_read_b64_tr_b16 a[74:75], v14 offset:25088
    v_mfma_f32_16x16x32_bf16 v[52:55], a[68:71], a[80:83], v[52:55]
    ds_read_b64_tr_b16 a[76:77], v15 offset:24576
    ds_read_b64_tr_b16 a[78:79], v15 offset:25088
    v_mfma_f32_16x16x32_bf16 v[48:51], a[96:99], a[112:115], v[48:51]
    ds_read_b64_tr_b16 a[104:105], v18 offset:24576
    ds_read_b64_tr_b16 a[106:107], v18 offset:25088
    v_mfma_f32_16x16x32_bf16 v[56:59], a[96:99], a[116:119], v[56:59]
    ds_read_b64_tr_b16 a[108:109], v19 offset:24576
    ds_read_b64_tr_b16 a[110:111], v19 offset:25088
    v_mfma_f32_16x16x32_bf16 v[60:63], a[100:103], a[116:119], v[60:63]
    v_mfma_f32_16x16x32_bf16 v[52:55], a[100:103], a[112:115], v[52:55]
    s_nop 0
    s_waitcnt lgkmcnt(11)
    v_mfma_f32_16x16x32_bf16 v[64:67], a[64:67], a[88:91], v[64:67]
    s_nop 0
    s_waitcnt lgkmcnt(10)
    v_mfma_f32_16x16x32_bf16 v[72:75], a[64:67], a[92:95], v[72:75]
    s_nop 0
    v_mfma_f32_16x16x32_bf16 v[76:79], a[68:71], a[92:95], v[76:79]
    v_pk_mul_f32 v[48:49], v[48:49], v[34:35]
    v_pk_mul_f32 v[50:51], v[50:51], v[34:35]
    v_mfma_f32_16x16x32_bf16 v[68:71], a[68:71], a[88:91], v[68:71]
    v_pk_mul_f32 v[52:53], v[52:53], v[34:35]
    v_pk_mul_f32 v[54:55], v[54:55], v[34:35]
    s_waitcnt lgkmcnt(9)
    v_mfma_f32_16x16x32_bf16 v[64:67], a[96:99], a[120:123], v[64:67]
    v_cvt_pk_bf16_f32 v144, v48, v49
    v_cvt_pk_bf16_f32 v145, v50, v51
    s_waitcnt lgkmcnt(8)
    v_mfma_f32_16x16x32_bf16 v[72:75], a[96:99], a[124:127], v[72:75]
    v_cvt_pk_bf16_f32 v146, v52, v53
    v_cvt_pk_bf16_f32 v147, v54, v55
    v_mfma_f32_16x16x32_bf16 v[76:79], a[100:103], a[124:127], v[76:79]
    v_pk_mul_f32 v[56:57], v[56:57], v[34:35]
    v_pk_mul_f32 v[58:59], v[58:59], v[34:35]
    v_mfma_f32_16x16x32_bf16 v[68:71], a[100:103], a[120:123], v[68:71]
    v_pk_mul_f32 v[60:61], v[60:61], v[34:35]
    v_pk_mul_f32 v[62:63], v[62:63], v[34:35]
    s_waitcnt lgkmcnt(6)
    v_mfma_f32_16x16x32_bf16 v[96:99], a[72:75], a[88:91], v[96:99]
    v_cvt_pk_bf16_f32 v148, v56, v57
    v_cvt_pk_bf16_f32 v149, v58, v59
    v_mfma_f32_16x16x32_bf16 v[104:107], a[72:75], a[92:95], v[104:107]
    v_cvt_pk_bf16_f32 v150, v60, v61
    v_cvt_pk_bf16_f32 v151, v62, v63
    s_waitcnt lgkmcnt(4)
    v_mfma_f32_16x16x32_bf16 v[108:111], a[76:79], a[92:95], v[108:111]
    v_permlane16_swap_b32 v144, v146
    v_permlane16_swap_b32 v145, v147
    v_mfma_f32_16x16x32_bf16 v[100:103], a[76:79], a[88:91], v[100:103]
    s_cbranch_scc1 M_s_5
    buffer_store_dwordx4 v[144:147], v44, s[24:27], s68 offen offset:0
M_t_6:
    s_nop 0
    s_waitcnt lgkmcnt(2)
    v_mfma_f32_16x16x32_bf16 v[96:99], a[104:107], a[120:123], v[96:99]
    v_permlane16_swap_b32 v148, v150
    v_permlane16_swap_b32 v149, v151
    v_mfma_f32_16x16x32_bf16 v[104:107], a[104:107], a[124:127], v[104:107]
    s_cbranch_scc1 M_s_7
    buffer_store_dwordx4 v[148:151], v44, s[24:27], s68 offen offset:256
M_t_8:
    v_pk_mul_f32 v[64:65], v[64:65], v[34:35]
    s_waitcnt lgkmcnt(0)
    v_mfma_f32_16x16x32_bf16 v[108:111], a[108:111], a[124:127], v[108:111]
    v_pk_mul_f32 v[66:67], v[66:67], v[34:35]
    v_pk_mul_f32 v[68:69], v[68:69], v[34:35]
    v_mfma_f32_16x16x32_bf16 v[100:103], a[108:111], a[120:123], v[100:103]
    v_pk_mul_f32 v[70:71], v[70:71], v[34:35]
    v_cvt_pk_bf16_f32 v152, v64, v65
    v_mfma_f32_16x16x32_bf16 v[80:83], a[72:75], a[80:83], v[80:83]
    v_cvt_pk_bf16_f32 v153, v66, v67
    v_cvt_pk_bf16_f32 v154, v68, v69
    v_mfma_f32_16x16x32_bf16 v[88:91], a[72:75], a[84:87], v[88:91]
    v_cvt_pk_bf16_f32 v155, v70, v71
    v_pk_mul_f32 v[72:73], v[72:73], v[34:35]
    v_mfma_f32_16x16x32_bf16 v[92:95], a[76:79], a[84:87], v[92:95]
    v_pk_mul_f32 v[74:75], v[74:75], v[34:35]
    v_pk_mul_f32 v[76:77], v[76:77], v[34:35]
    v_mfma_f32_16x16x32_bf16 v[84:87], a[76:79], a[80:83], v[84:87]
    v_pk_mul_f32 v[78:79], v[78:79], v[34:35]
    v_cvt_pk_bf16_f32 v156, v72, v73
    v_mfma_f32_16x16x32_bf16 v[80:83], a[104:107], a[112:115], v[80:83]
    v_cvt_pk_bf16_f32 v157, v74, v75
    v_cvt_pk_bf16_f32 v158, v76, v77
    v_mfma_f32_16x16x32_bf16 v[88:91], a[104:107], a[116:119], v[88:91]
    v_cvt_pk_bf16_f32 v159, v78, v79
    v_permlane16_swap_b32 v152, v154
    v_mfma_f32_16x16x32_bf16 v[92:95], a[108:111], a[116:119], v[92:95]
    v_permlane16_swap_b32 v153, v155
    s_cbranch_scc1 M_s_9
    buffer_store_dwordx4 v[152:155], v44, s[24:27], s69 offen offset:0
M_t_10:
    v_mfma_f32_16x16x32_bf16 v[84:87], a[108:111], a[112:115], v[84:87]
    s_nop 0
    v_permlane16_swap_b32 v156, v158
    v_permlane16_swap_b32 v157, v159
    s_cbranch_scc1 M_s_11
    buffer_store_dwordx4 v[156:159], v44, s[24:27], s69 offen offset:256
M_t_12:
    v_pk_mul_f32 v[96:97], v[96:97], v[34:35]
    v_pk_mul_f32 v[98:99], v[98:99], v[34:35]
    v_pk_mul_f32 v[100:101], v[100:101], v[34:35]
    v_pk_mul_f32 v[102:103], v[102:103], v[34:35]
    v_cvt_pk_bf16_f32 v168, v96, v97
    v_cvt_pk_bf16_f32 v169, v98, v99
    v_cvt_pk_bf16_f32 v170, v100, v101
    v_cvt_pk_bf16_f32 v171, v102, v103
    v_pk_mul_f32 v[104:105], v[104:105], v[34:35]
    v_pk_mul_f32 v[106:107], v[106:107], v[34:35]
    v_pk_mul_f32 v[108:109], v[108:109], v[34:35]
    v_pk_mul_f32 v[110:111], v[110:111], v[34:35]
    v_cvt_pk_bf16_f32 v172, v104, v105
    v_cvt_pk_bf16_f32 v173, v106, v107
    v_cvt_pk_bf16_f32 v174, v108, v109
    v_cvt_pk_bf16_f32 v175, v110, v111
    v_permlane16_swap_b32 v168, v170
    v_permlane16_swap_b32 v169, v171
    s_cbranch_scc1 M_s_13
    buffer_store_dwordx4 v[168:171], v44, s[24:27], s69 offen offset:2048
M_t_14:
    s_nop 0
    v_permlane16_swap_b32 v172, v174
    v_permlane16_swap_b32 v173, v175
    s_cbranch_scc1 M_s_15
    buffer_store_dwordx4 v[172:175], v44, s[24:27], s69 offen offset:2304
M_t_16:
    v_pk_mul_f32 v[80:81], v[80:81], v[34:35]
    v_pk_mul_f32 v[82:83], v[82:83], v[34:35]
    v_pk_mul_f32 v[84:85], v[84:85], v[34:35]
    v_pk_mul_f32 v[86:87], v[86:87], v[34:35]
    v_cvt_pk_bf16_f32 v160, v80, v81
    v_cvt_pk_bf16_f32 v161, v82, v83
    v_cvt_pk_bf16_f32 v162, v84, v85
    v_cvt_pk_bf16_f32 v163, v86, v87
    v_pk_mul_f32 v[88:89], v[88:89], v[34:35]
    v_pk_mul_f32 v[90:91], v[90:91], v[34:35]
    v_pk_mul_f32 v[92:93], v[92:93], v[34:35]
    v_pk_mul_f32 v[94:95], v[94:95], v[34:35]
    v_cvt_pk_bf16_f32 v164, v88, v89
    v_cvt_pk_bf16_f32 v165, v90, v91
    v_cvt_pk_bf16_f32 v166, v92, v93
    v_cvt_pk_bf16_f32 v167, v94, v95
    v_permlane16_swap_b32 v160, v162
    v_permlane16_swap_b32 v161, v163
    s_cbranch_scc1 M_s_17
    buffer_store_dwordx4 v[160:163], v44, s[24:27], s68 offen offset:2048
M_t_18:
    s_nop 0
    v_permlane16_swap_b32 v164, v166
    v_permlane16_swap_b32 v165, v167
    s_cbranch_scc1 M_s_19
    buffer_store_dwordx4 v[164:167], v44, s[24:27], s68 offen offset:2304
M_t_20:
    s_cmp_eq_u32 s5, 0
    s_cbranch_scc1 IP_pg5
    s_cmp_eq_u32 s5, 1
    s_cbranch_scc1 IP_pg6
    s_cmp_eq_u32 s5, 2
    s_cbranch_scc1 IP_pg7
    s_branch IP_pg8
IP_ret5:
    s_cmp_lg_u32 s63, 0
    s_waitcnt vmcnt(0)
    s_cbranch_scc1 M_s_21
    buffer_store_dword v33, v32, s[24:27], s75 offen
M_t_22:
    s_barrier
    ds_read_b128 a[128:131], v4 offset:0
    ds_read_b128 a[132:135], v4 offset:32768
    ds_read_b128 a[136:139], v5 offset:0
    ds_read_b128 a[140:143], v5 offset:32768
    s_lshl_b32 s3, s5, 13
    s_add_u32 s3, s3, 131072
    v_and_b32 v36, 15, v1
    v_lshrrev_b32 v37, 4, v1
    v_lshlrev_b32 v36, 4, v36
    v_lshl_add_u32 v36, v37, 9, v36
    v_add_u32 v36, s3, v36
    v_xor_b32 v37, 16384, v36
    s_mov_b32 m0, s3
    s_mov_b32 s58, 0x40000
Q_poll:
    buffer_load_dword v31, v30, s[24:27], s56 offen sc1
    s_sub_u32 s58, s58, 1
    s_cbranch_scc1 Q_go
    s_waitcnt vmcnt(0)
    v_cmp_ne_u32 vcc, 0, v31
    s_cmp_eq_u32 vcc_lo, 3
    s_cbranch_scc0 Q_poll
Q_go:
    buffer_load_dwordx4 v47, s[24:27], s64 offen offset:0 sc1 lds
    buffer_load_dwordx4 v47, s[24:27], s64 offen offset:1024 sc1 lds
    buffer_load_dwordx4 v47, s[24:27], s64 offen offset:2048 sc1 lds
    buffer_load_dwordx4 v47, s[24:27], s64 offen offset:3072 sc1 lds
    s_add_u32 m0, s3, 4096
    s_nop 0
    buffer_load_dwordx4 v47, s[24:27], s65 offen offset:0 sc1 lds
    buffer_load_dwordx4 v47, s[24:27], s65 offen offset:1024 sc1 lds
    buffer_load_dwordx4 v47, s[24:27], s65 offen offset:2048 sc1 lds
    buffer_load_dwordx4 v47, s[24:27], s65 offen offset:3072 sc1 lds
    s_waitcnt vmcnt(0)
    s_barrier
    ds_read_b128 a[64:67], v36 offset:0
    ds_read_b128 a[80:83], v36 offset:256
    ds_read_b128 a[96:99], v37 offset:0
    ds_read_b128 a[112:115], v37 offset:256
    ds_read_b128 a[68:71], v36 offset:2048
    ds_read_b128 a[84:87], v36 offset:2304
    ds_read_b128 a[100:103], v37 offset:2048
    ds_read_b128 a[116:119], v37 offset:2304
    s_waitcnt lgkmcnt(0)
    v_mfma_f32_16x16x32_bf16 v[48:51], a[128:131], a[64:67], 0
    ds_read_b128 a[160:163], v6 offset:0
    v_mfma_f32_16x16x32_bf16 v[56:59], a[128:131], a[80:83], 0
    s_xor_b32 s48, s46, 16384
    ds_read_b128 a[72:75], v36 offset:4096
    v_mfma_f32_16x16x32_bf16 v[64:67], a[128:131], a[96:99], 0
    s_branch IP_sk3
IP_pg3:
    s_branch IP_ret1
IP_sk3:
    ds_read_b128 a[164:167], v6 offset:32768
    v_mfma_f32_16x16x32_bf16 v[72:75], a[128:131], a[112:115], 0
    s_add_u32 m0, s49, 12288
    ds_read_b128 a[88:91], v36 offset:4352
    v_mfma_f32_16x16x32_bf16 v[52:55], a[132:135], a[64:67], 0
    ds_read_b128 a[168:171], v7 offset:0
    v_mfma_f32_16x16x32_bf16 v[60:63], a[132:135], a[80:83], 0
    ds_read_b128 a[104:107], v37 offset:4096
    v_mfma_f32_16x16x32_bf16 v[68:71], a[132:135], a[96:99], 0
    ds_read_b128 a[172:175], v7 offset:32768
    v_mfma_f32_16x16x32_bf16 v[76:79], a[132:135], a[112:115], 0
    ds_read_b128 a[120:123], v37 offset:4352
    v_mfma_f32_16x16x32_bf16 v[48:51], a[136:139], a[68:71], v[48:51]
    v_mfma_f32_16x16x32_bf16 v[56:59], a[136:139], a[84:87], v[56:59]
    buffer_load_dwordx4 v20, s[16:19], s48 offen offset:0 lds
    ds_read_b128 a[76:79], v36 offset:6144
    v_mfma_f32_16x16x32_bf16 v[64:67], a[136:139], a[100:103], v[64:67]
    v_mfma_f32_16x16x32_bf16 v[72:75], a[136:139], a[116:119], v[72:75]
    buffer_load_dwordx4 v21, s[16:19], s48 offen offset:1024 lds
    ds_read_b128 a[92:95], v36 offset:6400
    v_mfma_f32_16x16x32_bf16 v[52:55], a[140:143], a[68:71], v[52:55]
    v_mfma_f32_16x16x32_bf16 v[60:63], a[140:143], a[84:87], v[60:63]
    buffer_load_dwordx4 v22, s[16:19], s48 offen offset:2048 lds
    ds_read_b128 a[108:111], v37 offset:6144
    v_mfma_f32_16x16x32_bf16 v[68:71], a[140:143], a[100:103], v[68:71]
    v_mfma_f32_16x16x32_bf16 v[76:79], a[140:143], a[116:119], v[76:79]
    buffer_load_dwordx4 v23, s[16:19], s48 offen offset:3072 lds
    ds_read_b128 a[124:127], v37 offset:6400
    s_waitcnt vmcnt(16) lgkmcnt(0)
    s_barrier
    v_mfma_f32_16x16x32_bf16 v[48:51], a[160:163], a[72:75], v[48:51]
    ds_read_b128 a[128:131], v4 offset:4096
    v_mfma_f32_16x16x32_bf16 v[56:59], a[160:163], a[88:91], v[56:59]
    s_xor_b32 s48, s46, 8192
    v_mfma_f32_16x16x32_bf16 v[64:67], a[160:163], a[104:107], v[64:67]
    ds_read_b128 a[132:135], v4 offset:36864
    v_mfma_f32_16x16x32_bf16 v[72:75], a[160:163], a[120:123], v[72:75]
    s_add_u32 m0, s49, 16384
    v_mfma_f32_16x16x32_bf16 v[52:55], a[164:167], a[72:75], v[52:55]
    ds_read_b128 a[136:139], v5 offset:4096
    v_mfma_f32_16x16x32_bf16 v[60:63], a[164:167], a[88:91], v[60:63]
    v_mfma_f32_16x16x32_bf16 v[68:71], a[164:167], a[104:107], v[68:71]
    ds_read_b128 a[140:143], v5 offset:36864
    v_mfma_f32_16x16x32_bf16 v[76:79], a[164:167], a[120:123], v[76:79]
    v_mfma_f32_16x16x32_bf16 v[48:51], a[168:171], a[76:79], v[48:51]
    v_mfma_f32_16x16x32_bf16 v[56:59], a[168:171], a[92:95], v[56:59]
    buffer_load_dwordx4 v24, s[20:23], s48 offen offset:0 lds
    v_mfma_f32_16x16x32_bf16 v[64:67], a[168:171], a[108:111], v[64:67]
    v_mfma_f32_16x16x32_bf16 v[72:75], a[168:171], a[124:127], v[72:75]
    buffer_load_dwordx4 v25, s[20:23], s48 offen offset:1024 lds
    v_mfma_f32_16x16x32_bf16 v[52:55], a[172:175], a[76:79], v[52:55]
    v_mfma_f32_16x16x32_bf16 v[60:63], a[172:175], a[92:95], v[60:63]
    buffer_load_dwordx4 v24, s[20:23], s48 offen offset:2048 lds
    v_mfma_f32_16x16x32_bf16 v[68:71], a[172:175], a[108:111], v[68:71]
    v_mfma_f32_16x16x32_bf16 v[76:79], a[172:175], a[124:127], v[76:79]
    buffer_load_dwordx4 v25, s[20:23], s48 offen offset:3072 lds
    s_nop 3
    v_max3_f32 v34, v48, v49, v50
    v_max3_f32 v35, v56, v57, v58
    v_max3_f32 v36, v64, v65, v66
    v_max3_f32 v37, v72, v73, v74
    v_max3_f32 v34, v34, v51, v52
    v_max3_f32 v35, v35, v59, v60
    v_max3_f32 v36, v36, v67, v68
    v_max3_f32 v37, v37, v75, v76
    v_max3_f32 v34, v34, v53, v54
    v_max3_f32 v35, v35, v61, v62
    v_max3_f32 v36, v36, v69, v70
    v_max3_f32 v37, v37, v77, v78
    v_max_f32 v34, v34, v55
    v_max_f32 v35, v35, v63
    v_max_f32 v36, v36, v71
    v_max_f32 v37, v37, v79
    v_mov_b32 v38, v34
    v_mov_b32 v39, v35
    v_mov_b32 v40, v36
    v_mov_b32 v41, v37
    v_permlane16_swap_b32 v34, v38
    v_permlane16_swap_b32 v35, v39
    v_permlane16_swap_b32 v36, v40
    v_permlane16_swap_b32 v37, v41
    v_max_f32 v34, v34, v38
    v_max_f32 v35, v35, v39
    v_max_f32 v36, v36, v40
    v_max_f32 v37, v37, v41
    v_mov_b32 v38, v34
    v_mov_b32 v39, v35
    v_mov_b32 v40, v36
    v_mov_b32 v41, v37
    v_permlane32_swap_b32 v34, v38
    v_permlane32_swap_b32 v35, v39
    v_permlane32_swap_b32 v36, v40
    v_permlane32_swap_b32 v37, v41
    v_max_f32 v34, v34, v38
    v_max_f32 v35, v35, v39
    v_max_f32 v36, v36, v40
    v_max_f32 v37, v37, v41
    v_sub_f32 v112, 0, v34
    v_sub_f32 v113, 0, v34
    v_sub_f32 v116, 0, v35
    v_sub_f32 v117, 0, v35
    v_sub_f32 v120, 0, v36
    v_sub_f32 v121, 0, v36
    v_sub_f32 v124, 0, v37
    v_sub_f32 v125, 0, v37
    v_mov_b64 v[114:115], v[112:113]
    v_mov_b64 v[118:119], v[116:117]
    v_mov_b64 v[122:123], v[120:121]
    v_mov_b64 v[126:127], v[124:125]
    s_nop 0
    s_waitcnt lgkmcnt(0)
    v_mfma_f32_16x16x32_bf16 v[80:83], a[128:131], a[64:67], v[112:115]
    ds_read_b128 a[160:163], v6 offset:4096
    v_add_f32 v48, v112, v48
    v_add_f32 v49, v112, v49
    v_exp_f32 v240, v48
    v_mfma_f32_16x16x32_bf16 v[88:91], a[128:131], a[80:83], v[116:119]
    v_exp_f32 v241, v49
    v_add_f32 v56, v116, v56
    v_add_f32 v57, v116, v57
    v_exp_f32 v242, v56
    v_mfma_f32_16x16x32_bf16 v[96:99], a[128:131], a[96:99], v[120:123]
    ds_read_b128 a[164:167], v6 offset:36864
    v_exp_f32 v243, v57
    v_add_f32 v132, v240, v241
    v_mfma_f32_16x16x32_bf16 v[104:107], a[128:131], a[112:115], v[124:127]
    v_cvt_pk_bf16_f32 v144, v240, v241
    v_add_f32 v64, v120, v64
    v_add_f32 v65, v120, v65
    v_exp_f32 v244, v64
    v_mfma_f32_16x16x32_bf16 v[84:87], a[132:135], a[64:67], v[112:115]
    ds_read_b128 a[168:171], v7 offset:4096
    v_exp_f32 v245, v65
    v_add_f32 v133, v242, v243
    v_cvt_pk_bf16_f32 v148, v242, v243
    v_mfma_f32_16x16x32_bf16 v[92:95], a[132:135], a[80:83], v[116:119]
    v_add_f32 v72, v124, v72
    v_add_f32 v73, v124, v73
    v_exp_f32 v240, v72
    v_exp_f32 v241, v73
    v_mfma_f32_16x16x32_bf16 v[100:103], a[132:135], a[96:99], v[120:123]
    ds_read_b128 a[172:175], v7 offset:36864
    v_add_f32 v134, v244, v245
    v_cvt_pk_bf16_f32 v152, v244, v245
    v_add_f32 v50, v112, v50
    v_add_f32 v51, v112, v51
    v_mfma_f32_16x16x32_bf16 v[108:111], a[132:135], a[112:115], v[124:127]
    v_exp_f32 v242, v50
    v_exp_f32 v243, v51
    v_add_f32 v135, v240, v241
    v_mfma_f32_16x16x32_bf16 v[80:83], a[136:139], a[68:71], v[80:83]
    v_cvt_pk_bf16_f32 v156, v240, v241
    v_add_f32 v58, v116, v58
    v_add_f32 v59, v116, v59
    v_exp_f32 v244, v58
    v_mfma_f32_16x16x32_bf16 v[88:91], a[136:139], a[84:87], v[88:91]
    v_exp_f32 v245, v59
    v_add_f32 v132, v132, v242
    v_add_f32 v132, v132, v243
    v_cvt_pk_bf16_f32 v145, v242, v243
    v_mfma_f32_16x16x32_bf16 v[96:99], a[136:139], a[100:103], v[96:99]
    v_add_f32 v66, v120, v66
    v_add_f32 v67, v120, v67
    v_exp_f32 v240, v66
    v_exp_f32 v241, v67
    v_mfma_f32_16x16x32_bf16 v[104:107], a[136:139], a[116:119], v[104:107]
    v_add_f32 v133, v133, v244
    v_add_f32 v133, v133, v245
    v_cvt_pk_bf16_f32 v149, v244, v245
    v_add_f32 v74, v124, v74
    v_mfma_f32_16x16x32_bf16 v[84:87], a[140:143], a[68:71], v[84:87]
    v_add_f32 v75, v124, v75
    v_exp_f32 v242, v74
    v_exp_f32 v243, v75
    v_mfma_f32_16x16x32_bf16 v[92:95], a[140:143], a[84:87], v[92:95]
    v_add_f32 v134, v134, v240
    v_add_f32 v134, v134, v241
    v_cvt_pk_bf16_f32 v153, v240, v241
    v_add_f32 v52, v112, v52
    v_add_f32 v53, v112, v53
    v_mfma_f32_16x16x32_bf16 v[100:103], a[140:143], a[100:103], v[100:103]
    v_exp_f32 v244, v52
    v_exp_f32 v245, v53
    v_add_f32 v135, v135, v242
    v_mfma_f32_16x16x32_bf16 v[108:111], a[140:143], a[116:119], v[108:111]
    v_add_f32 v135, v135, v243
    v_cvt_pk_bf16_f32 v157, v242, v243
    v_add_f32 v60, v116, v60
    v_add_f32 v61, v116, v61
    v_exp_f32 v240, v60
    s_waitcnt vmcnt(16) lgkmcnt(0)
    s_barrier
    v_mfma_f32_16x16x32_bf16 v[80:83], a[160:163], a[72:75], v[80:83]
    ds_read_b64_tr_b16 a[128:129], v26 offset:8192
    v_exp_f32 v241, v61
    v_add_f32 v132, v132, v244
    v_add_f32 v132, v132, v245
    v_mfma_f32_16x16x32_bf16 v[88:91], a[160:163], a[88:91], v[88:91]
    ds_read_b64_tr_b16 a[130:131], v26 offset:40960
    s_xor_b32 s48, s46, 24576
    v_cvt_pk_bf16_f32 v146, v244, v245
    v_add_f32 v68, v120, v68
    v_add_f32 v69, v120, v69
    v_mfma_f32_16x16x32_bf16 v[96:99], a[160:163], a[104:107], v[96:99]
    ds_read_b64_tr_b16 a[132:133], v27 offset:8192
    v_exp_f32 v242, v68
    v_exp_f32 v243, v69
    v_mfma_f32_16x16x32_bf16 v[104:107], a[160:163], a[120:123], v[104:107]
    ds_read_b64_tr_b16 a[134:135], v27 offset:40960
    s_add_u32 m0, s49, 20480
    v_add_f32 v133, v133, v240
    v_add_f32 v133, v133, v241
    v_cvt_pk_bf16_f32 v150, v240, v241
    v_mfma_f32_16x16x32_bf16 v[84:87], a[164:167], a[72:75], v[84:87]
    ds_read_b64_tr_b16 a[136:137], v28 offset:8192
    v_add_f32 v76, v124, v76
    v_add_f32 v77, v124, v77
    v_exp_f32 v244, v76
    v_mfma_f32_16x16x32_bf16 v[92:95], a[164:167], a[88:91], v[92:95]
    ds_read_b64_tr_b16 a[138:139], v28 offset:40960
    v_exp_f32 v245, v77
    v_add_f32 v134, v134, v242
    v_add_f32 v134, v134, v243
    v_mfma_f32_16x16x32_bf16 v[100:103], a[164:167], a[104:107], v[100:103]
    ds_read_b64_tr_b16 a[140:141], v29 offset:8192
    v_cvt_pk_bf16_f32 v154, v242, v243
    v_add_f32 v54, v112, v54
    v_add_f32 v55, v112, v55
    v_exp_f32 v240, v54
    v_mfma_f32_16x16x32_bf16 v[108:111], a[164:167], a[120:123], v[108:111]
    ds_read_b64_tr_b16 a[142:143], v29 offset:40960
    v_exp_f32 v241, v55
    v_add_f32 v135, v135, v244
    v_mfma_f32_16x16x32_bf16 v[80:83], a[168:171], a[76:79], v[80:83]
    v_add_f32 v135, v135, v245
    v_cvt_pk_bf16_f32 v158, v244, v245
    v_add_f32 v62, v116, v62
    v_add_f32 v63, v116, v63
    v_exp_f32 v242, v62
    v_mfma_f32_16x16x32_bf16 v[88:91], a[168:171], a[92:95], v[88:91]
    buffer_load_dwordx4 v20, s[16:19], s48 offen offset:0 lds
    v_exp_f32 v243, v63
    v_mfma_f32_16x16x32_bf16 v[96:99], a[168:171], a[108:111], v[96:99]
    v_add_f32 v132, v132, v240
    v_add_f32 v132, v132, v241
    v_cvt_pk_bf16_f32 v147, v240, v241
    v_add_f32 v70, v120, v70
    v_add_f32 v71, v120, v71
    v_mfma_f32_16x16x32_bf16 v[104:107], a[168:171], a[124:127], v[104:107]
    buffer_load_dwordx4 v21, s[16:19], s48 offen offset:1024 lds
    v_exp_f32 v244, v70
    v_exp_f32 v245, v71
    v_mfma_f32_16x16x32_bf16 v[84:87], a[172:175], a[76:79], v[84:87]
    v_add_f32 v133, v133, v242
    v_add_f32 v133, v133, v243
    v_cvt_pk_bf16_f32 v151, v242, v243
    v_add_f32 v78, v124, v78
    v_add_f32 v79, v124, v79
    v_mfma_f32_16x16x32_bf16 v[92:95], a[172:175], a[92:95], v[92:95]
    buffer_load_dwordx4 v22, s[16:19], s48 offen offset:2048 lds
    v_exp_f32 v240, v78
    v_mfma_f32_16x16x32_bf16 v[100:103], a[172:175], a[108:111], v[100:103]
    v_exp_f32 v241, v79
    v_add_f32 v134, v134, v244
    v_add_f32 v134, v134, v245
    v_cvt_pk_bf16_f32 v155, v244, v245
    s_nop 0
    v_mfma_f32_16x16x32_bf16 v[108:111], a[172:175], a[124:127], v[108:111]
    buffer_load_dwordx4 v23, s[16:19], s48 offen offset:3072 lds
    v_add_f32 v135, v135, v240
    v_add_f32 v135, v135, v241
    v_cvt_pk_bf16_f32 v159, v240, v241
    v_mov_b64 v[128:129], v[132:133]
    v_mov_b64 v[130:131], v[134:135]
    s_waitcnt lgkmcnt(0)
    v_mfma_f32_16x16x32_bf16 v[176:179], a[128:131], v[144:147], 0
    ds_read_b64_tr_b16 a[160:161], v8 offset:8192
    v_mfma_f32_16x16x32_bf16 v[184:187], a[128:131], v[148:151], 0
    ds_read_b64_tr_b16 a[162:163], v8 offset:40960
    v_mfma_f32_16x16x32_bf16 a[0:3], a[128:131], v[152:155], 0
    ds_read_b64_tr_b16 a[164:165], v9 offset:8192
    v_mfma_f32_16x16x32_bf16 a[8:11], a[128:131], v[156:159], 0
    ds_read_b64_tr_b16 a[166:167], v9 offset:40960
    v_mfma_f32_16x16x32_bf16 v[180:183], a[132:135], v[144:147], 0
    ds_read_b64_tr_b16 a[168:169], v10 offset:8192
    v_exp_f32 v240, v80
    v_mfma_f32_16x16x32_bf16 v[188:191], a[132:135], v[148:151], 0
    ds_read_b64_tr_b16 a[170:171], v10 offset:40960
    v_mfma_f32_16x16x32_bf16 a[4:7], a[132:135], v[152:155], 0
    ds_read_b64_tr_b16 a[172:173], v11 offset:8192
    v_exp_f32 v241, v81
    v_mfma_f32_16x16x32_bf16 a[12:15], a[132:135], v[156:159], 0
    ds_read_b64_tr_b16 a[174:175], v11 offset:40960
    v_exp_f32 v242, v88
    v_mfma_f32_16x16x32_bf16 v[192:195], a[136:139], v[144:147], 0
    v_exp_f32 v243, v89
    v_mfma_f32_16x16x32_bf16 v[200:203], a[136:139], v[148:151], 0
    v_add_f32 v132, v240, v241
    v_cvt_pk_bf16_f32 v160, v240, v241
    v_mfma_f32_16x16x32_bf16 a[16:19], a[136:139], v[152:155], 0
    v_exp_f32 v244, v96
    v_exp_f32 v245, v97
    v_mfma_f32_16x16x32_bf16 a[24:27], a[136:139], v[156:159], 0
    v_add_f32 v133, v242, v243
    v_cvt_pk_bf16_f32 v164, v242, v243
    v_mfma_f32_16x16x32_bf16 v[196:199], a[140:143], v[144:147], 0
    v_exp_f32 v240, v104
    v_mfma_f32_16x16x32_bf16 v[204:207], a[140:143], v[148:151], 0
    v_exp_f32 v241, v105
    v_add_f32 v134, v244, v245
    v_mfma_f32_16x16x32_bf16 a[20:23], a[140:143], v[152:155], 0
    v_cvt_pk_bf16_f32 v168, v244, v245
    v_exp_f32 v242, v82
    v_mfma_f32_16x16x32_bf16 a[28:31], a[140:143], v[156:159], 0
    v_exp_f32 v243, v83
    s_waitcnt vmcnt(8) lgkmcnt(0)
    s_barrier
    v_mfma_f32_16x16x32_bf16 v[208:211], a[160:163], v[144:147], 0
    ds_read_b128 a[128:131], v4 offset:12288
    v_add_f32 v135, v240, v241
    v_mfma_f32_16x16x32_bf16 v[216:219], a[160:163], v[148:151], 0
    s_xor_b32 s48, s46, 16384
    v_cvt_pk_bf16_f32 v172, v240, v241
    v_mfma_f32_16x16x32_bf16 a[32:35], a[160:163], v[152:155], 0
    ds_read_b128 a[132:135], v4 offset:45056
    v_exp_f32 v244, v90
    v_mfma_f32_16x16x32_bf16 a[40:43], a[160:163], v[156:159], 0
    s_add_u32 m0, s49, 24576
    v_exp_f32 v245, v91
    v_mfma_f32_16x16x32_bf16 v[212:215], a[164:167], v[144:147], 0
    ds_read_b128 a[136:139], v5 offset:12288
    v_add_f32 v132, v132, v242
    v_mfma_f32_16x16x32_bf16 v[220:223], a[164:167], v[148:151], 0
    v_add_f32 v132, v132, v243
    v_cvt_pk_bf16_f32 v161, v242, v243
    v_mfma_f32_16x16x32_bf16 a[36:39], a[164:167], v[152:155], 0
    ds_read_b128 a[140:143], v5 offset:45056
    v_exp_f32 v240, v98
    v_mfma_f32_16x16x32_bf16 a[44:47], a[164:167], v[156:159], 0
    v_exp_f32 v241, v99
    v_add_f32 v133, v133, v244
    v_mfma_f32_16x16x32_bf16 v[224:227], a[168:171], v[144:147], 0
    v_add_f32 v133, v133, v245
    v_cvt_pk_bf16_f32 v165, v244, v245
    v_mfma_f32_16x16x32_bf16 v[232:235], a[168:171], v[148:151], 0
    buffer_load_dwordx4 v24, s[20:23], s48 offen offset:0 lds
    v_mfma_f32_16x16x32_bf16 a[48:51], a[168:171], v[152:155], 0
    v_exp_f32 v242, v106
    v_exp_f32 v243, v107
    v_mfma_f32_16x16x32_bf16 a[56:59], a[168:171], v[156:159], 0
    buffer_load_dwordx4 v25, s[20:23], s48 offen offset:1024 lds
    v_mfma_f32_16x16x32_bf16 v[228:231], a[172:175], v[144:147], 0
    v_add_f32 v134, v134, v240
    v_add_f32 v134, v134, v241
    v_mfma_f32_16x16x32_bf16 v[236:239], a[172:175], v[148:151], 0
    buffer_load_dwordx4 v24, s[20:23], s48 offen offset:2048 lds
    v_cvt_pk_bf16_f32 v169, v240, v241
    v_mfma_f32_16x16x32_bf16 a[52:55], a[172:175], v[152:155], 0
    v_exp_f32 v244, v84
    v_mfma_f32_16x16x32_bf16 a[60:63], a[172:175], v[156:159], 0
    buffer_load_dwordx4 v25, s[20:23], s48 offen offset:3072 lds
    s_waitcnt lgkmcnt(0)
    v_mfma_f32_16x16x32_bf16 v[48:51], a[128:131], a[64:67], v[112:115]
    ds_read_b128 a[160:163], v6 offset:12288
    v_exp_f32 v245, v85
    v_mfma_f32_16x16x32_bf16 v[56:59], a[128:131], a[80:83], v[116:119]
    v_add_f32 v135, v135, v242
    v_add_f32 v135, v135, v243
    v_cvt_pk_bf16_f32 v173, v242, v243
    v_mfma_f32_16x16x32_bf16 v[64:67], a[128:131], a[96:99], v[120:123]
    ds_read_b128 a[164:167], v6 offset:45056
    v_mfma_f32_16x16x32_bf16 v[72:75], a[128:131], a[112:115], v[124:127]
    v_exp_f32 v240, v92
    v_exp_f32 v241, v93
    v_mfma_f32_16x16x32_bf16 v[52:55], a[132:135], a[64:67], v[112:115]
    ds_read_b128 a[168:171], v7 offset:12288
    v_add_f32 v132, v132, v244
    v_mfma_f32_16x16x32_bf16 v[60:63], a[132:135], a[80:83], v[116:119]
    v_add_f32 v132, v132, v245
    v_cvt_pk_bf16_f32 v162, v244, v245
    v_mfma_f32_16x16x32_bf16 v[68:71], a[132:135], a[96:99], v[120:123]
    ds_read_b128 a[172:175], v7 offset:45056
    v_exp_f32 v242, v100
    v_mfma_f32_16x16x32_bf16 v[76:79], a[132:135], a[112:115], v[124:127]
    v_exp_f32 v243, v101
    v_mfma_f32_16x16x32_bf16 v[48:51], a[136:139], a[68:71], v[48:51]
    v_add_f32 v133, v133, v240
    v_add_f32 v133, v133, v241
    v_cvt_pk_bf16_f32 v166, v240, v241
    v_mfma_f32_16x16x32_bf16 v[56:59], a[136:139], a[84:87], v[56:59]
    v_exp_f32 v244, v108
    v_mfma_f32_16x16x32_bf16 v[64:67], a[136:139], a[100:103], v[64:67]
    v_exp_f32 v245, v109
    v_add_f32 v134, v134, v242
    v_mfma_f32_16x16x32_bf16 v[72:75], a[136:139], a[116:119], v[72:75]
    v_add_f32 v134, v134, v243
    v_cvt_pk_bf16_f32 v170, v242, v243
    v_mfma_f32_16x16x32_bf16 v[52:55], a[140:143], a[68:71], v[52:55]
    v_exp_f32 v240, v86
    v_mfma_f32_16x16x32_bf16 v[60:63], a[140:143], a[84:87], v[60:63]
    v_exp_f32 v241, v87
    v_add_f32 v135, v135, v244
    v_mfma_f32_16x16x32_bf16 v[68:71], a[140:143], a[100:103], v[68:71]
    v_add_f32 v135, v135, v245
    v_cvt_pk_bf16_f32 v174, v244, v245
    v_mfma_f32_16x16x32_bf16 v[76:79], a[140:143], a[116:119], v[76:79]
    v_exp_f32 v242, v94
    v_exp_f32 v243, v95
    s_waitcnt vmcnt(8) lgkmcnt(0)
    s_barrier
    v_mfma_f32_16x16x32_bf16 v[48:51], a[160:163], a[72:75], v[48:51]
    ds_read_b64_tr_b16 a[128:129], v26 offset:16384
    v_add_f32 v132, v132, v240
    v_mfma_f32_16x16x32_bf16 v[56:59], a[160:163], a[88:91], v[56:59]
    ds_read_b64_tr_b16 a[130:131], v26 offset:49152
    s_xor_b32 s48, s46, 32768
    v_mfma_f32_16x16x32_bf16 v[64:67], a[160:163], a[104:107], v[64:67]
    ds_read_b64_tr_b16 a[132:133], v27 offset:16384
    v_add_f32 v132, v132, v241
    v_cvt_pk_bf16_f32 v163, v240, v241
    v_mfma_f32_16x16x32_bf16 v[72:75], a[160:163], a[120:123], v[72:75]
    ds_read_b64_tr_b16 a[134:135], v27 offset:49152
    s_add_u32 m0, s49, 28672
    v_mfma_f32_16x16x32_bf16 v[52:55], a[164:167], a[72:75], v[52:55]
    ds_read_b64_tr_b16 a[136:137], v28 offset:16384
    v_exp_f32 v244, v102
    v_mfma_f32_16x16x32_bf16 v[60:63], a[164:167], a[88:91], v[60:63]
    ds_read_b64_tr_b16 a[138:139], v28 offset:49152
    v_exp_f32 v245, v103
    v_mfma_f32_16x16x32_bf16 v[68:71], a[164:167], a[104:107], v[68:71]
    ds_read_b64_tr_b16 a[140:141], v29 offset:16384
    v_add_f32 v133, v133, v242
    v_mfma_f32_16x16x32_bf16 v[76:79], a[164:167], a[120:123], v[76:79]
    ds_read_b64_tr_b16 a[142:143], v29 offset:49152
    v_add_f32 v133, v133, v243
    v_mfma_f32_16x16x32_bf16 v[48:51], a[168:171], a[76:79], v[48:51]
    v_cvt_pk_bf16_f32 v167, v242, v243
    v_exp_f32 v240, v110
    v_mfma_f32_16x16x32_bf16 v[56:59], a[168:171], a[92:95], v[56:59]
    buffer_load_dwordx4 v20, s[16:19], s48 offen offset:0 lds
    v_mfma_f32_16x16x32_bf16 v[64:67], a[168:171], a[108:111], v[64:67]
    v_exp_f32 v241, v111
    v_add_f32 v134, v134, v244
    v_mfma_f32_16x16x32_bf16 v[72:75], a[168:171], a[124:127], v[72:75]
    buffer_load_dwordx4 v21, s[16:19], s48 offen offset:1024 lds
    v_mfma_f32_16x16x32_bf16 v[52:55], a[172:175], a[76:79], v[52:55]
    v_add_f32 v134, v134, v245
    v_cvt_pk_bf16_f32 v171, v244, v245
    s_nop 0
    v_mfma_f32_16x16x32_bf16 v[60:63], a[172:175], a[92:95], v[60:63]
    buffer_load_dwordx4 v22, s[16:19], s48 offen offset:2048 lds
    v_mfma_f32_16x16x32_bf16 v[68:71], a[172:175], a[108:111], v[68:71]
    v_add_f32 v135, v135, v240
    v_add_f32 v135, v135, v241
    v_cvt_pk_bf16_f32 v175, v240, v241
    v_mfma_f32_16x16x32_bf16 v[76:79], a[172:175], a[124:127], v[76:79]
    buffer_load_dwordx4 v23, s[16:19], s48 offen offset:3072 lds
    v_max3_f32 v34, v132, v133, v134
    v_max_f32 v34, v34, v135
    v_cmp_lt_f32 vcc, s59, v34
    s_cbranch_vccnz K_rs_23
K_bk_24:
    v_add_f32 v128, v128, v132
    v_add_f32 v129, v129, v133
    v_add_f32 v130, v130, v134
    v_add_f32 v131, v131, v135
    s_waitcnt lgkmcnt(0)
    v_mfma_f32_16x16x32_bf16 v[176:179], a[128:131], v[160:163], v[176:179]
    ds_read_b64_tr_b16 a[160:161], v8 offset:16384
    v_mfma_f32_16x16x32_bf16 v[184:187], a[128:131], v[164:167], v[184:187]
    ds_read_b64_tr_b16 a[162:163], v8 offset:49152
    v_mfma_f32_16x16x32_bf16 a[0:3], a[128:131], v[168:171], a[0:3]
    ds_read_b64_tr_b16 a[164:165], v9 offset:16384
    v_mfma_f32_16x16x32_bf16 a[8:11], a[128:131], v[172:175], a[8:11]
    ds_read_b64_tr_b16 a[166:167], v9 offset:49152
    v_mfma_f32_16x16x32_bf16 v[180:183], a[132:135], v[160:163], v[180:183]
    ds_read_b64_tr_b16 a[168:169], v10 offset:16384
    v_exp_f32 v240, v48
    v_mfma_f32_16x16x32_bf16 v[188:191], a[132:135], v[164:167], v[188:191]
    ds_read_b64_tr_b16 a[170:171], v10 offset:49152
    v_mfma_f32_16x16x32_bf16 a[4:7], a[132:135], v[168:171], a[4:7]
    ds_read_b64_tr_b16 a[172:173], v11 offset:16384
    v_exp_f32 v241, v49
    v_mfma_f32_16x16x32_bf16 a[12:15], a[132:135], v[172:175], a[12:15]
    ds_read_b64_tr_b16 a[174:175], v11 offset:49152
    v_exp_f32 v242, v56
    v_mfma_f32_16x16x32_bf16 v[192:195], a[136:139], v[160:163], v[192:195]
    v_exp_f32 v243, v57
    v_mfma_f32_16x16x32_bf16 v[200:203], a[136:139], v[164:167], v[200:203]
    v_add_f32 v132, v240, v241
    v_cvt_pk_bf16_f32 v144, v240, v241
    v_mfma_f32_16x16x32_bf16 a[16:19], a[136:139], v[168:171], a[16:19]
    v_exp_f32 v244, v64
    v_exp_f32 v245, v65
    v_mfma_f32_16x16x32_bf16 a[24:27], a[136:139], v[172:175], a[24:27]
    v_add_f32 v133, v242, v243
    v_cvt_pk_bf16_f32 v148, v242, v243
    v_mfma_f32_16x16x32_bf16 v[196:199], a[140:143], v[160:163], v[196:199]
    v_exp_f32 v240, v72
    v_mfma_f32_16x16x32_bf16 v[204:207], a[140:143], v[164:167], v[204:207]
    v_exp_f32 v241, v73
    v_add_f32 v134, v244, v245
    v_mfma_f32_16x16x32_bf16 a[20:23], a[140:143], v[168:171], a[20:23]
    v_cvt_pk_bf16_f32 v152, v244, v245
    v_exp_f32 v242, v50
    v_mfma_f32_16x16x32_bf16 a[28:31], a[140:143], v[172:175], a[28:31]
    v_exp_f32 v243, v51
    s_waitcnt vmcnt(8) lgkmcnt(0)
    s_barrier
    v_mfma_f32_16x16x32_bf16 v[208:211], a[160:163], v[160:163], v[208:211]
    ds_read_b128 a[128:131], v4 offset:20480
    v_add_f32 v135, v240, v241
    v_mfma_f32_16x16x32_bf16 v[216:219], a[160:163], v[164:167], v[216:219]
    s_xor_b32 s48, s46, 24576
    v_cvt_pk_bf16_f32 v156, v240, v241
    v_mfma_f32_16x16x32_bf16 a[32:35], a[160:163], v[168:171], a[32:35]
    ds_read_b128 a[132:135], v4 offset:53248
    v_exp_f32 v244, v58
    v_mfma_f32_16x16x32_bf16 a[40:43], a[160:163], v[172:175], a[40:43]
    s_add_u32 m0, s49, 0
    v_exp_f32 v245, v59
    v_mfma_f32_16x16x32_bf16 v[212:215], a[164:167], v[160:163], v[212:215]
    ds_read_b128 a[136:139], v5 offset:20480
    v_add_f32 v132, v132, v242
    v_mfma_f32_16x16x32_bf16 v[220:223], a[164:167], v[164:167], v[220:223]
    v_add_f32 v132, v132, v243
    v_cvt_pk_bf16_f32 v145, v242, v243
    v_mfma_f32_16x16x32_bf16 a[36:39], a[164:167], v[168:171], a[36:39]
    ds_read_b128 a[140:143], v5 offset:53248
    v_exp_f32 v240, v66
    v_mfma_f32_16x16x32_bf16 a[44:47], a[164:167], v[172:175], a[44:47]
    v_exp_f32 v241, v67
    v_add_f32 v133, v133, v244
    v_mfma_f32_16x16x32_bf16 v[224:227], a[168:171], v[160:163], v[224:227]
    v_add_f32 v133, v133, v245
    v_cvt_pk_bf16_f32 v149, v244, v245
    v_mfma_f32_16x16x32_bf16 v[232:235], a[168:171], v[164:167], v[232:235]
    buffer_load_dwordx4 v24, s[20:23], s48 offen offset:0 lds
    v_mfma_f32_16x16x32_bf16 a[48:51], a[168:171], v[168:171], a[48:51]
    v_exp_f32 v242, v74
    v_exp_f32 v243, v75
    v_mfma_f32_16x16x32_bf16 a[56:59], a[168:171], v[172:175], a[56:59]
    buffer_load_dwordx4 v25, s[20:23], s48 offen offset:1024 lds
    v_mfma_f32_16x16x32_bf16 v[228:231], a[172:175], v[160:163], v[228:231]
    v_add_f32 v134, v134, v240
    v_add_f32 v134, v134, v241
    v_mfma_f32_16x16x32_bf16 v[236:239], a[172:175], v[164:167], v[236:239]
    buffer_load_dwordx4 v24, s[20:23], s48 offen offset:2048 lds
    v_cvt_pk_bf16_f32 v153, v240, v241
    v_mfma_f32_16x16x32_bf16 a[52:55], a[172:175], v[168:171], a[52:55]
    v_exp_f32 v244, v52
    v_mfma_f32_16x16x32_bf16 a[60:63], a[172:175], v[172:175], a[60:63]
    buffer_load_dwordx4 v25, s[20:23], s48 offen offset:3072 lds
    s_waitcnt lgkmcnt(0)
    v_mfma_f32_16x16x32_bf16 v[80:83], a[128:131], a[64:67], v[112:115]
    ds_read_b128 a[160:163], v6 offset:20480
    v_exp_f32 v245, v53
    v_mfma_f32_16x16x32_bf16 v[88:91], a[128:131], a[80:83], v[116:119]
    v_add_f32 v135, v135, v242
    v_add_f32 v135, v135, v243
    v_cvt_pk_bf16_f32 v157, v242, v243
    v_mfma_f32_16x16x32_bf16 v[96:99], a[128:131], a[96:99], v[120:123]
    ds_read_b128 a[164:167], v6 offset:53248
    v_mfma_f32_16x16x32_bf16 v[104:107], a[128:131], a[112:115], v[124:127]
    v_exp_f32 v240, v60
    v_exp_f32 v241, v61
    v_mfma_f32_16x16x32_bf16 v[84:87], a[132:135], a[64:67], v[112:115]
    ds_read_b128 a[168:171], v7 offset:20480
    v_add_f32 v132, v132, v244
    v_mfma_f32_16x16x32_bf16 v[92:95], a[132:135], a[80:83], v[116:119]
    v_add_f32 v132, v132, v245
    v_cvt_pk_bf16_f32 v146, v244, v245
    v_mfma_f32_16x16x32_bf16 v[100:103], a[132:135], a[96:99], v[120:123]
    ds_read_b128 a[172:175], v7 offset:53248
    v_exp_f32 v242, v68
    v_mfma_f32_16x16x32_bf16 v[108:111], a[132:135], a[112:115], v[124:127]
    v_exp_f32 v243, v69
    v_mfma_f32_16x16x32_bf16 v[80:83], a[136:139], a[68:71], v[80:83]
    v_add_f32 v133, v133, v240
    v_add_f32 v133, v133, v241
    v_cvt_pk_bf16_f32 v150, v240, v241
    v_mfma_f32_16x16x32_bf16 v[88:91], a[136:139], a[84:87], v[88:91]
    v_exp_f32 v244, v76
    v_mfma_f32_16x16x32_bf16 v[96:99], a[136:139], a[100:103], v[96:99]
    v_exp_f32 v245, v77
    v_add_f32 v134, v134, v242
    v_mfma_f32_16x16x32_bf16 v[104:107], a[136:139], a[116:119], v[104:107]
    v_add_f32 v134, v134, v243
    v_cvt_pk_bf16_f32 v154, v242, v243
    v_mfma_f32_16x16x32_bf16 v[84:87], a[140:143], a[68:71], v[84:87]
    v_exp_f32 v240, v54
    v_mfma_f32_16x16x32_bf16 v[92:95], a[140:143], a[84:87], v[92:95]
    v_exp_f32 v241, v55
    v_add_f32 v135, v135, v244
    v_mfma_f32_16x16x32_bf16 v[100:103], a[140:143], a[100:103], v[100:103]
    v_add_f32 v135, v135, v245
    v_cvt_pk_bf16_f32 v158, v244, v245
    v_mfma_f32_16x16x32_bf16 v[108:111], a[140:143], a[116:119], v[108:111]
    v_exp_f32 v242, v62
    v_exp_f32 v243, v63
    s_waitcnt vmcnt(8) lgkmcnt(0)
    s_barrier
    v_mfma_f32_16x16x32_bf16 v[80:83], a[160:163], a[72:75], v[80:83]
    ds_read_b64_tr_b16 a[128:129], v26 offset:24576
    v_add_f32 v132, v132, v240
    v_mfma_f32_16x16x32_bf16 v[88:91], a[160:163], a[88:91], v[88:91]
    ds_read_b64_tr_b16 a[130:131], v26 offset:57344
    s_xor_b32 s48, s46, 40960
    v_mfma_f32_16x16x32_bf16 v[96:99], a[160:163], a[104:107], v[96:99]
    ds_read_b64_tr_b16 a[132:133], v27 offset:24576
    v_add_f32 v132, v132, v241
    v_cvt_pk_bf16_f32 v147, v240, v241
    v_mfma_f32_16x16x32_bf16 v[104:107], a[160:163], a[120:123], v[104:107]
    ds_read_b64_tr_b16 a[134:135], v27 offset:57344
    s_add_u32 m0, s49, 4096
    v_mfma_f32_16x16x32_bf16 v[84:87], a[164:167], a[72:75], v[84:87]
    ds_read_b64_tr_b16 a[136:137], v28 offset:24576
    v_exp_f32 v244, v70
    v_mfma_f32_16x16x32_bf16 v[92:95], a[164:167], a[88:91], v[92:95]
    ds_read_b64_tr_b16 a[138:139], v28 offset:57344
    v_exp_f32 v245, v71
    v_mfma_f32_16x16x32_bf16 v[100:103], a[164:167], a[104:107], v[100:103]
    ds_read_b64_tr_b16 a[140:141], v29 offset:24576
    v_add_f32 v133, v133, v242
    v_mfma_f32_16x16x32_bf16 v[108:111], a[164:167], a[120:123], v[108:111]
    ds_read_b64_tr_b16 a[142:143], v29 offset:57344
    v_add_f32 v133, v133, v243
    v_mfma_f32_16x16x32_bf16 v[80:83], a[168:171], a[76:79], v[80:83]
    v_cvt_pk_bf16_f32 v151, v242, v243
    v_exp_f32 v240, v78
    v_mfma_f32_16x16x32_bf16 v[88:91], a[168:171], a[92:95], v[88:91]
    buffer_load_dwordx4 v20, s[16:19], s48 offen offset:0 lds
    v_mfma_f32_16x16x32_bf16 v[96:99], a[168:171], a[108:111], v[96:99]
    v_exp_f32 v241, v79
    v_add_f32 v134, v134, v244
    v_mfma_f32_16x16x32_bf16 v[104:107], a[168:171], a[124:127], v[104:107]
    buffer_load_dwordx4 v21, s[16:19], s48 offen offset:1024 lds
    v_mfma_f32_16x16x32_bf16 v[84:87], a[172:175], a[76:79], v[84:87]
    v_add_f32 v134, v134, v245
    v_cvt_pk_bf16_f32 v155, v244, v245
    s_nop 0
    v_mfma_f32_16x16x32_bf16 v[92:95], a[172:175], a[92:95], v[92:95]
    buffer_load_dwordx4 v22, s[16:19], s48 offen offset:2048 lds
    v_mfma_f32_16x16x32_bf16 v[100:103], a[172:175], a[108:111], v[100:103]
    v_add_f32 v135, v135, v240
    v_add_f32 v135, v135, v241
    v_cvt_pk_bf16_f32 v159, v240, v241
    v_mfma_f32_16x16x32_bf16 v[108:111], a[172:175], a[124:127], v[108:111]
    buffer_load_dwordx4 v23, s[16:19], s48 offen offset:3072 lds
    v_max3_f32 v34, v132, v133, v134
    v_max_f32 v34, v34, v135
    v_cmp_lt_f32 vcc, s59, v34
    s_cbranch_vccnz K_rs_25
K_bk_26:
    v_add_f32 v128, v128, v132
    v_add_f32 v129, v129, v133
    v_add_f32 v130, v130, v134
    v_add_f32 v131, v131, v135
    s_waitcnt lgkmcnt(0)
    s_branch IP_sk4
IP_pg4:
    s_branch IP_ret1
IP_sk4:
    v_mfma_f32_16x16x32_bf16 v[176:179], a[128:131], v[144:147], v[176:179]
    ds_read_b64_tr_b16 a[160:161], v8 offset:24576
    v_mfma_f32_16x16x32_bf16 v[184:187], a[128:131], v[148:151], v[184:187]
    ds_read_b64_tr_b16 a[162:163], v8 offset:57344
    v_mfma_f32_16x16x32_bf16 a[0:3], a[128:131], v[152:155], a[0:3]
    ds_read_b64_tr_b16 a[164:165], v9 offset:24576
    v_mfma_f32_16x16x32_bf16 a[8:11], a[128:131], v[156:159], a[8:11]
    ds_read_b64_tr_b16 a[166:167], v9 offset:57344
    v_mfma_f32_16x16x32_bf16 v[180:183], a[132:135], v[144:147], v[180:183]
    ds_read_b64_tr_b16 a[168:169], v10 offset:24576
    v_exp_f32 v240, v80
    v_mfma_f32_16x16x32_bf16 v[188:191], a[132:135], v[148:151], v[188:191]
    ds_read_b64_tr_b16 a[170:171], v10 offset:57344
    v_mfma_f32_16x16x32_bf16 a[4:7], a[132:135], v[152:155], a[4:7]
    ds_read_b64_tr_b16 a[172:173], v11 offset:24576
    v_exp_f32 v241, v81
    v_mfma_f32_16x16x32_bf16 a[12:15], a[132:135], v[156:159], a[12:15]
    ds_read_b64_tr_b16 a[174:175], v11 offset:57344
    v_exp_f32 v242, v88
    v_mfma_f32_16x16x32_bf16 v[192:195], a[136:139], v[144:147], v[192:195]
    v_exp_f32 v243, v89
    v_mfma_f32_16x16x32_bf16 v[200:203], a[136:139], v[148:151], v[200:203]
    v_add_f32 v132, v240, v241
    v_cvt_pk_bf16_f32 v160, v240, v241
    v_mfma_f32_16x16x32_bf16 a[16:19], a[136:139], v[152:155], a[16:19]
    v_exp_f32 v244, v96
    v_exp_f32 v245, v97
    v_mfma_f32_16x16x32_bf16 a[24:27], a[136:139], v[156:159], a[24:27]
    v_add_f32 v133, v242, v243
    v_cvt_pk_bf16_f32 v164, v242, v243
    v_mfma_f32_16x16x32_bf16 v[196:199], a[140:143], v[144:147], v[196:199]
    v_exp_f32 v240, v104
    v_mfma_f32_16x16x32_bf16 v[204:207], a[140:143], v[148:151], v[204:207]
    v_exp_f32 v241, v105
    v_add_f32 v134, v244, v245
    v_mfma_f32_16x16x32_bf16 a[20:23], a[140:143], v[152:155], a[20:23]
    v_cvt_pk_bf16_f32 v168, v244, v245
    v_exp_f32 v242, v82
    v_mfma_f32_16x16x32_bf16 a[28:31], a[140:143], v[156:159], a[28:31]
    v_exp_f32 v243, v83
    s_waitcnt vmcnt(8) lgkmcnt(0)
    s_barrier
    v_mfma_f32_16x16x32_bf16 v[208:211], a[160:163], v[144:147], v[208:211]
    ds_read_b128 a[128:131], v4 offset:28672
    v_add_f32 v135, v240, v241
    v_mfma_f32_16x16x32_bf16 v[216:219], a[160:163], v[148:151], v[216:219]
    s_xor_b32 s48, s46, 32768
    v_cvt_pk_bf16_f32 v172, v240, v241
    v_mfma_f32_16x16x32_bf16 a[32:35], a[160:163], v[152:155], a[32:35]
    ds_read_b128 a[132:135], v4 offset:61440
    v_exp_f32 v244, v90
    v_mfma_f32_16x16x32_bf16 a[40:43], a[160:163], v[156:159], a[40:43]
    s_add_u32 m0, s49, 8192
    v_exp_f32 v245, v91
    v_mfma_f32_16x16x32_bf16 v[212:215], a[164:167], v[144:147], v[212:215]
    ds_read_b128 a[136:139], v5 offset:28672
    v_add_f32 v132, v132, v242
    v_mfma_f32_16x16x32_bf16 v[220:223], a[164:167], v[148:151], v[220:223]
    v_add_f32 v132, v132, v243
    v_cvt_pk_bf16_f32 v161, v242, v243
    v_mfma_f32_16x16x32_bf16 a[36:39], a[164:167], v[152:155], a[36:39]
    ds_read_b128 a[140:143], v5 offset:61440
    v_exp_f32 v240, v98
    v_mfma_f32_16x16x32_bf16 a[44:47], a[164:167], v[156:159], a[44:47]
    v_exp_f32 v241, v99
    v_add_f32 v133, v133, v244
    v_mfma_f32_16x16x32_bf16 v[224:227], a[168:171], v[144:147], v[224:227]
    v_add_f32 v133, v133, v245
    v_cvt_pk_bf16_f32 v165, v244, v245
    v_mfma_f32_16x16x32_bf16 v[232:235], a[168:171], v[148:151], v[232:235]
    buffer_load_dwordx4 v24, s[20:23], s48 offen offset:0 lds
    v_mfma_f32_16x16x32_bf16 a[48:51], a[168:171], v[152:155], a[48:51]
    v_exp_f32 v242, v106
    v_exp_f32 v243, v107
    v_mfma_f32_16x16x32_bf16 a[56:59], a[168:171], v[156:159], a[56:59]
    buffer_load_dwordx4 v25, s[20:23], s48 offen offset:1024 lds
    v_mfma_f32_16x16x32_bf16 v[228:231], a[172:175], v[144:147], v[228:231]
    v_add_f32 v134, v134, v240
    v_add_f32 v134, v134, v241
    v_mfma_f32_16x16x32_bf16 v[236:239], a[172:175], v[148:151], v[236:239]
    buffer_load_dwordx4 v24, s[20:23], s48 offen offset:2048 lds
    v_cvt_pk_bf16_f32 v169, v240, v241
    v_mfma_f32_16x16x32_bf16 a[52:55], a[172:175], v[152:155], a[52:55]
    v_exp_f32 v244, v84
    v_mfma_f32_16x16x32_bf16 a[60:63], a[172:175], v[156:159], a[60:63]
    buffer_load_dwordx4 v25, s[20:23], s48 offen offset:3072 lds
    s_waitcnt lgkmcnt(0)
    v_mfma_f32_16x16x32_bf16 v[48:51], a[128:131], a[64:67], v[112:115]
    ds_read_b128 a[160:163], v6 offset:28672
    v_exp_f32 v245, v85
    v_mfma_f32_16x16x32_bf16 v[56:59], a[128:131], a[80:83], v[116:119]
    v_add_f32 v135, v135, v242
    v_add_f32 v135, v135, v243
    v_cvt_pk_bf16_f32 v173, v242, v243
    v_mfma_f32_16x16x32_bf16 v[64:67], a[128:131], a[96:99], v[120:123]
    ds_read_b128 a[164:167], v6 offset:61440
    v_mfma_f32_16x16x32_bf16 v[72:75], a[128:131], a[112:115], v[124:127]
    v_exp_f32 v240, v92
    v_exp_f32 v241, v93
    v_mfma_f32_16x16x32_bf16 v[52:55], a[132:135], a[64:67], v[112:115]
    ds_read_b128 a[168:171], v7 offset:28672
    v_add_f32 v132, v132, v244
    v_mfma_f32_16x16x32_bf16 v[60:63], a[132:135], a[80:83], v[116:119]
    v_add_f32 v132, v132, v245
    v_cvt_pk_bf16_f32 v162, v244, v245
    v_mfma_f32_16x16x32_bf16 v[68:71], a[132:135], a[96:99], v[120:123]
    ds_read_b128 a[172:175], v7 offset:61440
    v_exp_f32 v242, v100
    v_mfma_f32_16x16x32_bf16 v[76:79], a[132:135], a[112:115], v[124:127]
    v_exp_f32 v243, v101
    v_mfma_f32_16x16x32_bf16 v[48:51], a[136:139], a[68:71], v[48:51]
    v_add_f32 v133, v133, v240
    v_add_f32 v133, v133, v241
    v_cvt_pk_bf16_f32 v166, v240, v241
    v_mfma_f32_16x16x32_bf16 v[56:59], a[136:139], a[84:87], v[56:59]
    v_exp_f32 v244, v108
    v_mfma_f32_16x16x32_bf16 v[64:67], a[136:139], a[100:103], v[64:67]
    v_exp_f32 v245, v109
    v_add_f32 v134, v134, v242
    v_mfma_f32_16x16x32_bf16 v[72:75], a[136:139], a[116:119], v[72:75]
    v_add_f32 v134, v134, v243
    v_cvt_pk_bf16_f32 v170, v242, v243
    v_mfma_f32_16x16x32_bf16 v[52:55], a[140:143], a[68:71], v[52:55]
    v_exp_f32 v240, v86
    v_mfma_f32_16x16x32_bf16 v[60:63], a[140:143], a[84:87], v[60:63]
    v_exp_f32 v241, v87
    v_add_f32 v135, v135, v244
    v_mfma_f32_16x16x32_bf16 v[68:71], a[140:143], a[100:103], v[68:71]
    v_add_f32 v135, v135, v245
    v_cvt_pk_bf16_f32 v174, v244, v245
    v_mfma_f32_16x16x32_bf16 v[76:79], a[140:143], a[116:119], v[76:79]
    v_exp_f32 v242, v94
    v_exp_f32 v243, v95
    s_waitcnt vmcnt(8) lgkmcnt(0)
    s_barrier
    v_mfma_f32_16x16x32_bf16 v[48:51], a[160:163], a[72:75], v[48:51]
    ds_read_b64_tr_b16 a[128:129], v26 offset:0
    v_add_f32 v132, v132, v240
    v_mfma_f32_16x16x32_bf16 v[56:59], a[160:163], a[88:91], v[56:59]
    ds_read_b64_tr_b16 a[130:131], v26 offset:32768
    s_xor_b32 s48, s46, 49152
    v_mfma_f32_16x16x32_bf16 v[64:67], a[160:163], a[104:107], v[64:67]
    ds_read_b64_tr_b16 a[132:133], v27 offset:0
    v_add_f32 v132, v132, v241
    v_cvt_pk_bf16_f32 v163, v240, v241
    v_mfma_f32_16x16x32_bf16 v[72:75], a[160:163], a[120:123], v[72:75]
    ds_read_b64_tr_b16 a[134:135], v27 offset:32768
    s_add_u32 m0, s49, 12288
    v_mfma_f32_16x16x32_bf16 v[52:55], a[164:167], a[72:75], v[52:55]
    ds_read_b64_tr_b16 a[136:137], v28 offset:0
    v_exp_f32 v244, v102
    v_mfma_f32_16x16x32_bf16 v[60:63], a[164:167], a[88:91], v[60:63]
    ds_read_b64_tr_b16 a[138:139], v28 offset:32768
    v_exp_f32 v245, v103
    v_mfma_f32_16x16x32_bf16 v[68:71], a[164:167], a[104:107], v[68:71]
    ds_read_b64_tr_b16 a[140:141], v29 offset:0
    v_add_f32 v133, v133, v242
    v_mfma_f32_16x16x32_bf16 v[76:79], a[164:167], a[120:123], v[76:79]
    ds_read_b64_tr_b16 a[142:143], v29 offset:32768
    v_add_f32 v133, v133, v243
    v_mfma_f32_16x16x32_bf16 v[48:51], a[168:171], a[76:79], v[48:51]
    v_cvt_pk_bf16_f32 v167, v242, v243
    v_exp_f32 v240, v110
    v_mfma_f32_16x16x32_bf16 v[56:59], a[168:171], a[92:95], v[56:59]
    buffer_load_dwordx4 v20, s[16:19], s48 offen offset:0 lds
    v_mfma_f32_16x16x32_bf16 v[64:67], a[168:171], a[108:111], v[64:67]
    v_exp_f32 v241, v111
    v_add_f32 v134, v134, v244
    v_mfma_f32_16x16x32_bf16 v[72:75], a[168:171], a[124:127], v[72:75]
    buffer_load_dwordx4 v21, s[16:19], s48 offen offset:1024 lds
    v_mfma_f32_16x16x32_bf16 v[52:55], a[172:175], a[76:79], v[52:55]
    v_add_f32 v134, v134, v245
    v_cvt_pk_bf16_f32 v171, v244, v245
    s_nop 0
    v_mfma_f32_16x16x32_bf16 v[60:63], a[172:175], a[92:95], v[60:63]
    buffer_load_dwordx4 v22, s[16:19], s48 offen offset:2048 lds
    v_mfma_f32_16x16x32_bf16 v[68:71], a[172:175], a[108:111], v[68:71]
    v_add_f32 v135, v135, v240
    v_add_f32 v135, v135, v241
    v_cvt_pk_bf16_f32 v175, v240, v241
    v_mfma_f32_16x16x32_bf16 v[76:79], a[172:175], a[124:127], v[76:79]
    buffer_load_dwordx4 v23, s[16:19], s48 offen offset:3072 lds
    v_max3_f32 v34, v132, v133, v134
    v_max_f32 v34, v34, v135
    v_cmp_lt_f32 vcc, s59, v34
    s_cbranch_vccnz K_rs_27
K_bk_28:
    v_add_f32 v128, v128, v132
    v_add_f32 v129, v129, v133
    v_add_f32 v130, v130, v134
    v_add_f32 v131, v131, v135
    s_waitcnt lgkmcnt(0)
    v_mfma_f32_16x16x32_bf16 v[176:179], a[128:131], v[160:163], v[176:179]
    ds_read_b64_tr_b16 a[160:161], v8 offset:0
    v_mfma_f32_16x16x32_bf16 v[184:187], a[128:131], v[164:167], v[184:187]
    ds_read_b64_tr_b16 a[162:163], v8 offset:32768
    v_mfma_f32_16x16x32_bf16 a[0:3], a[128:131], v[168:171], a[0:3]
    ds_read_b64_tr_b16 a[164:165], v9 offset:0
    v_mfma_f32_16x16x32_bf16 a[8:11], a[128:131], v[172:175], a[8:11]
    ds_read_b64_tr_b16 a[166:167], v9 offset:32768
    v_mfma_f32_16x16x32_bf16 v[180:183], a[132:135], v[160:163], v[180:183]
    ds_read_b64_tr_b16 a[168:169], v10 offset:0
    v_exp_f32 v240, v48
    v_mfma_f32_16x16x32_bf16 v[188:191], a[132:135], v[164:167], v[188:191]
    ds_read_b64_tr_b16 a[170:171], v10 offset:32768
    v_mfma_f32_16x16x32_bf16 a[4:7], a[132:135], v[168:171], a[4:7]
    ds_read_b64_tr_b16 a[172:173], v11 offset:0
    v_exp_f32 v241, v49
    v_mfma_f32_16x16x32_bf16 a[12:15], a[132:135], v[172:175], a[12:15]
    ds_read_b64_tr_b16 a[174:175], v11 offset:32768
    v_exp_f32 v242, v56
    v_mfma_f32_16x16x32_bf16 v[192:195], a[136:139], v[160:163], v[192:195]
    v_exp_f32 v243, v57
    v_mfma_f32_16x16x32_bf16 v[200:203], a[136:139], v[164:167], v[200:203]
    v_add_f32 v132, v240, v241
    v_cvt_pk_bf16_f32 v144, v240, v241
    v_mfma_f32_16x16x32_bf16 a[16:19], a[136:139], v[168:171], a[16:19]
    v_exp_f32 v244, v64
    v_exp_f32 v245, v65
    v_mfma_f32_16x16x32_bf16 a[24:27], a[136:139], v[172:175], a[24:27]
    v_add_f32 v133, v242, v243
    v_cvt_pk_bf16_f32 v148, v242, v243
    v_mfma_f32_16x16x32_bf16 v[196:199], a[140:143], v[160:163], v[196:199]
    v_exp_f32 v240, v72
    v_mfma_f32_16x16x32_bf16 v[204:207], a[140:143], v[164:167], v[204:207]
    v_exp_f32 v241, v73
    v_add_f32 v134, v244, v245
    v_mfma_f32_16x16x32_bf16 a[20:23], a[140:143], v[168:171], a[20:23]
    v_cvt_pk_bf16_f32 v152, v244, v245
    v_exp_f32 v242, v50
    v_mfma_f32_16x16x32_bf16 a[28:31], a[140:143], v[172:175], a[28:31]
    v_exp_f32 v243, v51
    s_waitcnt vmcnt(8) lgkmcnt(0)
    s_barrier
    v_mfma_f32_16x16x32_bf16 v[208:211], a[160:163], v[160:163], v[208:211]
    ds_read_b128 a[128:131], v4 offset:4096
    v_add_f32 v135, v240, v241
    v_mfma_f32_16x16x32_bf16 v[216:219], a[160:163], v[164:167], v[216:219]
    s_xor_b32 s48, s46, 40960
    v_cvt_pk_bf16_f32 v156, v240, v241
    v_mfma_f32_16x16x32_bf16 a[32:35], a[160:163], v[168:171], a[32:35]
    ds_read_b128 a[132:135], v4 offset:36864
    v_exp_f32 v244, v58
    v_mfma_f32_16x16x32_bf16 a[40:43], a[160:163], v[172:175], a[40:43]
    s_add_u32 m0, s49, 16384
    v_exp_f32 v245, v59
    v_mfma_f32_16x16x32_bf16 v[212:215], a[164:167], v[160:163], v[212:215]
    ds_read_b128 a[136:139], v5 offset:4096
    v_add_f32 v132, v132, v242
    v_mfma_f32_16x16x32_bf16 v[220:223], a[164:167], v[164:167], v[220:223]
    v_add_f32 v132, v132, v243
    v_cvt_pk_bf16_f32 v145, v242, v243
    v_mfma_f32_16x16x32_bf16 a[36:39], a[164:167], v[168:171], a[36:39]
    ds_read_b128 a[140:143], v5 offset:36864
    v_exp_f32 v240, v66
    v_mfma_f32_16x16x32_bf16 a[44:47], a[164:167], v[172:175], a[44:47]
    v_exp_f32 v241, v67
    v_add_f32 v133, v133, v244
    v_mfma_f32_16x16x32_bf16 v[224:227], a[168:171], v[160:163], v[224:227]
    v_add_f32 v133, v133, v245
    v_cvt_pk_bf16_f32 v149, v244, v245
    v_mfma_f32_16x16x32_bf16 v[232:235], a[168:171], v[164:167], v[232:235]
    buffer_load_dwordx4 v24, s[20:23], s48 offen offset:0 lds
    v_mfma_f32_16x16x32_bf16 a[48:51], a[168:171], v[168:171], a[48:51]
    v_exp_f32 v242, v74
    v_exp_f32 v243, v75
    v_mfma_f32_16x16x32_bf16 a[56:59], a[168:171], v[172:175], a[56:59]
    buffer_load_dwordx4 v25, s[20:23], s48 offen offset:1024 lds
    v_mfma_f32_16x16x32_bf16 v[228:231], a[172:175], v[160:163], v[228:231]
    v_add_f32 v134, v134, v240
    v_add_f32 v134, v134, v241
    v_mfma_f32_16x16x32_bf16 v[236:239], a[172:175], v[164:167], v[236:239]
    buffer_load_dwordx4 v24, s[20:23], s48 offen offset:2048 lds
    v_cvt_pk_bf16_f32 v153, v240, v241
    v_mfma_f32_16x16x32_bf16 a[52:55], a[172:175], v[168:171], a[52:55]
    v_exp_f32 v244, v52
    v_mfma_f32_16x16x32_bf16 a[60:63], a[172:175], v[172:175], a[60:63]
    buffer_load_dwordx4 v25, s[20:23], s48 offen offset:3072 lds
    s_waitcnt lgkmcnt(0)
    v_mfma_f32_16x16x32_bf16 v[80:83], a[128:131], a[64:67], v[112:115]
    ds_read_b128 a[160:163], v6 offset:4096
    v_exp_f32 v245, v53
    v_mfma_f32_16x16x32_bf16 v[88:91], a[128:131], a[80:83], v[116:119]
    v_add_f32 v135, v135, v242
    v_add_f32 v135, v135, v243
    v_cvt_pk_bf16_f32 v157, v242, v243
    v_mfma_f32_16x16x32_bf16 v[96:99], a[128:131], a[96:99], v[120:123]
    ds_read_b128 a[164:167], v6 offset:36864
    v_mfma_f32_16x16x32_bf16 v[104:107], a[128:131], a[112:115], v[124:127]
    v_exp_f32 v240, v60
    v_exp_f32 v241, v61
    v_mfma_f32_16x16x32_bf16 v[84:87], a[132:135], a[64:67], v[112:115]
    ds_read_b128 a[168:171], v7 offset:4096
    v_add_f32 v132, v132, v244
    v_mfma_f32_16x16x32_bf16 v[92:95], a[132:135], a[80:83], v[116:119]
    v_add_f32 v132, v132, v245
    v_cvt_pk_bf16_f32 v146, v244, v245
    v_mfma_f32_16x16x32_bf16 v[100:103], a[132:135], a[96:99], v[120:123]
    ds_read_b128 a[172:175], v7 offset:36864
    v_exp_f32 v242, v68
    v_mfma_f32_16x16x32_bf16 v[108:111], a[132:135], a[112:115], v[124:127]
    v_exp_f32 v243, v69
    v_mfma_f32_16x16x32_bf16 v[80:83], a[136:139], a[68:71], v[80:83]
    v_add_f32 v133, v133, v240
    v_add_f32 v133, v133, v241
    v_cvt_pk_bf16_f32 v150, v240, v241
    v_mfma_f32_16x16x32_bf16 v[88:91], a[136:139], a[84:87], v[88:91]
    v_exp_f32 v244, v76
    v_mfma_f32_16x16x32_bf16 v[96:99], a[136:139], a[100:103], v[96:99]
    v_exp_f32 v245, v77
    v_add_f32 v134, v134, v242
    v_mfma_f32_16x16x32_bf16 v[104:107], a[136:139], a[116:119], v[104:107]
    v_add_f32 v134, v134, v243
    v_cvt_pk_bf16_f32 v154, v242, v243
    v_mfma_f32_16x16x32_bf16 v[84:87], a[140:143], a[68:71], v[84:87]
    v_exp_f32 v240, v54
    v_mfma_f32_16x16x32_bf16 v[92:95], a[140:143], a[84:87], v[92:95]
    v_exp_f32 v241, v55
    v_add_f32 v135, v135, v244
    v_mfma_f32_16x16x32_bf16 v[100:103], a[140:143], a[100:103], v[100:103]
    v_add_f32 v135, v135, v245
    v_cvt_pk_bf16_f32 v158, v244, v245
    v_mfma_f32_16x16x32_bf16 v[108:111], a[140:143], a[116:119], v[108:111]
    v_exp_f32 v242, v62
    v_exp_f32 v243, v63
    s_waitcnt vmcnt(8) lgkmcnt(0)
    s_barrier
    v_mfma_f32_16x16x32_bf16 v[80:83], a[160:163], a[72:75], v[80:83]
    ds_read_b64_tr_b16 a[128:129], v26 offset:8192
    v_add_f32 v132, v132, v240
    v_mfma_f32_16x16x32_bf16 v[88:91], a[160:163], a[88:91], v[88:91]
    ds_read_b64_tr_b16 a[130:131], v26 offset:40960
    s_xor_b32 s48, s46, 57344
    v_mfma_f32_16x16x32_bf16 v[96:99], a[160:163], a[104:107], v[96:99]
    ds_read_b64_tr_b16 a[132:133], v27 offset:8192
    v_add_f32 v132, v132, v241
    v_cvt_pk_bf16_f32 v147, v240, v241
    v_mfma_f32_16x16x32_bf16 v[104:107], a[160:163], a[120:123], v[104:107]
    ds_read_b64_tr_b16 a[134:135], v27 offset:40960
    s_add_u32 m0, s49, 20480
    v_mfma_f32_16x16x32_bf16 v[84:87], a[164:167], a[72:75], v[84:87]
    ds_read_b64_tr_b16 a[136:137], v28 offset:8192
    v_exp_f32 v244, v70
    v_mfma_f32_16x16x32_bf16 v[92:95], a[164:167], a[88:91], v[92:95]
    ds_read_b64_tr_b16 a[138:139], v28 offset:40960
    v_exp_f32 v245, v71
    v_mfma_f32_16x16x32_bf16 v[100:103], a[164:167], a[104:107], v[100:103]
    ds_read_b64_tr_b16 a[140:141], v29 offset:8192
    v_add_f32 v133, v133, v242
    v_mfma_f32_16x16x32_bf16 v[108:111], a[164:167], a[120:123], v[108:111]
    ds_read_b64_tr_b16 a[142:143], v29 offset:40960
    v_add_f32 v133, v133, v243
    v_mfma_f32_16x16x32_bf16 v[80:83], a[168:171], a[76:79], v[80:83]
    v_cvt_pk_bf16_f32 v151, v242, v243
    v_exp_f32 v240, v78
    v_mfma_f32_16x16x32_bf16 v[88:91], a[168:171], a[92:95], v[88:91]
    buffer_load_dwordx4 v20, s[16:19], s48 offen offset:0 lds
    v_mfma_f32_16x16x32_bf16 v[96:99], a[168:171], a[108:111], v[96:99]
    v_exp_f32 v241, v79
    v_add_f32 v134, v134, v244
    v_mfma_f32_16x16x32_bf16 v[104:107], a[168:171], a[124:127], v[104:107]
    buffer_load_dwordx4 v21, s[16:19], s48 offen offset:1024 lds
    v_mfma_f32_16x16x32_bf16 v[84:87], a[172:175], a[76:79], v[84:87]
    v_add_f32 v134, v134, v245
    v_cvt_pk_bf16_f32 v155, v244, v245
    s_nop 0
    v_mfma_f32_16x16x32_bf16 v[92:95], a[172:175], a[92:95], v[92:95]
    buffer_load_dwordx4 v22, s[16:19], s48 offen offset:2048 lds
    v_mfma_f32_16x16x32_bf16 v[100:103], a[172:175], a[108:111], v[100:103]
    v_add_f32 v135, v135, v240
    v_add_f32 v135, v135, v241
    v_cvt_pk_bf16_f32 v159, v240, v241
    v_mfma_f32_16x16x32_bf16 v[108:111], a[172:175], a[124:127], v[108:111]
    buffer_load_dwordx4 v23, s[16:19], s48 offen offset:3072 lds
    v_max3_f32 v34, v132, v133, v134
    v_max_f32 v34, v34, v135
    v_cmp_lt_f32 vcc, s59, v34
    s_cbranch_vccnz K_rs_29
K_bk_30:
    v_add_f32 v128, v128, v132
    v_add_f32 v129, v129, v133
    v_add_f32 v130, v130, v134
    v_add_f32 v131, v131, v135
    s_waitcnt lgkmcnt(0)
    v_mfma_f32_16x16x32_bf16 v[176:179], a[128:131], v[144:147], v[176:179]
    ds_read_b64_tr_b16 a[160:161], v8 offset:8192
    v_mfma_f32_16x16x32_bf16 v[184:187], a[128:131], v[148:151], v[184:187]
    ds_read_b64_tr_b16 a[162:163], v8 offset:40960
    s_xor_b32 s48, s46, 49152
    v_mfma_f32_16x16x32_bf16 a[0:3], a[128:131], v[152:155], a[0:3]
    ds_read_b64_tr_b16 a[164:165], v9 offset:8192
    v_mfma_f32_16x16x32_bf16 a[8:11], a[128:131], v[156:159], a[8:11]
    ds_read_b64_tr_b16 a[166:167], v9 offset:40960
    s_add_u32 m0, s49, 24576
    v_mfma_f32_16x16x32_bf16 v[180:183], a[132:135], v[144:147], v[180:183]
    ds_read_b64_tr_b16 a[168:169], v10 offset:8192
    v_exp_f32 v240, v80
    v_mfma_f32_16x16x32_bf16 v[188:191], a[132:135], v[148:151], v[188:191]
    ds_read_b64_tr_b16 a[170:171], v10 offset:40960
    v_mfma_f32_16x16x32_bf16 a[4:7], a[132:135], v[152:155], a[4:7]
    ds_read_b64_tr_b16 a[172:173], v11 offset:8192
    v_exp_f32 v241, v81
    v_mfma_f32_16x16x32_bf16 a[12:15], a[132:135], v[156:159], a[12:15]
    ds_read_b64_tr_b16 a[174:175], v11 offset:40960
    v_exp_f32 v242, v88
    v_mfma_f32_16x16x32_bf16 v[192:195], a[136:139], v[144:147], v[192:195]
    v_exp_f32 v243, v89
    v_mfma_f32_16x16x32_bf16 v[200:203], a[136:139], v[148:151], v[200:203]
    buffer_load_dwordx4 v24, s[20:23], s48 offen offset:0 lds
    v_add_f32 v132, v240, v241
    v_mfma_f32_16x16x32_bf16 a[16:19], a[136:139], v[152:155], a[16:19]
    v_cvt_pk_bf16_f32 v160, v240, v241
    v_exp_f32 v244, v96
    v_mfma_f32_16x16x32_bf16 a[24:27], a[136:139], v[156:159], a[24:27]
    buffer_load_dwordx4 v25, s[20:23], s48 offen offset:1024 lds
    v_mfma_f32_16x16x32_bf16 v[196:199], a[140:143], v[144:147], v[196:199]
    v_exp_f32 v245, v97
    v_mfma_f32_16x16x32_bf16 v[204:207], a[140:143], v[148:151], v[204:207]
    buffer_load_dwordx4 v24, s[20:23], s48 offen offset:2048 lds
    v_add_f32 v133, v242, v243
    v_mfma_f32_16x16x32_bf16 a[20:23], a[140:143], v[152:155], a[20:23]
    v_cvt_pk_bf16_f32 v164, v242, v243
    v_mfma_f32_16x16x32_bf16 a[28:31], a[140:143], v[156:159], a[28:31]
    buffer_load_dwordx4 v25, s[20:23], s48 offen offset:3072 lds
    v_exp_f32 v240, v104
    s_waitcnt vmcnt(12) lgkmcnt(0)
    s_barrier
    v_mfma_f32_16x16x32_bf16 v[208:211], a[160:163], v[144:147], v[208:211]
    ds_read_b128 a[128:131], v4 offset:12288
    v_mfma_f32_16x16x32_bf16 v[216:219], a[160:163], v[148:151], v[216:219]
    v_exp_f32 v241, v105
    v_add_f32 v134, v244, v245
    v_mfma_f32_16x16x32_bf16 a[32:35], a[160:163], v[152:155], a[32:35]
    ds_read_b128 a[132:135], v4 offset:45056
    v_cvt_pk_bf16_f32 v168, v244, v245
    v_mfma_f32_16x16x32_bf16 a[40:43], a[160:163], v[156:159], a[40:43]
    v_exp_f32 v242, v82
    v_exp_f32 v243, v83
    v_mfma_f32_16x16x32_bf16 v[212:215], a[164:167], v[144:147], v[212:215]
    ds_read_b128 a[136:139], v5 offset:12288
    v_add_f32 v135, v240, v241
    v_mfma_f32_16x16x32_bf16 v[220:223], a[164:167], v[148:151], v[220:223]
    v_cvt_pk_bf16_f32 v172, v240, v241
    v_exp_f32 v244, v90
    v_mfma_f32_16x16x32_bf16 a[36:39], a[164:167], v[152:155], a[36:39]
    ds_read_b128 a[140:143], v5 offset:45056
    v_mfma_f32_16x16x32_bf16 a[44:47], a[164:167], v[156:159], a[44:47]
    v_exp_f32 v245, v91
    v_add_f32 v132, v132, v242
    v_mfma_f32_16x16x32_bf16 v[224:227], a[168:171], v[144:147], v[224:227]
    v_add_f32 v132, v132, v243
    v_cvt_pk_bf16_f32 v161, v242, v243
    v_mfma_f32_16x16x32_bf16 v[232:235], a[168:171], v[148:151], v[232:235]
    v_exp_f32 v240, v98
    v_mfma_f32_16x16x32_bf16 a[48:51], a[168:171], v[152:155], a[48:51]
    v_exp_f32 v241, v99
    v_add_f32 v133, v133, v244
    v_mfma_f32_16x16x32_bf16 a[56:59], a[168:171], v[156:159], a[56:59]
    v_add_f32 v133, v133, v245
    v_cvt_pk_bf16_f32 v165, v244, v245
    v_mfma_f32_16x16x32_bf16 v[228:231], a[172:175], v[144:147], v[228:231]
    v_exp_f32 v242, v106
    v_exp_f32 v243, v107
    v_mfma_f32_16x16x32_bf16 v[236:239], a[172:175], v[148:151], v[236:239]
    v_add_f32 v134, v134, v240
    v_add_f32 v134, v134, v241
    v_mfma_f32_16x16x32_bf16 a[52:55], a[172:175], v[152:155], a[52:55]
    v_cvt_pk_bf16_f32 v169, v240, v241
    v_exp_f32 v244, v84
    v_mfma_f32_16x16x32_bf16 a[60:63], a[172:175], v[156:159], a[60:63]
    v_exp_f32 v245, v85
    s_waitcnt lgkmcnt(0)
    v_mfma_f32_16x16x32_bf16 v[48:51], a[128:131], a[64:67], v[112:115]
    ds_read_b128 a[160:163], v6 offset:12288
    v_add_f32 v135, v135, v242
    v_mfma_f32_16x16x32_bf16 v[56:59], a[128:131], a[80:83], v[116:119]
    s_xor_b32 s48, s46, 57344
    v_add_f32 v135, v135, v243
    v_cvt_pk_bf16_f32 v173, v242, v243
    v_mfma_f32_16x16x32_bf16 v[64:67], a[128:131], a[96:99], v[120:123]
    ds_read_b128 a[164:167], v6 offset:45056
    v_mfma_f32_16x16x32_bf16 v[72:75], a[128:131], a[112:115], v[124:127]
    s_add_u32 m0, s49, 28672
    v_exp_f32 v240, v92
    v_mfma_f32_16x16x32_bf16 v[52:55], a[132:135], a[64:67], v[112:115]
    ds_read_b128 a[168:171], v7 offset:12288
    v_exp_f32 v241, v93
    v_mfma_f32_16x16x32_bf16 v[60:63], a[132:135], a[80:83], v[116:119]
    v_add_f32 v132, v132, v244
    v_add_f32 v132, v132, v245
    v_mfma_f32_16x16x32_bf16 v[68:71], a[132:135], a[96:99], v[120:123]
    ds_read_b128 a[172:175], v7 offset:45056
    v_cvt_pk_bf16_f32 v162, v244, v245
    v_mfma_f32_16x16x32_bf16 v[76:79], a[132:135], a[112:115], v[124:127]
    v_exp_f32 v242, v100
    v_exp_f32 v243, v101
    v_mfma_f32_16x16x32_bf16 v[48:51], a[136:139], a[68:71], v[48:51]
    v_add_f32 v133, v133, v240
    v_add_f32 v133, v133, v241
    v_mfma_f32_16x16x32_bf16 v[56:59], a[136:139], a[84:87], v[56:59]
    buffer_load_dwordx4 v24, s[20:23], s48 offen offset:0 lds
    v_mfma_f32_16x16x32_bf16 v[64:67], a[136:139], a[100:103], v[64:67]
    v_cvt_pk_bf16_f32 v166, v240, v241
    v_exp_f32 v244, v108
    v_mfma_f32_16x16x32_bf16 v[72:75], a[136:139], a[116:119], v[72:75]
    buffer_load_dwordx4 v25, s[20:23], s48 offen offset:1024 lds
    v_mfma_f32_16x16x32_bf16 v[52:55], a[140:143], a[68:71], v[52:55]
    v_exp_f32 v245, v109
    v_mfma_f32_16x16x32_bf16 v[60:63], a[140:143], a[84:87], v[60:63]
    buffer_load_dwordx4 v24, s[20:23], s48 offen offset:2048 lds
    v_add_f32 v134, v134, v242
    v_mfma_f32_16x16x32_bf16 v[68:71], a[140:143], a[100:103], v[68:71]
    v_add_f32 v134, v134, v243
    v_cvt_pk_bf16_f32 v170, v242, v243
    v_mfma_f32_16x16x32_bf16 v[76:79], a[140:143], a[116:119], v[76:79]
    buffer_load_dwordx4 v25, s[20:23], s48 offen offset:3072 lds
    s_waitcnt vmcnt(12) lgkmcnt(0)
    s_barrier
    v_mfma_f32_16x16x32_bf16 v[48:51], a[160:163], a[72:75], v[48:51]
    ds_read_b64_tr_b16 a[128:129], v26 offset:16384
    v_exp_f32 v240, v86
    v_mfma_f32_16x16x32_bf16 v[56:59], a[160:163], a[88:91], v[56:59]
    ds_read_b64_tr_b16 a[130:131], v26 offset:49152
    v_exp_f32 v241, v87
    v_mfma_f32_16x16x32_bf16 v[64:67], a[160:163], a[104:107], v[64:67]
    ds_read_b64_tr_b16 a[132:133], v27 offset:16384
    v_add_f32 v135, v135, v244
    v_mfma_f32_16x16x32_bf16 v[72:75], a[160:163], a[120:123], v[72:75]
    ds_read_b64_tr_b16 a[134:135], v27 offset:49152
    v_add_f32 v135, v135, v245
    v_cvt_pk_bf16_f32 v174, v244, v245
    v_mfma_f32_16x16x32_bf16 v[52:55], a[164:167], a[72:75], v[52:55]
    ds_read_b64_tr_b16 a[136:137], v28 offset:16384
    v_exp_f32 v242, v94
    v_mfma_f32_16x16x32_bf16 v[60:63], a[164:167], a[88:91], v[60:63]
    ds_read_b64_tr_b16 a[138:139], v28 offset:49152
    v_mfma_f32_16x16x32_bf16 v[68:71], a[164:167], a[104:107], v[68:71]
    ds_read_b64_tr_b16 a[140:141], v29 offset:16384
    v_exp_f32 v243, v95
    v_mfma_f32_16x16x32_bf16 v[76:79], a[164:167], a[120:123], v[76:79]
    ds_read_b64_tr_b16 a[142:143], v29 offset:49152
    v_add_f32 v132, v132, v240
    v_mfma_f32_16x16x32_bf16 v[48:51], a[168:171], a[76:79], v[48:51]
    v_add_f32 v132, v132, v241
    v_cvt_pk_bf16_f32 v163, v240, v241
    v_mfma_f32_16x16x32_bf16 v[56:59], a[168:171], a[92:95], v[56:59]
    v_exp_f32 v244, v102
    v_exp_f32 v245, v103
    v_mfma_f32_16x16x32_bf16 v[64:67], a[168:171], a[108:111], v[64:67]
    v_add_f32 v133, v133, v242
    v_add_f32 v133, v133, v243
    v_mfma_f32_16x16x32_bf16 v[72:75], a[168:171], a[124:127], v[72:75]
    v_cvt_pk_bf16_f32 v167, v242, v243
    v_exp_f32 v240, v110
    v_mfma_f32_16x16x32_bf16 v[52:55], a[172:175], a[76:79], v[52:55]
    v_exp_f32 v241, v111
    v_mfma_f32_16x16x32_bf16 v[60:63], a[172:175], a[92:95], v[60:63]
    v_add_f32 v134, v134, v244
    v_add_f32 v134, v134, v245
    v_mfma_f32_16x16x32_bf16 v[68:71], a[172:175], a[108:111], v[68:71]
    v_cvt_pk_bf16_f32 v171, v244, v245
    s_nop 0
    v_add_f32 v135, v135, v240
    v_mfma_f32_16x16x32_bf16 v[76:79], a[172:175], a[124:127], v[76:79]
    v_add_f32 v135, v135, v241
    v_cvt_pk_bf16_f32 v175, v240, v241
    v_max3_f32 v34, v132, v133, v134
    v_max_f32 v34, v34, v135
    v_cmp_lt_f32 vcc, s59, v34
    s_cbranch_vccnz K_rs_31
K_bk_32:
    v_add_f32 v128, v128, v132
    v_add_f32 v129, v129, v133
    v_add_f32 v130, v130, v134
    v_add_f32 v131, v131, v135
    s_waitcnt lgkmcnt(0)
    v_mfma_f32_16x16x32_bf16 v[176:179], a[128:131], v[160:163], v[176:179]
    ds_read_b64_tr_b16 a[160:161], v8 offset:16384
    v_mfma_f32_16x16x32_bf16 v[184:187], a[128:131], v[164:167], v[184:187]
    ds_read_b64_tr_b16 a[162:163], v8 offset:49152
    s_bfe_u32 s45, s100, 0x40000
    v_mfma_f32_16x16x32_bf16 a[0:3], a[128:131], v[168:171], a[0:3]
    ds_read_b64_tr_b16 a[164:165], v9 offset:16384
    v_mfma_f32_16x16x32_bf16 a[8:11], a[128:131], v[172:175], a[8:11]
    ds_read_b64_tr_b16 a[166:167], v9 offset:49152
    s_lshl_b32 s45, s45, 17
    v_mfma_f32_16x16x32_bf16 v[180:183], a[132:135], v[160:163], v[180:183]
    ds_read_b64_tr_b16 a[168:169], v10 offset:16384
    v_exp_f32 v240, v48
    v_mfma_f32_16x16x32_bf16 v[188:191], a[132:135], v[164:167], v[188:191]
    ds_read_b64_tr_b16 a[170:171], v10 offset:49152
    s_add_u32 s45, s45, s40
    v_mfma_f32_16x16x32_bf16 a[4:7], a[132:135], v[168:171], a[4:7]
    ds_read_b64_tr_b16 a[172:173], v11 offset:16384
    v_exp_f32 v241, v49
    v_mfma_f32_16x16x32_bf16 a[12:15], a[132:135], v[172:175], a[12:15]
    ds_read_b64_tr_b16 a[174:175], v11 offset:49152
    s_add_u32 m0, s49, 0
    v_mfma_f32_16x16x32_bf16 v[192:195], a[136:139], v[160:163], v[192:195]
    buffer_load_dword v31, v247, s[24:27], s55 offen sc1
    v_mfma_f32_16x16x32_bf16 v[200:203], a[136:139], v[164:167], v[200:203]
    buffer_load_dwordx4 v248, s[96:99], s45 offen offset:0 lds
    v_exp_f32 v242, v56
    v_mfma_f32_16x16x32_bf16 a[16:19], a[136:139], v[168:171], a[16:19]
    v_exp_f32 v243, v57
    v_mfma_f32_16x16x32_bf16 a[24:27], a[136:139], v[172:175], a[24:27]
    buffer_load_dwordx4 v249, s[96:99], s45 offen offset:1024 lds
    v_mfma_f32_16x16x32_bf16 v[196:199], a[140:143], v[160:163], v[196:199]
    v_add_f32 v132, v240, v241
    v_cvt_pk_bf16_f32 v144, v240, v241
    v_mfma_f32_16x16x32_bf16 v[204:207], a[140:143], v[164:167], v[204:207]
    buffer_load_dwordx4 v250, s[96:99], s45 offen offset:2048 lds
    v_exp_f32 v244, v64
    v_mfma_f32_16x16x32_bf16 a[20:23], a[140:143], v[168:171], a[20:23]
    v_exp_f32 v245, v65
    v_mfma_f32_16x16x32_bf16 a[28:31], a[140:143], v[172:175], a[28:31]
    buffer_load_dwordx4 v251, s[96:99], s45 offen offset:3072 lds
    v_add_f32 v133, v242, v243
    s_waitcnt vmcnt(13) lgkmcnt(0)
    s_barrier
    v_mfma_f32_16x16x32_bf16 v[208:211], a[160:163], v[160:163], v[208:211]
    ds_read_b128 a[128:131], v4 offset:20480
    v_cvt_pk_bf16_f32 v148, v242, v243
    v_mfma_f32_16x16x32_bf16 v[216:219], a[160:163], v[164:167], v[216:219]
    v_exp_f32 v240, v72
    v_mfma_f32_16x16x32_bf16 a[32:35], a[160:163], v[168:171], a[32:35]
    ds_read_b128 a[132:135], v4 offset:53248
    v_exp_f32 v241, v73
    v_mfma_f32_16x16x32_bf16 a[40:43], a[160:163], v[172:175], a[40:43]
    v_add_f32 v134, v244, v245
    v_cvt_pk_bf16_f32 v152, v244, v245
    v_mfma_f32_16x16x32_bf16 v[212:215], a[164:167], v[160:163], v[212:215]
    ds_read_b128 a[136:139], v5 offset:20480
    s_branch IP_sk5
IP_pg5:
    s_branch IP_ret5
IP_sk5:
    v_exp_f32 v242, v50
    v_mfma_f32_16x16x32_bf16 v[220:223], a[164:167], v[164:167], v[220:223]
    v_exp_f32 v243, v51
    v_add_f32 v135, v240, v241
    v_mfma_f32_16x16x32_bf16 a[36:39], a[164:167], v[168:171], a[36:39]
    ds_read_b128 a[140:143], v5 offset:53248
    v_cvt_pk_bf16_f32 v156, v240, v241
    v_mfma_f32_16x16x32_bf16 a[44:47], a[164:167], v[172:175], a[44:47]
    v_exp_f32 v244, v58
    v_exp_f32 v245, v59
    v_mfma_f32_16x16x32_bf16 v[224:227], a[168:171], v[160:163], v[224:227]
    v_add_f32 v132, v132, v242
    v_add_f32 v132, v132, v243
    v_mfma_f32_16x16x32_bf16 v[232:235], a[168:171], v[164:167], v[232:235]
    v_cvt_pk_bf16_f32 v145, v242, v243
    v_exp_f32 v240, v66
    v_mfma_f32_16x16x32_bf16 a[48:51], a[168:171], v[168:171], a[48:51]
    v_exp_f32 v241, v67
    v_mfma_f32_16x16x32_bf16 a[56:59], a[168:171], v[172:175], a[56:59]
    v_add_f32 v133, v133, v244
    v_add_f32 v133, v133, v245
    v_mfma_f32_16x16x32_bf16 v[228:231], a[172:175], v[160:163], v[228:231]
    v_cvt_pk_bf16_f32 v149, v244, v245
    v_exp_f32 v242, v74
    v_mfma_f32_16x16x32_bf16 v[236:239], a[172:175], v[164:167], v[236:239]
    v_exp_f32 v243, v75
    v_mfma_f32_16x16x32_bf16 a[52:55], a[172:175], v[168:171], a[52:55]
    v_add_f32 v134, v134, v240
    v_add_f32 v134, v134, v241
    v_cvt_pk_bf16_f32 v153, v240, v241
    v_mfma_f32_16x16x32_bf16 a[60:63], a[172:175], v[172:175], a[60:63]
    v_exp_f32 v244, v52
    s_waitcnt lgkmcnt(0)
    v_mfma_f32_16x16x32_bf16 v[80:83], a[128:131], a[64:67], v[112:115]
    ds_read_b128 a[160:163], v6 offset:20480
    v_exp_f32 v245, v53
    v_mfma_f32_16x16x32_bf16 v[88:91], a[128:131], a[80:83], v[116:119]
    s_bfe_u32 s45, s100, 0x40004
    v_add_f32 v135, v135, v242
    v_add_f32 v135, v135, v243
    v_mfma_f32_16x16x32_bf16 v[96:99], a[128:131], a[96:99], v[120:123]
    ds_read_b128 a[164:167], v6 offset:53248
    v_cvt_pk_bf16_f32 v157, v242, v243
    v_mfma_f32_16x16x32_bf16 v[104:107], a[128:131], a[112:115], v[124:127]
    s_lshl_b32 s45, s45, 17
    v_exp_f32 v240, v60
    v_mfma_f32_16x16x32_bf16 v[84:87], a[132:135], a[64:67], v[112:115]
    ds_read_b128 a[168:171], v7 offset:20480
    v_exp_f32 v241, v61
    v_mfma_f32_16x16x32_bf16 v[92:95], a[132:135], a[80:83], v[116:119]
    s_add_u32 s45, s45, s40
    v_add_f32 v132, v132, v244
    v_mfma_f32_16x16x32_bf16 v[100:103], a[132:135], a[96:99], v[120:123]
    ds_read_b128 a[172:175], v7 offset:53248
    v_add_f32 v132, v132, v245
    v_mfma_f32_16x16x32_bf16 v[108:111], a[132:135], a[112:115], v[124:127]
    s_add_u32 m0, s49, 4096
    v_cvt_pk_bf16_f32 v146, v244, v245
    v_mfma_f32_16x16x32_bf16 v[80:83], a[136:139], a[68:71], v[80:83]
    v_exp_f32 v242, v68
    v_exp_f32 v243, v69
    v_mfma_f32_16x16x32_bf16 v[88:91], a[136:139], a[84:87], v[88:91]
    buffer_load_dwordx4 v248, s[96:99], s45 offen offset:0 lds
    v_mfma_f32_16x16x32_bf16 v[96:99], a[136:139], a[100:103], v[96:99]
    v_add_f32 v133, v133, v240
    v_add_f32 v133, v133, v241
    v_mfma_f32_16x16x32_bf16 v[104:107], a[136:139], a[116:119], v[104:107]
    buffer_load_dwordx4 v249, s[96:99], s45 offen offset:1024 lds
    v_cvt_pk_bf16_f32 v150, v240, v241
    v_mfma_f32_16x16x32_bf16 v[84:87], a[140:143], a[68:71], v[84:87]
    v_exp_f32 v244, v76
    v_mfma_f32_16x16x32_bf16 v[92:95], a[140:143], a[84:87], v[92:95]
    buffer_load_dwordx4 v250, s[96:99], s45 offen offset:2048 lds
    v_exp_f32 v245, v77
    v_mfma_f32_16x16x32_bf16 v[100:103], a[140:143], a[100:103], v[100:103]
    v_add_f32 v134, v134, v242
    v_add_f32 v134, v134, v243
    v_mfma_f32_16x16x32_bf16 v[108:111], a[140:143], a[116:119], v[108:111]
    buffer_load_dwordx4 v251, s[96:99], s45 offen offset:3072 lds
    s_waitcnt vmcnt(13) lgkmcnt(0)
    s_barrier
    v_mfma_f32_16x16x32_bf16 v[80:83], a[160:163], a[72:75], v[80:83]
    ds_read_b64_tr_b16 a[128:129], v26 offset:24576
    v_cvt_pk_bf16_f32 v154, v242, v243
    v_mfma_f32_16x16x32_bf16 v[88:91], a[160:163], a[88:91], v[88:91]
    ds_read_b64_tr_b16 a[130:131], v26 offset:57344
    v_exp_f32 v240, v54
    v_mfma_f32_16x16x32_bf16 v[96:99], a[160:163], a[104:107], v[96:99]
    ds_read_b64_tr_b16 a[132:133], v27 offset:24576
    v_exp_f32 v241, v55
    v_mfma_f32_16x16x32_bf16 v[104:107], a[160:163], a[120:123], v[104:107]
    ds_read_b64_tr_b16 a[134:135], v27 offset:57344
    v_add_f32 v135, v135, v244
    v_mfma_f32_16x16x32_bf16 v[84:87], a[164:167], a[72:75], v[84:87]
    ds_read_b64_tr_b16 a[136:137], v28 offset:24576
    v_add_f32 v135, v135, v245
    v_cvt_pk_bf16_f32 v158, v244, v245
    v_mfma_f32_16x16x32_bf16 v[92:95], a[164:167], a[88:91], v[92:95]
    ds_read_b64_tr_b16 a[138:139], v28 offset:57344
    v_exp_f32 v242, v62
    v_mfma_f32_16x16x32_bf16 v[100:103], a[164:167], a[104:107], v[100:103]
    ds_read_b64_tr_b16 a[140:141], v29 offset:24576
    v_exp_f32 v243, v63
    v_mfma_f32_16x16x32_bf16 v[108:111], a[164:167], a[120:123], v[108:111]
    ds_read_b64_tr_b16 a[142:143], v29 offset:57344
    v_add_f32 v132, v132, v240
    v_mfma_f32_16x16x32_bf16 v[80:83], a[168:171], a[76:79], v[80:83]
    v_add_f32 v132, v132, v241
    v_cvt_pk_bf16_f32 v147, v240, v241
    v_mfma_f32_16x16x32_bf16 v[88:91], a[168:171], a[92:95], v[88:91]
    v_exp_f32 v244, v70
    v_mfma_f32_16x16x32_bf16 v[96:99], a[168:171], a[108:111], v[96:99]
    v_exp_f32 v245, v71
    v_add_f32 v133, v133, v242
    v_mfma_f32_16x16x32_bf16 v[104:107], a[168:171], a[124:127], v[104:107]
    v_add_f32 v133, v133, v243
    v_cvt_pk_bf16_f32 v151, v242, v243
    v_mfma_f32_16x16x32_bf16 v[84:87], a[172:175], a[76:79], v[84:87]
    v_exp_f32 v240, v78
    v_exp_f32 v241, v79
    v_mfma_f32_16x16x32_bf16 v[92:95], a[172:175], a[92:95], v[92:95]
    v_add_f32 v134, v134, v244
    v_add_f32 v134, v134, v245
    v_mfma_f32_16x16x32_bf16 v[100:103], a[172:175], a[108:111], v[100:103]
    v_cvt_pk_bf16_f32 v155, v244, v245
    s_nop 0
    v_mfma_f32_16x16x32_bf16 v[108:111], a[172:175], a[124:127], v[108:111]
    v_add_f32 v135, v135, v240
    v_add_f32 v135, v135, v241
    v_cvt_pk_bf16_f32 v159, v240, v241
    v_max3_f32 v34, v132, v133, v134
    v_max_f32 v34, v34, v135
    v_cmp_lt_f32 vcc, s59, v34
    s_cbranch_vccnz K_rs_33
K_bk_34:
    v_add_f32 v128, v128, v132
    v_add_f32 v129, v129, v133
    v_add_f32 v130, v130, v134
    v_add_f32 v131, v131, v135
    s_waitcnt lgkmcnt(0)
    v_mfma_f32_16x16x32_bf16 v[176:179], a[128:131], v[144:147], v[176:179]
    ds_read_b64_tr_b16 a[160:161], v8 offset:24576
    v_mfma_f32_16x16x32_bf16 v[184:187], a[128:131], v[148:151], v[184:187]
    ds_read_b64_tr_b16 a[162:163], v8 offset:57344
    s_bfe_u32 s45, s100, 0x40008
    v_mfma_f32_16x16x32_bf16 a[0:3], a[128:131], v[152:155], a[0:3]
    ds_read_b64_tr_b16 a[164:165], v9 offset:24576
    v_mfma_f32_16x16x32_bf16 a[8:11], a[128:131], v[156:159], a[8:11]
    ds_read_b64_tr_b16 a[166:167], v9 offset:57344
    s_lshl_b32 s45, s45, 17
    v_mfma_f32_16x16x32_bf16 v[180:183], a[132:135], v[144:147], v[180:183]
    ds_read_b64_tr_b16 a[168:169], v10 offset:24576
    v_exp_f32 v240, v80
    v_exp_f32 v241, v81
    v_mfma_f32_16x16x32_bf16 v[188:191], a[132:135], v[148:151], v[188:191]
    ds_read_b64_tr_b16 a[170:171], v10 offset:57344
    s_add_u32 s45, s45, s40
    v_exp_f32 v242, v88
    v_mfma_f32_16x16x32_bf16 a[4:7], a[132:135], v[152:155], a[4:7]
    ds_read_b64_tr_b16 a[172:173], v11 offset:24576
    v_exp_f32 v243, v89
    v_add_f32 v132, v240, v241
    v_cvt_pk_bf16_f32 v160, v240, v241
    v_mfma_f32_16x16x32_bf16 a[12:15], a[132:135], v[156:159], a[12:15]
    ds_read_b64_tr_b16 a[174:175], v11 offset:57344
    s_add_u32 m0, s49, 8192
    v_exp_f32 v244, v96
    v_exp_f32 v245, v97
    v_mfma_f32_16x16x32_bf16 v[192:195], a[136:139], v[144:147], v[192:195]
    v_add_f32 v133, v242, v243
    v_cvt_pk_bf16_f32 v164, v242, v243
    v_exp_f32 v240, v104
    v_mfma_f32_16x16x32_bf16 v[200:203], a[136:139], v[148:151], v[200:203]
    buffer_load_dwordx4 v248, s[96:99], s45 offen offset:0 lds
    v_exp_f32 v241, v105
    v_add_f32 v134, v244, v245
    v_mfma_f32_16x16x32_bf16 a[16:19], a[136:139], v[152:155], a[16:19]
    v_cvt_pk_bf16_f32 v168, v244, v245
    v_exp_f32 v242, v82
    v_exp_f32 v243, v83
    v_mfma_f32_16x16x32_bf16 a[24:27], a[136:139], v[156:159], a[24:27]
    buffer_load_dwordx4 v249, s[96:99], s45 offen offset:1024 lds
    v_add_f32 v135, v240, v241
    v_cvt_pk_bf16_f32 v172, v240, v241
    v_mfma_f32_16x16x32_bf16 v[196:199], a[140:143], v[144:147], v[196:199]
    v_exp_f32 v244, v90
    v_exp_f32 v245, v91
    v_add_f32 v132, v132, v242
    v_mfma_f32_16x16x32_bf16 v[204:207], a[140:143], v[148:151], v[204:207]
    buffer_load_dwordx4 v250, s[96:99], s45 offen offset:2048 lds
    v_add_f32 v132, v132, v243
    v_cvt_pk_bf16_f32 v161, v242, v243
    v_mfma_f32_16x16x32_bf16 a[20:23], a[140:143], v[152:155], a[20:23]
    v_exp_f32 v240, v98
    v_exp_f32 v241, v99
    v_add_f32 v133, v133, v244
    v_mfma_f32_16x16x32_bf16 a[28:31], a[140:143], v[156:159], a[28:31]
    buffer_load_dwordx4 v251, s[96:99], s45 offen offset:3072 lds
    v_add_f32 v133, v133, v245
    v_cvt_pk_bf16_f32 v165, v244, v245
    v_exp_f32 v242, v106
    s_waitcnt vmcnt(13) lgkmcnt(0)
    s_barrier
    v_mfma_f32_16x16x32_bf16 v[208:211], a[160:163], v[144:147], v[208:211]
    ds_read_b64_tr_b16 a[128:129], v26 offset:28672
    v_exp_f32 v243, v107
    v_add_f32 v134, v134, v240
    v_mfma_f32_16x16x32_bf16 v[216:219], a[160:163], v[148:151], v[216:219]
    ds_read_b64_tr_b16 a[130:131], v26 offset:61440
    v_add_f32 v134, v134, v241
    v_cvt_pk_bf16_f32 v169, v240, v241
    v_exp_f32 v244, v84
    v_mfma_f32_16x16x32_bf16 a[32:35], a[160:163], v[152:155], a[32:35]
    ds_read_b64_tr_b16 a[132:133], v27 offset:28672
    v_exp_f32 v245, v85
    v_add_f32 v135, v135, v242
    v_mfma_f32_16x16x32_bf16 a[40:43], a[160:163], v[156:159], a[40:43]
    ds_read_b64_tr_b16 a[134:135], v27 offset:61440
    v_add_f32 v135, v135, v243
    v_cvt_pk_bf16_f32 v173, v242, v243
    v_exp_f32 v240, v92
    v_mfma_f32_16x16x32_bf16 v[212:215], a[164:167], v[144:147], v[212:215]
    ds_read_b64_tr_b16 a[136:137], v28 offset:28672
    v_exp_f32 v241, v93
    v_add_f32 v132, v132, v244
    v_add_f32 v132, v132, v245
    v_mfma_f32_16x16x32_bf16 v[220:223], a[164:167], v[148:151], v[220:223]
    ds_read_b64_tr_b16 a[138:139], v28 offset:61440
    v_cvt_pk_bf16_f32 v162, v244, v245
    v_exp_f32 v242, v100
    v_mfma_f32_16x16x32_bf16 a[36:39], a[164:167], v[152:155], a[36:39]
    ds_read_b64_tr_b16 a[140:141], v29 offset:28672
    v_exp_f32 v243, v101
    v_add_f32 v133, v133, v240
    v_add_f32 v133, v133, v241
    v_mfma_f32_16x16x32_bf16 a[44:47], a[164:167], v[156:159], a[44:47]
    ds_read_b64_tr_b16 a[142:143], v29 offset:61440
    v_cvt_pk_bf16_f32 v166, v240, v241
    v_exp_f32 v244, v108
    v_exp_f32 v245, v109
    v_mfma_f32_16x16x32_bf16 v[224:227], a[168:171], v[144:147], v[224:227]
    v_add_f32 v134, v134, v242
    v_add_f32 v134, v134, v243
    v_cvt_pk_bf16_f32 v170, v242, v243
    v_mfma_f32_16x16x32_bf16 v[232:235], a[168:171], v[148:151], v[232:235]
    v_exp_f32 v240, v86
    v_exp_f32 v241, v87
    v_add_f32 v135, v135, v244
    v_add_f32 v135, v135, v245
    v_mfma_f32_16x16x32_bf16 a[48:51], a[168:171], v[152:155], a[48:51]
    v_cvt_pk_bf16_f32 v174, v244, v245
    v_exp_f32 v242, v94
    v_exp_f32 v243, v95
    v_mfma_f32_16x16x32_bf16 a[56:59], a[168:171], v[156:159], a[56:59]
    v_add_f32 v132, v132, v240
    v_add_f32 v132, v132, v241
    v_cvt_pk_bf16_f32 v163, v240, v241
    v_exp_f32 v244, v102
    v_mfma_f32_16x16x32_bf16 v[228:231], a[172:175], v[144:147], v[228:231]
    v_exp_f32 v245, v103
    v_add_f32 v133, v133, v242
    v_add_f32 v133, v133, v243
    v_mfma_f32_16x16x32_bf16 v[236:239], a[172:175], v[148:151], v[236:239]
    v_cvt_pk_bf16_f32 v167, v242, v243
    v_exp_f32 v240, v110
    v_exp_f32 v241, v111
    v_mfma_f32_16x16x32_bf16 a[52:55], a[172:175], v[152:155], a[52:55]
    v_add_f32 v134, v134, v244
    v_add_f32 v134, v134, v245
    v_cvt_pk_bf16_f32 v171, v244, v245
    s_nop 0
    v_mfma_f32_16x16x32_bf16 a[60:63], a[172:175], v[156:159], a[60:63]
    buffer_load_dword v45, v246, s[24:27], s74 offen sc1
    v_add_f32 v135, v135, v240
    v_add_f32 v135, v135, v241
    v_cvt_pk_bf16_f32 v175, v240, v241
    v_max3_f32 v34, v132, v133, v134
    v_max_f32 v34, v34, v135
    v_cmp_lt_f32 vcc, s59, v34
    s_cbranch_vccnz K_rs_35
K_bk_36:
    v_add_f32 v128, v128, v132
    v_add_f32 v129, v129, v133
    v_add_f32 v130, v130, v134
    v_add_f32 v131, v131, v135
    s_waitcnt lgkmcnt(0)
    v_mfma_f32_16x16x32_bf16 a[0:3], a[128:131], v[168:171], a[0:3]
    ds_read_b64_tr_b16 a[160:161], v8 offset:28672
    ds_read_b64_tr_b16 a[162:163], v8 offset:61440
    v_mfma_f32_16x16x32_bf16 a[8:11], a[128:131], v[172:175], a[8:11]
    ds_read_b64_tr_b16 a[164:165], v9 offset:28672
    ds_read_b64_tr_b16 a[166:167], v9 offset:61440
    s_bfe_u32 s45, s100, 0x4000c
    v_mfma_f32_16x16x32_bf16 a[4:7], a[132:135], v[168:171], a[4:7]
    ds_read_b64_tr_b16 a[168:169], v10 offset:28672
    ds_read_b64_tr_b16 a[170:171], v10 offset:61440
    v_mfma_f32_16x16x32_bf16 a[12:15], a[132:135], v[172:175], a[12:15]
    ds_read_b64_tr_b16 a[172:173], v11 offset:28672
    ds_read_b64_tr_b16 a[174:175], v11 offset:61440
    s_lshl_b32 s45, s45, 17
    v_mfma_f32_16x16x32_bf16 a[16:19], a[136:139], v[168:171], a[16:19]
    v_mov_b32 v34, v128
    v_mov_b32 v35, v129
    v_mov_b32 v36, v130
    v_mfma_f32_16x16x32_bf16 a[24:27], a[136:139], v[172:175], a[24:27]
    s_add_u32 s45, s45, s40
    v_mov_b32 v37, v131
    v_permlane16_swap_b32 v128, v34
    v_permlane16_swap_b32 v129, v35
    v_mfma_f32_16x16x32_bf16 a[20:23], a[140:143], v[168:171], a[20:23]
    v_permlane16_swap_b32 v130, v36
    v_permlane16_swap_b32 v131, v37
    v_add_f32 v128, v128, v34
    v_mfma_f32_16x16x32_bf16 a[28:31], a[140:143], v[172:175], a[28:31]
    s_add_u32 m0, s49, 12288
    v_add_f32 v129, v129, v35
    v_add_f32 v130, v130, v36
    v_add_f32 v131, v131, v37
    s_waitcnt lgkmcnt(0)
    v_mfma_f32_16x16x32_bf16 a[32:35], a[160:163], v[168:171], a[32:35]
    v_mov_b32 v34, v128
    v_mov_b32 v35, v129
    v_mov_b32 v36, v130
    v_mfma_f32_16x16x32_bf16 a[40:43], a[160:163], v[172:175], a[40:43]
    buffer_load_dwordx4 v248, s[96:99], s45 offen offset:0 lds
    v_mov_b32 v37, v131
    v_permlane32_swap_b32 v128, v34
    v_permlane32_swap_b32 v129, v35
    v_mfma_f32_16x16x32_bf16 a[36:39], a[164:167], v[168:171], a[36:39]
    v_permlane32_swap_b32 v130, v36
    v_permlane32_swap_b32 v131, v37
    v_add_f32 v128, v128, v34
    v_mfma_f32_16x16x32_bf16 a[44:47], a[164:167], v[172:175], a[44:47]
    buffer_load_dwordx4 v249, s[96:99], s45 offen offset:1024 lds
    v_add_f32 v129, v129, v35
    v_add_f32 v130, v130, v36
    v_add_f32 v131, v131, v37
    v_mfma_f32_16x16x32_bf16 a[48:51], a[168:171], v[168:171], a[48:51]
    v_add_u32 v38, s49, v47
    v_mov_b32 v136, v120
    v_mov_b32 v137, v124
    v_mfma_f32_16x16x32_bf16 a[56:59], a[168:171], v[172:175], a[56:59]
    buffer_load_dwordx4 v250, s[96:99], s45 offen offset:2048 lds
    v_mov_b64 v[138:139], v[130:131]
    v_xor_b32 v39, 0x10000, v38
    s_lshl_b32 s3, s5, 13
    v_mfma_f32_16x16x32_bf16 a[52:55], a[172:175], v[168:171], a[52:55]
    s_add_u32 s3, s3, 131072
    v_add_u32 v40, s3, v47
    v_xor_b32 v41, 16384, v40
    v_mfma_f32_16x16x32_bf16 a[60:63], a[172:175], v[172:175], a[60:63]
    buffer_load_dwordx4 v251, s[96:99], s45 offen offset:3072 lds
    s_add_u32 s4, s74, 4096
    ds_write_b128 v38, v[136:139] offset:24576
    s_waitcnt lgkmcnt(0)
    s_barrier
    s_waitcnt lgkmcnt(0)
    v_mfma_f32_16x16x32_bf16 v[176:179], a[128:131], v[160:163], v[176:179]
    ds_read_b128 v[136:139], v39 offset:24576
    v_mfma_f32_16x16x32_bf16 v[184:187], a[128:131], v[164:167], v[184:187]
    ds_write_b128 v38, a[0:3] offset:16384
    v_mfma_f32_16x16x32_bf16 v[180:183], a[132:135], v[160:163], v[180:183]
    v_mfma_f32_16x16x32_bf16 v[188:191], a[132:135], v[164:167], v[188:191]
    ds_write_b128 v38, a[4:7] offset:17408
    v_mfma_f32_16x16x32_bf16 v[192:195], a[136:139], v[160:163], v[192:195]
    s_waitcnt lgkmcnt(2)
    v_min_f32 v152, v112, v136
    v_min_f32 v153, v116, v137
    v_sub_f32 v144, v152, v112
    v_mfma_f32_16x16x32_bf16 v[200:203], a[136:139], v[164:167], v[200:203]
    ds_write_b128 v38, a[8:11] offset:18432
    v_sub_f32 v146, v152, v136
    v_sub_f32 v148, v153, v116
    v_mfma_f32_16x16x32_bf16 v[196:199], a[140:143], v[160:163], v[196:199]
    v_sub_f32 v150, v153, v137
    v_exp_f32 v144, v144
    v_mfma_f32_16x16x32_bf16 v[204:207], a[140:143], v[164:167], v[204:207]
    ds_write_b128 v38, a[12:15] offset:19456
    v_exp_f32 v146, v146
    v_exp_f32 v148, v148
    v_mfma_f32_16x16x32_bf16 v[208:211], a[160:163], v[160:163], v[208:211]
    v_exp_f32 v150, v150
    v_mul_f32 v152, v144, v128
    v_mfma_f32_16x16x32_bf16 v[216:219], a[160:163], v[164:167], v[216:219]
    ds_write_b128 v38, a[16:19] offset:20480
    v_mul_f32 v153, v148, v129
    v_fmac_f32 v152, v146, v138
    v_mfma_f32_16x16x32_bf16 v[212:215], a[164:167], v[160:163], v[212:215]
    v_fmac_f32 v153, v150, v139
    v_rcp_f32 v152, v152
    v_mfma_f32_16x16x32_bf16 v[220:223], a[164:167], v[164:167], v[220:223]
    ds_write_b128 v38, a[20:23] offset:21504
    v_rcp_f32 v153, v153
    s_nop 0
    v_mfma_f32_16x16x32_bf16 v[224:227], a[168:171], v[160:163], v[224:227]
    v_mul_f32 v144, v144, v152
    v_mul_f32 v146, v146, v152
    v_mfma_f32_16x16x32_bf16 v[232:235], a[168:171], v[164:167], v[232:235]
    ds_write_b128 v38, a[24:27] offset:22528
    v_mul_f32 v148, v148, v153
    v_mul_f32 v150, v150, v153
    v_mfma_f32_16x16x32_bf16 v[228:231], a[172:175], v[160:163], v[228:231]
    v_mov_b32 v145, v144
    v_mov_b32 v147, v146
    v_mfma_f32_16x16x32_bf16 v[236:239], a[172:175], v[164:167], v[236:239]
    ds_write_b128 v38, a[28:31] offset:23552
    v_mov_b32 v149, v148
    v_mov_b32 v151, v150
    ds_write_b128 v40, a[32:35] offset:0
    v_pk_mul_f32 v[176:177], v[176:177], v[144:145]
    v_pk_mul_f32 v[178:179], v[178:179], v[144:145]
    v_pk_mul_f32 v[180:181], v[180:181], v[144:145]
    v_pk_mul_f32 v[182:183], v[182:183], v[144:145]
    ds_write_b128 v40, a[36:39] offset:1024
    v_pk_mul_f32 v[184:185], v[184:185], v[148:149]
    v_pk_mul_f32 v[186:187], v[186:187], v[148:149]
    v_pk_mul_f32 v[188:189], v[188:189], v[148:149]
    v_pk_mul_f32 v[190:191], v[190:191], v[148:149]
    ds_write_b128 v40, a[40:43] offset:2048
    v_pk_mul_f32 v[192:193], v[192:193], v[144:145]
    v_pk_mul_f32 v[194:195], v[194:195], v[144:145]
    v_pk_mul_f32 v[196:197], v[196:197], v[144:145]
    v_pk_mul_f32 v[198:199], v[198:199], v[144:145]
    ds_write_b128 v40, a[44:47] offset:3072
    v_pk_mul_f32 v[200:201], v[200:201], v[148:149]
    v_pk_mul_f32 v[202:203], v[202:203], v[148:149]
    v_pk_mul_f32 v[204:205], v[204:205], v[148:149]
    v_pk_mul_f32 v[206:207], v[206:207], v[148:149]
    ds_write_b128 v40, a[48:51] offset:4096
    v_pk_mul_f32 v[208:209], v[208:209], v[144:145]
    v_pk_mul_f32 v[210:211], v[210:211], v[144:145]
    v_pk_mul_f32 v[212:213], v[212:213], v[144:145]
    v_pk_mul_f32 v[214:215], v[214:215], v[144:145]
    ds_write_b128 v40, a[52:55] offset:5120
    v_pk_mul_f32 v[216:217], v[216:217], v[148:149]
    v_pk_mul_f32 v[218:219], v[218:219], v[148:149]
    v_pk_mul_f32 v[220:221], v[220:221], v[148:149]
    v_pk_mul_f32 v[222:223], v[222:223], v[148:149]
    ds_write_b128 v40, a[56:59] offset:6144
    v_pk_mul_f32 v[224:225], v[224:225], v[144:145]
    v_pk_mul_f32 v[226:227], v[226:227], v[144:145]
    v_pk_mul_f32 v[228:229], v[228:229], v[144:145]
    v_pk_mul_f32 v[230:231], v[230:231], v[144:145]
    ds_write_b128 v40, a[60:63] offset:7168
    v_pk_mul_f32 v[232:233], v[232:233], v[148:149]
    v_pk_mul_f32 v[234:235], v[234:235], v[148:149]
    v_pk_mul_f32 v[236:237], v[236:237], v[148:149]
    v_pk_mul_f32 v[238:239], v[238:239], v[148:149]
    s_waitcnt lgkmcnt(0)
    s_barrier
    ds_read_b128 v[48:51], v39 offset:16384
    ds_read_b128 v[52:55], v39 offset:17408
    ds_read_b128 v[56:59], v39 offset:18432
    ds_read_b128 v[60:63], v39 offset:19456
    ds_read_b128 v[64:67], v39 offset:20480
    ds_read_b128 v[68:71], v39 offset:21504
    ds_read_b128 v[72:75], v39 offset:22528
    ds_read_b128 v[76:79], v39 offset:23552
    ds_read_b128 v[80:83], v41 offset:0
    ds_read_b128 v[84:87], v41 offset:1024
    ds_read_b128 v[88:91], v41 offset:2048
    ds_read_b128 v[92:95], v41 offset:3072
    ds_read_b128 v[96:99], v41 offset:4096
    ds_read_b128 v[100:103], v41 offset:5120
    ds_read_b128 v[104:107], v41 offset:6144
    s_cmp_lg_u32 s63, 0
    s_waitcnt lgkmcnt(13)
    ds_read_b128 v[108:111], v41 offset:7168
    v_pk_fma_f32 v[176:177], v[48:49], v[146:147], v[176:177]
    v_pk_fma_f32 v[178:179], v[50:51], v[146:147], v[178:179]
    v_pk_fma_f32 v[180:181], v[52:53], v[146:147], v[180:181]
    v_pk_fma_f32 v[182:183], v[54:55], v[146:147], v[182:183]
    v_cvt_pk_bf16_f32 v112, v176, v177
    v_cvt_pk_bf16_f32 v113, v178, v179
    v_cvt_pk_bf16_f32 v114, v180, v181
    v_cvt_pk_bf16_f32 v115, v182, v183
    s_waitcnt lgkmcnt(12)
    v_pk_fma_f32 v[184:185], v[56:57], v[150:151], v[184:185]
    v_pk_fma_f32 v[186:187], v[58:59], v[150:151], v[186:187]
    v_pk_fma_f32 v[188:189], v[60:61], v[150:151], v[188:189]
    v_pk_fma_f32 v[190:191], v[62:63], v[150:151], v[190:191]
    v_permlane16_swap_b32 v112, v114
    v_permlane16_swap_b32 v113, v115
    s_cbranch_scc1 M_s_37
    buffer_store_dwordx4 v[112:115], v44, s[24:27], s74 offen offset:0
M_t_38:
    v_cvt_pk_bf16_f32 v116, v184, v185
    v_cvt_pk_bf16_f32 v117, v186, v187
    v_cvt_pk_bf16_f32 v118, v188, v189
    v_cvt_pk_bf16_f32 v119, v190, v191
    s_waitcnt lgkmcnt(10)
    v_pk_fma_f32 v[192:193], v[64:65], v[146:147], v[192:193]
    v_pk_fma_f32 v[194:195], v[66:67], v[146:147], v[194:195]
    v_pk_fma_f32 v[196:197], v[68:69], v[146:147], v[196:197]
    v_pk_fma_f32 v[198:199], v[70:71], v[146:147], v[198:199]
    v_permlane16_swap_b32 v116, v118
    v_permlane16_swap_b32 v117, v119
    s_cbranch_scc1 M_s_39
    buffer_store_dwordx4 v[116:119], v44, s[24:27], s74 offen offset:256
M_t_40:
    v_cvt_pk_bf16_f32 v120, v192, v193
    v_cvt_pk_bf16_f32 v121, v194, v195
    v_cvt_pk_bf16_f32 v122, v196, v197
    v_cvt_pk_bf16_f32 v123, v198, v199
    s_waitcnt lgkmcnt(8)
    v_pk_fma_f32 v[200:201], v[72:73], v[150:151], v[200:201]
    v_pk_fma_f32 v[202:203], v[74:75], v[150:151], v[202:203]
    v_pk_fma_f32 v[204:205], v[76:77], v[150:151], v[204:205]
    v_pk_fma_f32 v[206:207], v[78:79], v[150:151], v[206:207]
    v_permlane16_swap_b32 v120, v122
    v_permlane16_swap_b32 v121, v123
    s_cbranch_scc1 M_s_41
    buffer_store_dwordx4 v[120:123], v44, s[24:27], s74 offen offset:2048
M_t_42:
    v_cvt_pk_bf16_f32 v124, v200, v201
    v_cvt_pk_bf16_f32 v125, v202, v203
    v_cvt_pk_bf16_f32 v126, v204, v205
    v_cvt_pk_bf16_f32 v127, v206, v207
    s_waitcnt lgkmcnt(6)
    v_pk_fma_f32 v[208:209], v[80:81], v[146:147], v[208:209]
    v_pk_fma_f32 v[210:211], v[82:83], v[146:147], v[210:211]
    v_pk_fma_f32 v[212:213], v[84:85], v[146:147], v[212:213]
    v_pk_fma_f32 v[214:215], v[86:87], v[146:147], v[214:215]
    v_permlane16_swap_b32 v124, v126
    v_permlane16_swap_b32 v125, v127
    s_cbranch_scc1 M_s_43
    buffer_store_dwordx4 v[124:127], v44, s[24:27], s74 offen offset:2304
M_t_44:
    v_cvt_pk_bf16_f32 v128, v208, v209
    v_cvt_pk_bf16_f32 v129, v210, v211
    v_cvt_pk_bf16_f32 v130, v212, v213
    v_cvt_pk_bf16_f32 v131, v214, v215
    s_waitcnt lgkmcnt(4)
    v_pk_fma_f32 v[216:217], v[88:89], v[150:151], v[216:217]
    v_pk_fma_f32 v[218:219], v[90:91], v[150:151], v[218:219]
    v_pk_fma_f32 v[220:221], v[92:93], v[150:151], v[220:221]
    v_pk_fma_f32 v[222:223], v[94:95], v[150:151], v[222:223]
    v_permlane16_swap_b32 v128, v130
    v_permlane16_swap_b32 v129, v131
    s_cbranch_scc1 M_s_45
    buffer_store_dwordx4 v[128:131], v44, s[24:27], s4 offen offset:0
M_t_46:
    v_cvt_pk_bf16_f32 v132, v216, v217
    v_cvt_pk_bf16_f32 v133, v218, v219
    v_cvt_pk_bf16_f32 v134, v220, v221
    v_cvt_pk_bf16_f32 v135, v222, v223
    s_waitcnt lgkmcnt(2)
    v_pk_fma_f32 v[224:225], v[96:97], v[146:147], v[224:225]
    v_pk_fma_f32 v[226:227], v[98:99], v[146:147], v[226:227]
    v_pk_fma_f32 v[228:229], v[100:101], v[146:147], v[228:229]
    v_pk_fma_f32 v[230:231], v[102:103], v[146:147], v[230:231]
    v_permlane16_swap_b32 v132, v134
    v_permlane16_swap_b32 v133, v135
    s_cbranch_scc1 M_s_47
    buffer_store_dwordx4 v[132:135], v44, s[24:27], s4 offen offset:256
M_t_48:
    v_cvt_pk_bf16_f32 v136, v224, v225
    v_cvt_pk_bf16_f32 v137, v226, v227
    v_cvt_pk_bf16_f32 v138, v228, v229
    v_cvt_pk_bf16_f32 v139, v230, v231
    s_waitcnt lgkmcnt(0)
    v_pk_fma_f32 v[232:233], v[104:105], v[150:151], v[232:233]
    v_pk_fma_f32 v[234:235], v[106:107], v[150:151], v[234:235]
    v_pk_fma_f32 v[236:237], v[108:109], v[150:151], v[236:237]
    v_pk_fma_f32 v[238:239], v[110:111], v[150:151], v[238:239]
    v_permlane16_swap_b32 v136, v138
    v_permlane16_swap_b32 v137, v139
    s_cbranch_scc1 M_s_49
    buffer_store_dwordx4 v[136:139], v44, s[24:27], s4 offen offset:2048
M_t_50:
    v_cvt_pk_bf16_f32 v140, v232, v233
    v_cvt_pk_bf16_f32 v141, v234, v235
    v_cvt_pk_bf16_f32 v142, v236, v237
    v_cvt_pk_bf16_f32 v143, v238, v239
    s_nop 1
    v_permlane16_swap_b32 v140, v142
    v_permlane16_swap_b32 v141, v143
    s_cbranch_scc1 M_s_51
    buffer_store_dwordx4 v[140:143], v44, s[24:27], s4 offen offset:2304
M_t_52:
    s_and_b32 s3, s6, 1
    s_lshl_b32 s3, s3, 6
    v_xor_b32 v12, s3, v12
    v_xor_b32 v13, s3, v13
    v_xor_b32 v14, s3, v14
    v_xor_b32 v15, s3, v15
    v_xor_b32 v16, s3, v16
    v_xor_b32 v17, s3, v17
    v_xor_b32 v18, s3, v18
    v_xor_b32 v19, s3, v19
    s_lshr_b32 s3, s6, 1
    s_lshl_b32 s3, s3, 15
    s_add_u32 s3, s3, s62
    v_and_b32 v42, 15, v1
    v_lshrrev_b32 v43, 4, v1
    v_lshlrev_b32 v42, 4, v42
    v_lshl_add_u32 v42, v43, 9, v42
    v_add_u32 v42, s3, v42
    v_xor_b32 v43, 0x8000, v42
    s_add_u32 s75, s75, 131072
    s_bfe_u32 s44, s100, 0x40000
    s_lshl_b32 s44, s44, 12
    s_add_u32 s44, s44, s41
    s_add_u32 m0, s49, 16384
    s_cmp_lg_u32 s63, 0
    s_waitcnt vmcnt(0)
    s_cbranch_scc1 M_s_53
    buffer_store_dword v33, v32, s[24:27], s75 offen
M_t_54:
    s_barrier
    s_mov_b32 s58, 0x40000
O_poll:
    buffer_load_dword v31, v247, s[24:27], s55 offen sc1
    s_sub_u32 s58, s58, 1
    s_cbranch_scc1 O_go
    s_waitcnt vmcnt(0)
    v_cmp_ne_u32 vcc, 0, v31
    s_cmp_eq_u32 vcc_lo, 255
    s_cbranch_scc0 O_poll
O_go:
    buffer_load_dwordx4 v47, s[24:27], s44 offen offset:0 sc1 lds
    buffer_load_dwordx4 v47, s[24:27], s44 offen offset:1024 sc1 lds
    buffer_load_dwordx4 v47, s[24:27], s44 offen offset:2048 sc1 lds
    buffer_load_dwordx4 v47, s[24:27], s44 offen offset:3072 sc1 lds
    s_bfe_u32 s44, s100, 0x40004
    s_lshl_b32 s44, s44, 12
    s_add_u32 s44, s44, s41
    s_add_u32 m0, s49, 20480
    s_nop 0
    buffer_load_dwordx4 v47, s[24:27], s44 offen offset:0 sc1 lds
    buffer_load_dwordx4 v47, s[24:27], s44 offen offset:1024 sc1 lds
    buffer_load_dwordx4 v47, s[24:27], s44 offen offset:2048 sc1 lds
    buffer_load_dwordx4 v47, s[24:27], s44 offen offset:3072 sc1 lds
    s_waitcnt vmcnt(4)
    s_barrier
    ds_read_b128 a[144:147], v42 offset:16384
    ds_read_b64_tr_b16 a[128:129], v12 offset:0
    ds_read_b64_tr_b16 a[130:131], v12 offset:512
    ds_read_b128 a[148:151], v42 offset:16640
    ds_read_b64_tr_b16 a[132:133], v13 offset:0
    ds_read_b64_tr_b16 a[134:135], v13 offset:512
    ds_read_b128 a[152:155], v43 offset:16384
    ds_read_b64_tr_b16 a[136:137], v14 offset:0
    ds_read_b64_tr_b16 a[138:139], v14 offset:512
    ds_read_b128 a[156:159], v43 offset:16640
    ds_read_b64_tr_b16 a[140:141], v15 offset:0
    ds_read_b64_tr_b16 a[142:143], v15 offset:512
    s_bfe_u32 s44, s100, 0x40008
    s_lshl_b32 s44, s44, 12
    s_add_u32 s44, s44, s41
    s_add_u32 m0, s49, 24576
    s_nop 0
    buffer_load_dwordx4 v47, s[24:27], s44 offen offset:0 sc1 lds
    buffer_load_dwordx4 v47, s[24:27], s44 offen offset:1024 sc1 lds
    buffer_load_dwordx4 v47, s[24:27], s44 offen offset:2048 sc1 lds
    buffer_load_dwordx4 v47, s[24:27], s44 offen offset:3072 sc1 lds
    s_bfe_u32 s44, s100, 0x4000c
    s_lshl_b32 s44, s44, 12
    s_add_u32 s44, s44, s41
    s_lshr_b64 s[100:101], s[100:101], 16
    s_waitcnt lgkmcnt(0)
    s_branch IP_sk6
IP_pg6:
    s_branch IP_ret5
IP_sk6:
    v_mfma_f32_16x16x32_bf16 v[48:51], a[128:131], a[144:147], 0
    ds_read_b128 a[176:179], v42 offset:18432
    ds_read_b64_tr_b16 a[160:161], v16 offset:0
    v_mfma_f32_16x16x32_bf16 v[56:59], a[128:131], a[148:151], 0
    ds_read_b64_tr_b16 a[162:163], v16 offset:512
    v_mfma_f32_16x16x32_bf16 v[64:67], a[128:131], a[152:155], 0
    ds_read_b128 a[180:183], v42 offset:18688
    ds_read_b64_tr_b16 a[164:165], v17 offset:0
    v_mfma_f32_16x16x32_bf16 v[72:75], a[128:131], a[156:159], 0
    ds_read_b64_tr_b16 a[166:167], v17 offset:512
    v_mfma_f32_16x16x32_bf16 v[52:55], a[132:135], a[144:147], 0
    ds_read_b128 a[184:187], v43 offset:18432
    ds_read_b64_tr_b16 a[168:169], v18 offset:0
    v_mfma_f32_16x16x32_bf16 v[60:63], a[132:135], a[148:151], 0
    ds_read_b64_tr_b16 a[170:171], v18 offset:512
    v_mfma_f32_16x16x32_bf16 v[68:71], a[132:135], a[152:155], 0
    ds_read_b128 a[188:191], v43 offset:18688
    ds_read_b64_tr_b16 a[172:173], v19 offset:0
    v_mfma_f32_16x16x32_bf16 v[76:79], a[132:135], a[156:159], 0
    ds_read_b64_tr_b16 a[174:175], v19 offset:512
    s_add_u32 m0, s49, 28672
    v_mfma_f32_16x16x32_bf16 v[80:83], a[136:139], a[144:147], 0
    v_mfma_f32_16x16x32_bf16 v[88:91], a[136:139], a[148:151], 0
    buffer_load_dwordx4 v47, s[24:27], s44 offen offset:0 sc1 lds
    v_mfma_f32_16x16x32_bf16 v[96:99], a[136:139], a[152:155], 0
    v_mfma_f32_16x16x32_bf16 v[104:107], a[136:139], a[156:159], 0
    buffer_load_dwordx4 v47, s[24:27], s44 offen offset:1024 sc1 lds
    v_mfma_f32_16x16x32_bf16 v[84:87], a[140:143], a[144:147], 0
    v_mfma_f32_16x16x32_bf16 v[92:95], a[140:143], a[148:151], 0
    buffer_load_dwordx4 v47, s[24:27], s44 offen offset:2048 sc1 lds
    v_mfma_f32_16x16x32_bf16 v[100:103], a[140:143], a[152:155], 0
    v_mfma_f32_16x16x32_bf16 v[108:111], a[140:143], a[156:159], 0
    buffer_load_dwordx4 v47, s[24:27], s44 offen offset:3072 sc1 lds
    s_waitcnt vmcnt(8) lgkmcnt(0)
    s_barrier
    v_mfma_f32_16x16x32_bf16 v[48:51], a[160:163], a[176:179], v[48:51]
    ds_read_b128 a[144:147], v42 offset:20480
    ds_read_b64_tr_b16 a[128:129], v12 offset:4096
    v_mfma_f32_16x16x32_bf16 v[56:59], a[160:163], a[180:183], v[56:59]
    ds_read_b64_tr_b16 a[130:131], v12 offset:4608
    s_and_b32 s42, s100, 15
    v_mfma_f32_16x16x32_bf16 v[64:67], a[160:163], a[184:187], v[64:67]
    s_lshr_b64 s[100:101], s[100:101], 4
    ds_read_b128 a[148:151], v42 offset:20736
    v_mfma_f32_16x16x32_bf16 v[72:75], a[160:163], a[188:191], v[72:75]
    ds_read_b64_tr_b16 a[132:133], v13 offset:4096
    ds_read_b64_tr_b16 a[134:135], v13 offset:4608
    v_mfma_f32_16x16x32_bf16 v[52:55], a[164:167], a[176:179], v[52:55]
    s_lshl_b32 s45, s42, 17
    s_lshl_b32 s44, s42, 12
    v_mfma_f32_16x16x32_bf16 v[60:63], a[164:167], a[180:183], v[60:63]
    ds_read_b128 a[152:155], v43 offset:20480
    ds_read_b64_tr_b16 a[136:137], v14 offset:4096
    v_mfma_f32_16x16x32_bf16 v[68:71], a[164:167], a[184:187], v[68:71]
    ds_read_b64_tr_b16 a[138:139], v14 offset:4608
    s_add_u32 s45, s45, s40
    v_mfma_f32_16x16x32_bf16 v[76:79], a[164:167], a[188:191], v[76:79]
    s_add_u32 s44, s44, s41
    ds_read_b128 a[156:159], v43 offset:20736
    v_mfma_f32_16x16x32_bf16 v[80:83], a[168:171], a[176:179], v[80:83]
    ds_read_b64_tr_b16 a[140:141], v15 offset:4096
    v_mfma_f32_16x16x32_bf16 v[88:91], a[168:171], a[180:183], v[88:91]
    ds_read_b64_tr_b16 a[142:143], v15 offset:4608
    s_add_u32 m0, s49, 0
    v_mfma_f32_16x16x32_bf16 v[96:99], a[168:171], a[184:187], v[96:99]
    buffer_load_dwordx4 v248, s[96:99], s45 offen offset:0 lds
    v_mfma_f32_16x16x32_bf16 v[104:107], a[168:171], a[188:191], v[104:107]
    v_mfma_f32_16x16x32_bf16 v[84:87], a[172:175], a[176:179], v[84:87]
    buffer_load_dwordx4 v249, s[96:99], s45 offen offset:1024 lds
    v_mfma_f32_16x16x32_bf16 v[92:95], a[172:175], a[180:183], v[92:95]
    buffer_load_dwordx4 v250, s[96:99], s45 offen offset:2048 lds
    v_mfma_f32_16x16x32_bf16 v[100:103], a[172:175], a[184:187], v[100:103]
    v_mfma_f32_16x16x32_bf16 v[108:111], a[172:175], a[188:191], v[108:111]
    buffer_load_dwordx4 v251, s[96:99], s45 offen offset:3072 lds
    s_waitcnt lgkmcnt(0)
    v_mfma_f32_16x16x32_bf16 v[48:51], a[128:131], a[144:147], v[48:51]
    ds_read_b128 a[176:179], v42 offset:22528
    ds_read_b64_tr_b16 a[160:161], v16 offset:4096
    v_mfma_f32_16x16x32_bf16 v[56:59], a[128:131], a[148:151], v[56:59]
    ds_read_b64_tr_b16 a[162:163], v16 offset:4608
    v_mfma_f32_16x16x32_bf16 v[64:67], a[128:131], a[152:155], v[64:67]
    ds_read_b128 a[180:183], v42 offset:22784
    ds_read_b64_tr_b16 a[164:165], v17 offset:4096
    v_mfma_f32_16x16x32_bf16 v[72:75], a[128:131], a[156:159], v[72:75]
    ds_read_b64_tr_b16 a[166:167], v17 offset:4608
    v_mfma_f32_16x16x32_bf16 v[52:55], a[132:135], a[144:147], v[52:55]
    ds_read_b128 a[184:187], v43 offset:22528
    ds_read_b64_tr_b16 a[168:169], v18 offset:4096
    v_mfma_f32_16x16x32_bf16 v[60:63], a[132:135], a[148:151], v[60:63]
    ds_read_b64_tr_b16 a[170:171], v18 offset:4608
    v_mfma_f32_16x16x32_bf16 v[68:71], a[132:135], a[152:155], v[68:71]
    ds_read_b128 a[188:191], v43 offset:22784
    ds_read_b64_tr_b16 a[172:173], v19 offset:4096
    v_mfma_f32_16x16x32_bf16 v[76:79], a[132:135], a[156:159], v[76:79]
    ds_read_b64_tr_b16 a[174:175], v19 offset:4608
    s_add_u32 m0, s49, 16384
    v_mfma_f32_16x16x32_bf16 v[80:83], a[136:139], a[144:147], v[80:83]
    v_mfma_f32_16x16x32_bf16 v[88:91], a[136:139], a[148:151], v[88:91]
    buffer_load_dwordx4 v47, s[24:27], s44 offen offset:0 sc1 lds
    v_mfma_f32_16x16x32_bf16 v[96:99], a[136:139], a[152:155], v[96:99]
    v_mfma_f32_16x16x32_bf16 v[104:107], a[136:139], a[156:159], v[104:107]
    buffer_load_dwordx4 v47, s[24:27], s44 offen offset:1024 sc1 lds
    v_mfma_f32_16x16x32_bf16 v[84:87], a[140:143], a[144:147], v[84:87]
    v_mfma_f32_16x16x32_bf16 v[92:95], a[140:143], a[148:151], v[92:95]
    buffer_load_dwordx4 v47, s[24:27], s44 offen offset:2048 sc1 lds
    v_mfma_f32_16x16x32_bf16 v[100:103], a[140:143], a[152:155], v[100:103]
    v_mfma_f32_16x16x32_bf16 v[108:111], a[140:143], a[156:159], v[108:111]
    buffer_load_dwordx4 v47, s[24:27], s44 offen offset:3072 sc1 lds
    s_waitcnt vmcnt(12) lgkmcnt(0)
    s_barrier
    v_mfma_f32_16x16x32_bf16 v[48:51], a[160:163], a[176:179], v[48:51]
    ds_read_b128 a[144:147], v42 offset:24576
    ds_read_b64_tr_b16 a[128:129], v12 offset:8192
    v_mfma_f32_16x16x32_bf16 v[56:59], a[160:163], a[180:183], v[56:59]
    ds_read_b64_tr_b16 a[130:131], v12 offset:8704
    s_and_b32 s42, s100, 15
    v_mfma_f32_16x16x32_bf16 v[64:67], a[160:163], a[184:187], v[64:67]
    s_lshr_b64 s[100:101], s[100:101], 4
    ds_read_b128 a[148:151], v42 offset:24832
    v_mfma_f32_16x16x32_bf16 v[72:75], a[160:163], a[188:191], v[72:75]
    ds_read_b64_tr_b16 a[132:133], v13 offset:8192
    ds_read_b64_tr_b16 a[134:135], v13 offset:8704
    v_mfma_f32_16x16x32_bf16 v[52:55], a[164:167], a[176:179], v[52:55]
    s_lshl_b32 s45, s42, 17
    s_lshl_b32 s44, s42, 12
    v_mfma_f32_16x16x32_bf16 v[60:63], a[164:167], a[180:183], v[60:63]
    ds_read_b128 a[152:155], v43 offset:24576
    ds_read_b64_tr_b16 a[136:137], v14 offset:8192
    v_mfma_f32_16x16x32_bf16 v[68:71], a[164:167], a[184:187], v[68:71]
    ds_read_b64_tr_b16 a[138:139], v14 offset:8704
    s_add_u32 s45, s45, s40
    v_mfma_f32_16x16x32_bf16 v[76:79], a[164:167], a[188:191], v[76:79]
    s_add_u32 s44, s44, s41
    ds_read_b128 a[156:159], v43 offset:24832
    v_mfma_f32_16x16x32_bf16 v[80:83], a[168:171], a[176:179], v[80:83]
    ds_read_b64_tr_b16 a[140:141], v15 offset:8192
    v_mfma_f32_16x16x32_bf16 v[88:91], a[168:171], a[180:183], v[88:91]
    ds_read_b64_tr_b16 a[142:143], v15 offset:8704
    s_add_u32 m0, s49, 4096
    v_mfma_f32_16x16x32_bf16 v[96:99], a[168:171], a[184:187], v[96:99]
    buffer_load_dwordx4 v248, s[96:99], s45 offen offset:0 lds
    v_mfma_f32_16x16x32_bf16 v[104:107], a[168:171], a[188:191], v[104:107]
    v_mfma_f32_16x16x32_bf16 v[84:87], a[172:175], a[176:179], v[84:87]
    buffer_load_dwordx4 v249, s[96:99], s45 offen offset:1024 lds
    v_mfma_f32_16x16x32_bf16 v[92:95], a[172:175], a[180:183], v[92:95]
    buffer_load_dwordx4 v250, s[96:99], s45 offen offset:2048 lds
    v_mfma_f32_16x16x32_bf16 v[100:103], a[172:175], a[184:187], v[100:103]
    v_mfma_f32_16x16x32_bf16 v[108:111], a[172:175], a[188:191], v[108:111]
    buffer_load_dwordx4 v251, s[96:99], s45 offen offset:3072 lds
    s_waitcnt lgkmcnt(0)
    v_mfma_f32_16x16x32_bf16 v[48:51], a[128:131], a[144:147], v[48:51]
    ds_read_b128 a[176:179], v42 offset:26624
    ds_read_b64_tr_b16 a[160:161], v16 offset:8192
    v_mfma_f32_16x16x32_bf16 v[56:59], a[128:131], a[148:151], v[56:59]
    ds_read_b64_tr_b16 a[162:163], v16 offset:8704
    v_mfma_f32_16x16x32_bf16 v[64:67], a[128:131], a[152:155], v[64:67]
    ds_read_b128 a[180:183], v42 offset:26880
    ds_read_b64_tr_b16 a[164:165], v17 offset:8192
    v_mfma_f32_16x16x32_bf16 v[72:75], a[128:131], a[156:159], v[72:75]
    ds_read_b64_tr_b16 a[166:167], v17 offset:8704
    v_mfma_f32_16x16x32_bf16 v[52:55], a[132:135], a[144:147], v[52:55]
    ds_read_b128 a[184:187], v43 offset:26624
    ds_read_b64_tr_b16 a[168:169], v18 offset:8192
    v_mfma_f32_16x16x32_bf16 v[60:63], a[132:135], a[148:151], v[60:63]
    ds_read_b64_tr_b16 a[170:171], v18 offset:8704
    v_mfma_f32_16x16x32_bf16 v[68:71], a[132:135], a[152:155], v[68:71]
    ds_read_b128 a[188:191], v43 offset:26880
    ds_read_b64_tr_b16 a[172:173], v19 offset:8192
    v_mfma_f32_16x16x32_bf16 v[76:79], a[132:135], a[156:159], v[76:79]
    ds_read_b64_tr_b16 a[174:175], v19 offset:8704
    s_add_u32 m0, s49, 20480
    v_mfma_f32_16x16x32_bf16 v[80:83], a[136:139], a[144:147], v[80:83]
    v_mfma_f32_16x16x32_bf16 v[88:91], a[136:139], a[148:151], v[88:91]
    buffer_load_dwordx4 v47, s[24:27], s44 offen offset:0 sc1 lds
    v_mfma_f32_16x16x32_bf16 v[96:99], a[136:139], a[152:155], v[96:99]
    v_mfma_f32_16x16x32_bf16 v[104:107], a[136:139], a[156:159], v[104:107]
    buffer_load_dwordx4 v47, s[24:27], s44 offen offset:1024 sc1 lds
    v_mfma_f32_16x16x32_bf16 v[84:87], a[140:143], a[144:147], v[84:87]
    v_mfma_f32_16x16x32_bf16 v[92:95], a[140:143], a[148:151], v[92:95]
    buffer_load_dwordx4 v47, s[24:27], s44 offen offset:2048 sc1 lds
    v_mfma_f32_16x16x32_bf16 v[100:103], a[140:143], a[152:155], v[100:103]
    v_mfma_f32_16x16x32_bf16 v[108:111], a[140:143], a[156:159], v[108:111]
    buffer_load_dwordx4 v47, s[24:27], s44 offen offset:3072 sc1 lds
    s_waitcnt vmcnt(16) lgkmcnt(0)
    s_barrier
    v_mfma_f32_16x16x32_bf16 v[48:51], a[160:163], a[176:179], v[48:51]
    ds_read_b128 a[144:147], v42 offset:28672
    ds_read_b64_tr_b16 a[128:129], v12 offset:12288
    v_mfma_f32_16x16x32_bf16 v[56:59], a[160:163], a[180:183], v[56:59]
    ds_read_b64_tr_b16 a[130:131], v12 offset:12800
    s_and_b32 s42, s100, 15
    v_mfma_f32_16x16x32_bf16 v[64:67], a[160:163], a[184:187], v[64:67]
    s_lshr_b64 s[100:101], s[100:101], 4
    ds_read_b128 a[148:151], v42 offset:28928
    v_mfma_f32_16x16x32_bf16 v[72:75], a[160:163], a[188:191], v[72:75]
    ds_read_b64_tr_b16 a[132:133], v13 offset:12288
    ds_read_b64_tr_b16 a[134:135], v13 offset:12800
    v_mfma_f32_16x16x32_bf16 v[52:55], a[164:167], a[176:179], v[52:55]
    s_lshl_b32 s45, s42, 17
    s_lshl_b32 s44, s42, 12
    v_mfma_f32_16x16x32_bf16 v[60:63], a[164:167], a[180:183], v[60:63]
    ds_read_b128 a[152:155], v43 offset:28672
    ds_read_b64_tr_b16 a[136:137], v14 offset:12288
    v_mfma_f32_16x16x32_bf16 v[68:71], a[164:167], a[184:187], v[68:71]
    ds_read_b64_tr_b16 a[138:139], v14 offset:12800
    s_add_u32 s45, s45, s40
    v_mfma_f32_16x16x32_bf16 v[76:79], a[164:167], a[188:191], v[76:79]
    s_add_u32 s44, s44, s41
    ds_read_b128 a[156:159], v43 offset:28928
    v_mfma_f32_16x16x32_bf16 v[80:83], a[168:171], a[176:179], v[80:83]
    ds_read_b64_tr_b16 a[140:141], v15 offset:12288
    v_mfma_f32_16x16x32_bf16 v[88:91], a[168:171], a[180:183], v[88:91]
    ds_read_b64_tr_b16 a[142:143], v15 offset:12800
    s_add_u32 m0, s49, 8192
    v_mfma_f32_16x16x32_bf16 v[96:99], a[168:171], a[184:187], v[96:99]
    buffer_load_dwordx4 v248, s[96:99], s45 offen offset:0 lds
    v_mfma_f32_16x16x32_bf16 v[104:107], a[168:171], a[188:191], v[104:107]
    v_mfma_f32_16x16x32_bf16 v[84:87], a[172:175], a[176:179], v[84:87]
    buffer_load_dwordx4 v249, s[96:99], s45 offen offset:1024 lds
    v_mfma_f32_16x16x32_bf16 v[92:95], a[172:175], a[180:183], v[92:95]
    buffer_load_dwordx4 v250, s[96:99], s45 offen offset:2048 lds
    v_mfma_f32_16x16x32_bf16 v[100:103], a[172:175], a[184:187], v[100:103]
    v_mfma_f32_16x16x32_bf16 v[108:111], a[172:175], a[188:191], v[108:111]
    buffer_load_dwordx4 v251, s[96:99], s45 offen offset:3072 lds
    s_waitcnt lgkmcnt(0)
    v_mfma_f32_16x16x32_bf16 v[48:51], a[128:131], a[144:147], v[48:51]
    ds_read_b128 a[176:179], v42 offset:30720
    ds_read_b64_tr_b16 a[160:161], v16 offset:12288
    v_mfma_f32_16x16x32_bf16 v[56:59], a[128:131], a[148:151], v[56:59]
    ds_read_b64_tr_b16 a[162:163], v16 offset:12800
    v_mfma_f32_16x16x32_bf16 v[64:67], a[128:131], a[152:155], v[64:67]
    ds_read_b128 a[180:183], v42 offset:30976
    ds_read_b64_tr_b16 a[164:165], v17 offset:12288
    v_mfma_f32_16x16x32_bf16 v[72:75], a[128:131], a[156:159], v[72:75]
    ds_read_b64_tr_b16 a[166:167], v17 offset:12800
    v_mfma_f32_16x16x32_bf16 v[52:55], a[132:135], a[144:147], v[52:55]
    ds_read_b128 a[184:187], v43 offset:30720
    ds_read_b64_tr_b16 a[168:169], v18 offset:12288
    v_mfma_f32_16x16x32_bf16 v[60:63], a[132:135], a[148:151], v[60:63]
    ds_read_b64_tr_b16 a[170:171], v18 offset:12800
    v_mfma_f32_16x16x32_bf16 v[68:71], a[132:135], a[152:155], v[68:71]
    ds_read_b128 a[188:191], v43 offset:30976
    ds_read_b64_tr_b16 a[172:173], v19 offset:12288
    v_mfma_f32_16x16x32_bf16 v[76:79], a[132:135], a[156:159], v[76:79]
    ds_read_b64_tr_b16 a[174:175], v19 offset:12800
    s_add_u32 m0, s49, 24576
    v_mfma_f32_16x16x32_bf16 v[80:83], a[136:139], a[144:147], v[80:83]
    v_mfma_f32_16x16x32_bf16 v[88:91], a[136:139], a[148:151], v[88:91]
    buffer_load_dwordx4 v47, s[24:27], s44 offen offset:0 sc1 lds
    v_mfma_f32_16x16x32_bf16 v[96:99], a[136:139], a[152:155], v[96:99]
    v_mfma_f32_16x16x32_bf16 v[104:107], a[136:139], a[156:159], v[104:107]
    buffer_load_dwordx4 v47, s[24:27], s44 offen offset:1024 sc1 lds
    v_mfma_f32_16x16x32_bf16 v[84:87], a[140:143], a[144:147], v[84:87]
    v_mfma_f32_16x16x32_bf16 v[92:95], a[140:143], a[148:151], v[92:95]
    buffer_load_dwordx4 v47, s[24:27], s44 offen offset:2048 sc1 lds
    v_mfma_f32_16x16x32_bf16 v[100:103], a[140:143], a[152:155], v[100:103]
    v_mfma_f32_16x16x32_bf16 v[108:111], a[140:143], a[156:159], v[108:111]
    buffer_load_dwordx4 v47, s[24:27], s44 offen offset:3072 sc1 lds
    s_waitcnt vmcnt(16) lgkmcnt(0)
    s_barrier
    v_mfma_f32_16x16x32_bf16 v[48:51], a[160:163], a[176:179], v[48:51]
    ds_read_b128 a[144:147], v42 offset:16384
    ds_read_b64_tr_b16 a[128:129], v12 offset:0
    v_mfma_f32_16x16x32_bf16 v[56:59], a[160:163], a[180:183], v[56:59]
    ds_read_b64_tr_b16 a[130:131], v12 offset:512
    s_and_b32 s42, s100, 15
    v_mfma_f32_16x16x32_bf16 v[64:67], a[160:163], a[184:187], v[64:67]
    s_lshr_b64 s[100:101], s[100:101], 4
    ds_read_b128 a[148:151], v42 offset:16640
    v_mfma_f32_16x16x32_bf16 v[72:75], a[160:163], a[188:191], v[72:75]
    ds_read_b64_tr_b16 a[132:133], v13 offset:0
    ds_read_b64_tr_b16 a[134:135], v13 offset:512
    v_mfma_f32_16x16x32_bf16 v[52:55], a[164:167], a[176:179], v[52:55]
    s_lshl_b32 s45, s42, 17
    s_lshl_b32 s44, s42, 12
    v_mfma_f32_16x16x32_bf16 v[60:63], a[164:167], a[180:183], v[60:63]
    ds_read_b128 a[152:155], v43 offset:16384
    ds_read_b64_tr_b16 a[136:137], v14 offset:0
    v_mfma_f32_16x16x32_bf16 v[68:71], a[164:167], a[184:187], v[68:71]
    ds_read_b64_tr_b16 a[138:139], v14 offset:512
    s_add_u32 s45, s45, s40
    v_mfma_f32_16x16x32_bf16 v[76:79], a[164:167], a[188:191], v[76:79]
    s_add_u32 s44, s44, s41
    ds_read_b128 a[156:159], v43 offset:16640
    v_mfma_f32_16x16x32_bf16 v[80:83], a[168:171], a[176:179], v[80:83]
    ds_read_b64_tr_b16 a[140:141], v15 offset:0
    v_mfma_f32_16x16x32_bf16 v[88:91], a[168:171], a[180:183], v[88:91]
    ds_read_b64_tr_b16 a[142:143], v15 offset:512
    s_add_u32 m0, s49, 12288
    v_mfma_f32_16x16x32_bf16 v[96:99], a[168:171], a[184:187], v[96:99]
    buffer_load_dwordx4 v248, s[96:99], s45 offen offset:0 lds
    v_mfma_f32_16x16x32_bf16 v[104:107], a[168:171], a[188:191], v[104:107]
    v_mfma_f32_16x16x32_bf16 v[84:87], a[172:175], a[176:179], v[84:87]
    buffer_load_dwordx4 v249, s[96:99], s45 offen offset:1024 lds
    v_mfma_f32_16x16x32_bf16 v[92:95], a[172:175], a[180:183], v[92:95]
    buffer_load_dwordx4 v250, s[96:99], s45 offen offset:2048 lds
    v_mfma_f32_16x16x32_bf16 v[100:103], a[172:175], a[184:187], v[100:103]
    v_mfma_f32_16x16x32_bf16 v[108:111], a[172:175], a[188:191], v[108:111]
    buffer_load_dwordx4 v251, s[96:99], s45 offen offset:3072 lds
    s_waitcnt lgkmcnt(0)
    v_mfma_f32_16x16x32_bf16 v[48:51], a[128:131], a[144:147], v[48:51]
    ds_read_b128 a[176:179], v42 offset:18432
    ds_read_b64_tr_b16 a[160:161], v16 offset:0
    v_mfma_f32_16x16x32_bf16 v[56:59], a[128:131], a[148:151], v[56:59]
    ds_read_b64_tr_b16 a[162:163], v16 offset:512
    v_mfma_f32_16x16x32_bf16 v[64:67], a[128:131], a[152:155], v[64:67]
    ds_read_b128 a[180:183], v42 offset:18688
    ds_read_b64_tr_b16 a[164:165], v17 offset:0
    v_mfma_f32_16x16x32_bf16 v[72:75], a[128:131], a[156:159], v[72:75]
    ds_read_b64_tr_b16 a[166:167], v17 offset:512
    v_mfma_f32_16x16x32_bf16 v[52:55], a[132:135], a[144:147], v[52:55]
    ds_read_b128 a[184:187], v43 offset:18432
    ds_read_b64_tr_b16 a[168:169], v18 offset:0
    v_mfma_f32_16x16x32_bf16 v[60:63], a[132:135], a[148:151], v[60:63]
    ds_read_b64_tr_b16 a[170:171], v18 offset:512
    v_mfma_f32_16x16x32_bf16 v[68:71], a[132:135], a[152:155], v[68:71]
    ds_read_b128 a[188:191], v43 offset:18688
    ds_read_b64_tr_b16 a[172:173], v19 offset:0
    v_mfma_f32_16x16x32_bf16 v[76:79], a[132:135], a[156:159], v[76:79]
    ds_read_b64_tr_b16 a[174:175], v19 offset:512
    s_add_u32 m0, s49, 28672
    v_mfma_f32_16x16x32_bf16 v[80:83], a[136:139], a[144:147], v[80:83]
    v_mfma_f32_16x16x32_bf16 v[88:91], a[136:139], a[148:151], v[88:91]
    buffer_load_dwordx4 v47, s[24:27], s44 offen offset:0 sc1 lds
    v_mfma_f32_16x16x32_bf16 v[96:99], a[136:139], a[152:155], v[96:99]
    v_mfma_f32_16x16x32_bf16 v[104:107], a[136:139], a[156:159], v[104:107]
    buffer_load_dwordx4 v47, s[24:27], s44 offen offset:1024 sc1 lds
    v_mfma_f32_16x16x32_bf16 v[84:87], a[140:143], a[144:147], v[84:87]
    v_mfma_f32_16x16x32_bf16 v[92:95], a[140:143], a[148:151], v[92:95]
    buffer_load_dwordx4 v47, s[24:27], s44 offen offset:2048 sc1 lds
    v_mfma_f32_16x16x32_bf16 v[100:103], a[140:143], a[152:155], v[100:103]
    v_mfma_f32_16x16x32_bf16 v[108:111], a[140:143], a[156:159], v[108:111]
    buffer_load_dwordx4 v47, s[24:27], s44 offen offset:3072 sc1 lds
    s_waitcnt vmcnt(16) lgkmcnt(0)
    s_barrier
    v_mfma_f32_16x16x32_bf16 v[48:51], a[160:163], a[176:179], v[48:51]
    ds_read_b128 a[144:147], v42 offset:20480
    ds_read_b64_tr_b16 a[128:129], v12 offset:4096
    v_mfma_f32_16x16x32_bf16 v[56:59], a[160:163], a[180:183], v[56:59]
    ds_read_b64_tr_b16 a[130:131], v12 offset:4608
    s_and_b32 s42, s100, 15
    v_mfma_f32_16x16x32_bf16 v[64:67], a[160:163], a[184:187], v[64:67]
    s_lshr_b64 s[100:101], s[100:101], 4
    ds_read_b128 a[148:151], v42 offset:20736
    v_mfma_f32_16x16x32_bf16 v[72:75], a[160:163], a[188:191], v[72:75]
    ds_read_b64_tr_b16 a[132:133], v13 offset:4096
    ds_read_b64_tr_b16 a[134:135], v13 offset:4608
    v_mfma_f32_16x16x32_bf16 v[52:55], a[164:167], a[176:179], v[52:55]
    s_lshl_b32 s45, s42, 17
    s_lshl_b32 s44, s42, 12
    v_mfma_f32_16x16x32_bf16 v[60:63], a[164:167], a[180:183], v[60:63]
    ds_read_b128 a[152:155], v43 offset:20480
    ds_read_b64_tr_b16 a[136:137], v14 offset:4096
    v_mfma_f32_16x16x32_bf16 v[68:71], a[164:167], a[184:187], v[68:71]
    ds_read_b64_tr_b16 a[138:139], v14 offset:4608
    s_add_u32 s45, s45, s40
    v_mfma_f32_16x16x32_bf16 v[76:79], a[164:167], a[188:191], v[76:79]
    s_add_u32 s44, s44, s41
    ds_read_b128 a[156:159], v43 offset:20736
    v_mfma_f32_16x16x32_bf16 v[80:83], a[168:171], a[176:179], v[80:83]
    ds_read_b64_tr_b16 a[140:141], v15 offset:4096
    v_mfma_f32_16x16x32_bf16 v[88:91], a[168:171], a[180:183], v[88:91]
    ds_read_b64_tr_b16 a[142:143], v15 offset:4608
    s_add_u32 m0, s49, 0
    v_mfma_f32_16x16x32_bf16 v[96:99], a[168:171], a[184:187], v[96:99]
    buffer_load_dwordx4 v248, s[96:99], s45 offen offset:0 lds
    v_mfma_f32_16x16x32_bf16 v[104:107], a[168:171], a[188:191], v[104:107]
    v_mfma_f32_16x16x32_bf16 v[84:87], a[172:175], a[176:179], v[84:87]
    buffer_load_dwordx4 v249, s[96:99], s45 offen offset:1024 lds
    v_mfma_f32_16x16x32_bf16 v[92:95], a[172:175], a[180:183], v[92:95]
    buffer_load_dwordx4 v250, s[96:99], s45 offen offset:2048 lds
    v_mfma_f32_16x16x32_bf16 v[100:103], a[172:175], a[184:187], v[100:103]
    v_mfma_f32_16x16x32_bf16 v[108:111], a[172:175], a[188:191], v[108:111]
    buffer_load_dwordx4 v251, s[96:99], s45 offen offset:3072 lds
    s_waitcnt lgkmcnt(0)
    v_mfma_f32_16x16x32_bf16 v[48:51], a[128:131], a[144:147], v[48:51]
    ds_read_b128 a[176:179], v42 offset:22528
    ds_read_b64_tr_b16 a[160:161], v16 offset:4096
    v_mfma_f32_16x16x32_bf16 v[56:59], a[128:131], a[148:151], v[56:59]
    ds_read_b64_tr_b16 a[162:163], v16 offset:4608
    v_mfma_f32_16x16x32_bf16 v[64:67], a[128:131], a[152:155], v[64:67]
    ds_read_b128 a[180:183], v42 offset:22784
    ds_read_b64_tr_b16 a[164:165], v17 offset:4096
    v_mfma_f32_16x16x32_bf16 v[72:75], a[128:131], a[156:159], v[72:75]
    ds_read_b64_tr_b16 a[166:167], v17 offset:4608
    v_mfma_f32_16x16x32_bf16 v[52:55], a[132:135], a[144:147], v[52:55]
    ds_read_b128 a[184:187], v43 offset:22528
    ds_read_b64_tr_b16 a[168:169], v18 offset:4096
    v_mfma_f32_16x16x32_bf16 v[60:63], a[132:135], a[148:151], v[60:63]
    ds_read_b64_tr_b16 a[170:171], v18 offset:4608
    v_mfma_f32_16x16x32_bf16 v[68:71], a[132:135], a[152:155], v[68:71]
    ds_read_b128 a[188:191], v43 offset:22784
    ds_read_b64_tr_b16 a[172:173], v19 offset:4096
    v_mfma_f32_16x16x32_bf16 v[76:79], a[132:135], a[156:159], v[76:79]
    ds_read_b64_tr_b16 a[174:175], v19 offset:4608
    s_add_u32 m0, s49, 16384
    v_mfma_f32_16x16x32_bf16 v[80:83], a[136:139], a[144:147], v[80:83]
    v_mfma_f32_16x16x32_bf16 v[88:91], a[136:139], a[148:151], v[88:91]
    buffer_load_dwordx4 v47, s[24:27], s44 offen offset:0 sc1 lds
    v_mfma_f32_16x16x32_bf16 v[96:99], a[136:139], a[152:155], v[96:99]
    v_mfma_f32_16x16x32_bf16 v[104:107], a[136:139], a[156:159], v[104:107]
    buffer_load_dwordx4 v47, s[24:27], s44 offen offset:1024 sc1 lds
    v_mfma_f32_16x16x32_bf16 v[84:87], a[140:143], a[144:147], v[84:87]
    v_mfma_f32_16x16x32_bf16 v[92:95], a[140:143], a[148:151], v[92:95]
    buffer_load_dwordx4 v47, s[24:27], s44 offen offset:2048 sc1 lds
    v_mfma_f32_16x16x32_bf16 v[100:103], a[140:143], a[152:155], v[100:103]
    v_mfma_f32_16x16x32_bf16 v[108:111], a[140:143], a[156:159], v[108:111]
    buffer_load_dwordx4 v47, s[24:27], s44 offen offset:3072 sc1 lds
    s_waitcnt vmcnt(16) lgkmcnt(0)
    s_barrier
    v_mfma_f32_16x16x32_bf16 v[48:51], a[160:163], a[176:179], v[48:51]
    ds_read_b128 a[144:147], v42 offset:24576
    ds_read_b64_tr_b16 a[128:129], v12 offset:8192
    v_mfma_f32_16x16x32_bf16 v[56:59], a[160:163], a[180:183], v[56:59]
    ds_read_b64_tr_b16 a[130:131], v12 offset:8704
    s_and_b32 s42, s100, 15
    v_mfma_f32_16x16x32_bf16 v[64:67], a[160:163], a[184:187], v[64:67]
    s_lshr_b64 s[100:101], s[100:101], 4
    ds_read_b128 a[148:151], v42 offset:24832
    v_mfma_f32_16x16x32_bf16 v[72:75], a[160:163], a[188:191], v[72:75]
    ds_read_b64_tr_b16 a[132:133], v13 offset:8192
    ds_read_b64_tr_b16 a[134:135], v13 offset:8704
    v_mfma_f32_16x16x32_bf16 v[52:55], a[164:167], a[176:179], v[52:55]
    s_lshl_b32 s45, s42, 17
    s_lshl_b32 s44, s42, 12
    v_mfma_f32_16x16x32_bf16 v[60:63], a[164:167], a[180:183], v[60:63]
    ds_read_b128 a[152:155], v43 offset:24576
    ds_read_b64_tr_b16 a[136:137], v14 offset:8192
    v_mfma_f32_16x16x32_bf16 v[68:71], a[164:167], a[184:187], v[68:71]
    ds_read_b64_tr_b16 a[138:139], v14 offset:8704
    s_add_u32 s45, s45, s40
    v_mfma_f32_16x16x32_bf16 v[76:79], a[164:167], a[188:191], v[76:79]
    s_add_u32 s44, s44, s41
    ds_read_b128 a[156:159], v43 offset:24832
    v_mfma_f32_16x16x32_bf16 v[80:83], a[168:171], a[176:179], v[80:83]
    ds_read_b64_tr_b16 a[140:141], v15 offset:8192
    v_mfma_f32_16x16x32_bf16 v[88:91], a[168:171], a[180:183], v[88:91]
    ds_read_b64_tr_b16 a[142:143], v15 offset:8704
    s_add_u32 m0, s49, 4096
    v_mfma_f32_16x16x32_bf16 v[96:99], a[168:171], a[184:187], v[96:99]
    buffer_load_dwordx4 v248, s[96:99], s45 offen offset:0 lds
    v_mfma_f32_16x16x32_bf16 v[104:107], a[168:171], a[188:191], v[104:107]
    v_mfma_f32_16x16x32_bf16 v[84:87], a[172:175], a[176:179], v[84:87]
    buffer_load_dwordx4 v249, s[96:99], s45 offen offset:1024 lds
    v_mfma_f32_16x16x32_bf16 v[92:95], a[172:175], a[180:183], v[92:95]
    buffer_load_dwordx4 v250, s[96:99], s45 offen offset:2048 lds
    v_mfma_f32_16x16x32_bf16 v[100:103], a[172:175], a[184:187], v[100:103]
    v_mfma_f32_16x16x32_bf16 v[108:111], a[172:175], a[188:191], v[108:111]
    buffer_load_dwordx4 v251, s[96:99], s45 offen offset:3072 lds
    s_waitcnt lgkmcnt(0)
    v_mfma_f32_16x16x32_bf16 v[48:51], a[128:131], a[144:147], v[48:51]
    ds_read_b128 a[176:179], v42 offset:26624
    ds_read_b64_tr_b16 a[160:161], v16 offset:8192
    v_mfma_f32_16x16x32_bf16 v[56:59], a[128:131], a[148:151], v[56:59]
    ds_read_b64_tr_b16 a[162:163], v16 offset:8704
    v_mfma_f32_16x16x32_bf16 v[64:67], a[128:131], a[152:155], v[64:67]
    ds_read_b128 a[180:183], v42 offset:26880
    ds_read_b64_tr_b16 a[164:165], v17 offset:8192
    v_mfma_f32_16x16x32_bf16 v[72:75], a[128:131], a[156:159], v[72:75]
    ds_read_b64_tr_b16 a[166:167], v17 offset:8704
    v_mfma_f32_16x16x32_bf16 v[52:55], a[132:135], a[144:147], v[52:55]
    ds_read_b128 a[184:187], v43 offset:26624
    ds_read_b64_tr_b16 a[168:169], v18 offset:8192
    v_mfma_f32_16x16x32_bf16 v[60:63], a[132:135], a[148:151], v[60:63]
    ds_read_b64_tr_b16 a[170:171], v18 offset:8704
    v_mfma_f32_16x16x32_bf16 v[68:71], a[132:135], a[152:155], v[68:71]
    ds_read_b128 a[188:191], v43 offset:26880
    ds_read_b64_tr_b16 a[172:173], v19 offset:8192
    v_mfma_f32_16x16x32_bf16 v[76:79], a[132:135], a[156:159], v[76:79]
    ds_read_b64_tr_b16 a[174:175], v19 offset:8704
    s_add_u32 m0, s49, 20480
    v_mfma_f32_16x16x32_bf16 v[80:83], a[136:139], a[144:147], v[80:83]
    v_mfma_f32_16x16x32_bf16 v[88:91], a[136:139], a[148:151], v[88:91]
    buffer_load_dwordx4 v47, s[24:27], s44 offen offset:0 sc1 lds
    v_mfma_f32_16x16x32_bf16 v[96:99], a[136:139], a[152:155], v[96:99]
    v_mfma_f32_16x16x32_bf16 v[104:107], a[136:139], a[156:159], v[104:107]
    buffer_load_dwordx4 v47, s[24:27], s44 offen offset:1024 sc1 lds
    v_mfma_f32_16x16x32_bf16 v[84:87], a[140:143], a[144:147], v[84:87]
    v_mfma_f32_16x16x32_bf16 v[92:95], a[140:143], a[148:151], v[92:95]
    buffer_load_dwordx4 v47, s[24:27], s44 offen offset:2048 sc1 lds
    v_mfma_f32_16x16x32_bf16 v[100:103], a[140:143], a[152:155], v[100:103]
    v_mfma_f32_16x16x32_bf16 v[108:111], a[140:143], a[156:159], v[108:111]
    buffer_load_dwordx4 v47, s[24:27], s44 offen offset:3072 sc1 lds
    s_waitcnt vmcnt(16) lgkmcnt(0)
    s_barrier
    v_mfma_f32_16x16x32_bf16 v[48:51], a[160:163], a[176:179], v[48:51]
    ds_read_b128 a[144:147], v42 offset:28672
    ds_read_b64_tr_b16 a[128:129], v12 offset:12288
    v_mfma_f32_16x16x32_bf16 v[56:59], a[160:163], a[180:183], v[56:59]
    ds_read_b64_tr_b16 a[130:131], v12 offset:12800
    s_and_b32 s42, s100, 15
    v_mfma_f32_16x16x32_bf16 v[64:67], a[160:163], a[184:187], v[64:67]
    s_lshr_b64 s[100:101], s[100:101], 4
    ds_read_b128 a[148:151], v42 offset:28928
    v_mfma_f32_16x16x32_bf16 v[72:75], a[160:163], a[188:191], v[72:75]
    ds_read_b64_tr_b16 a[132:133], v13 offset:12288
    ds_read_b64_tr_b16 a[134:135], v13 offset:12800
    v_mfma_f32_16x16x32_bf16 v[52:55], a[164:167], a[176:179], v[52:55]
    s_lshl_b32 s45, s42, 17
    s_lshl_b32 s44, s42, 12
    v_mfma_f32_16x16x32_bf16 v[60:63], a[164:167], a[180:183], v[60:63]
    ds_read_b128 a[152:155], v43 offset:28672
    ds_read_b64_tr_b16 a[136:137], v14 offset:12288
    v_mfma_f32_16x16x32_bf16 v[68:71], a[164:167], a[184:187], v[68:71]
    ds_read_b64_tr_b16 a[138:139], v14 offset:12800
    s_add_u32 s45, s45, s40
    v_mfma_f32_16x16x32_bf16 v[76:79], a[164:167], a[188:191], v[76:79]
    s_add_u32 s44, s44, s41
    ds_read_b128 a[156:159], v43 offset:28928
    v_mfma_f32_16x16x32_bf16 v[80:83], a[168:171], a[176:179], v[80:83]
    ds_read_b64_tr_b16 a[140:141], v15 offset:12288
    v_mfma_f32_16x16x32_bf16 v[88:91], a[168:171], a[180:183], v[88:91]
    ds_read_b64_tr_b16 a[142:143], v15 offset:12800
    s_add_u32 m0, s49, 8192
    v_mfma_f32_16x16x32_bf16 v[96:99], a[168:171], a[184:187], v[96:99]
    buffer_load_dwordx4 v248, s[96:99], s45 offen offset:0 lds
    v_mfma_f32_16x16x32_bf16 v[104:107], a[168:171], a[188:191], v[104:107]
    v_mfma_f32_16x16x32_bf16 v[84:87], a[172:175], a[176:179], v[84:87]
    buffer_load_dwordx4 v249, s[96:99], s45 offen offset:1024 lds
    v_mfma_f32_16x16x32_bf16 v[92:95], a[172:175], a[180:183], v[92:95]
    buffer_load_dwordx4 v250, s[96:99], s45 offen offset:2048 lds
    v_mfma_f32_16x16x32_bf16 v[100:103], a[172:175], a[184:187], v[100:103]
    v_mfma_f32_16x16x32_bf16 v[108:111], a[172:175], a[188:191], v[108:111]
    buffer_load_dwordx4 v251, s[96:99], s45 offen offset:3072 lds
    s_waitcnt lgkmcnt(0)
    v_mfma_f32_16x16x32_bf16 v[48:51], a[128:131], a[144:147], v[48:51]
    ds_read_b128 a[176:179], v42 offset:30720
    ds_read_b64_tr_b16 a[160:161], v16 offset:12288
    v_mfma_f32_16x16x32_bf16 v[56:59], a[128:131], a[148:151], v[56:59]
    ds_read_b64_tr_b16 a[162:163], v16 offset:12800
    v_mfma_f32_16x16x32_bf16 v[64:67], a[128:131], a[152:155], v[64:67]
    ds_read_b128 a[180:183], v42 offset:30976
    ds_read_b64_tr_b16 a[164:165], v17 offset:12288
    v_mfma_f32_16x16x32_bf16 v[72:75], a[128:131], a[156:159], v[72:75]
    ds_read_b64_tr_b16 a[166:167], v17 offset:12800
    v_mfma_f32_16x16x32_bf16 v[52:55], a[132:135], a[144:147], v[52:55]
    ds_read_b128 a[184:187], v43 offset:30720
    ds_read_b64_tr_b16 a[168:169], v18 offset:12288
    v_mfma_f32_16x16x32_bf16 v[60:63], a[132:135], a[148:151], v[60:63]
    ds_read_b64_tr_b16 a[170:171], v18 offset:12800
    v_mfma_f32_16x16x32_bf16 v[68:71], a[132:135], a[152:155], v[68:71]
    ds_read_b128 a[188:191], v43 offset:30976
    ds_read_b64_tr_b16 a[172:173], v19 offset:12288
    v_mfma_f32_16x16x32_bf16 v[76:79], a[132:135], a[156:159], v[76:79]
    s_branch IP_sk7
IP_pg7:
    s_branch IP_ret5
IP_sk7:
    ds_read_b64_tr_b16 a[174:175], v19 offset:12800
    s_add_u32 m0, s49, 24576
    v_mfma_f32_16x16x32_bf16 v[80:83], a[136:139], a[144:147], v[80:83]
    v_mfma_f32_16x16x32_bf16 v[88:91], a[136:139], a[148:151], v[88:91]
    buffer_load_dwordx4 v47, s[24:27], s44 offen offset:0 sc1 lds
    v_mfma_f32_16x16x32_bf16 v[96:99], a[136:139], a[152:155], v[96:99]
    v_mfma_f32_16x16x32_bf16 v[104:107], a[136:139], a[156:159], v[104:107]
    buffer_load_dwordx4 v47, s[24:27], s44 offen offset:1024 sc1 lds
    v_mfma_f32_16x16x32_bf16 v[84:87], a[140:143], a[144:147], v[84:87]
    v_mfma_f32_16x16x32_bf16 v[92:95], a[140:143], a[148:151], v[92:95]
    buffer_load_dwordx4 v47, s[24:27], s44 offen offset:2048 sc1 lds
    v_mfma_f32_16x16x32_bf16 v[100:103], a[140:143], a[152:155], v[100:103]
    v_mfma_f32_16x16x32_bf16 v[108:111], a[140:143], a[156:159], v[108:111]
    buffer_load_dwordx4 v47, s[24:27], s44 offen offset:3072 sc1 lds
    s_waitcnt vmcnt(16) lgkmcnt(0)
    s_barrier
    v_mfma_f32_16x16x32_bf16 v[48:51], a[160:163], a[176:179], v[48:51]
    ds_read_b128 a[144:147], v42 offset:16384
    ds_read_b64_tr_b16 a[128:129], v12 offset:0
    v_mfma_f32_16x16x32_bf16 v[56:59], a[160:163], a[180:183], v[56:59]
    ds_read_b64_tr_b16 a[130:131], v12 offset:512
    s_and_b32 s42, s100, 15
    v_mfma_f32_16x16x32_bf16 v[64:67], a[160:163], a[184:187], v[64:67]
    s_lshr_b64 s[100:101], s[100:101], 4
    ds_read_b128 a[148:151], v42 offset:16640
    v_mfma_f32_16x16x32_bf16 v[72:75], a[160:163], a[188:191], v[72:75]
    ds_read_b64_tr_b16 a[132:133], v13 offset:0
    ds_read_b64_tr_b16 a[134:135], v13 offset:512
    v_mfma_f32_16x16x32_bf16 v[52:55], a[164:167], a[176:179], v[52:55]
    s_lshl_b32 s45, s42, 17
    s_lshl_b32 s44, s42, 12
    v_mfma_f32_16x16x32_bf16 v[60:63], a[164:167], a[180:183], v[60:63]
    ds_read_b128 a[152:155], v43 offset:16384
    ds_read_b64_tr_b16 a[136:137], v14 offset:0
    v_mfma_f32_16x16x32_bf16 v[68:71], a[164:167], a[184:187], v[68:71]
    ds_read_b64_tr_b16 a[138:139], v14 offset:512
    s_add_u32 s45, s45, s40
    v_mfma_f32_16x16x32_bf16 v[76:79], a[164:167], a[188:191], v[76:79]
    s_add_u32 s44, s44, s41
    ds_read_b128 a[156:159], v43 offset:16640
    v_mfma_f32_16x16x32_bf16 v[80:83], a[168:171], a[176:179], v[80:83]
    ds_read_b64_tr_b16 a[140:141], v15 offset:0
    v_mfma_f32_16x16x32_bf16 v[88:91], a[168:171], a[180:183], v[88:91]
    ds_read_b64_tr_b16 a[142:143], v15 offset:512
    s_add_u32 m0, s49, 12288
    v_mfma_f32_16x16x32_bf16 v[96:99], a[168:171], a[184:187], v[96:99]
    buffer_load_dwordx4 v248, s[96:99], s45 offen offset:0 lds
    v_mfma_f32_16x16x32_bf16 v[104:107], a[168:171], a[188:191], v[104:107]
    v_mfma_f32_16x16x32_bf16 v[84:87], a[172:175], a[176:179], v[84:87]
    buffer_load_dwordx4 v249, s[96:99], s45 offen offset:1024 lds
    v_mfma_f32_16x16x32_bf16 v[92:95], a[172:175], a[180:183], v[92:95]
    buffer_load_dwordx4 v250, s[96:99], s45 offen offset:2048 lds
    v_mfma_f32_16x16x32_bf16 v[100:103], a[172:175], a[184:187], v[100:103]
    v_mfma_f32_16x16x32_bf16 v[108:111], a[172:175], a[188:191], v[108:111]
    buffer_load_dwordx4 v251, s[96:99], s45 offen offset:3072 lds
    s_waitcnt lgkmcnt(0)
    v_mfma_f32_16x16x32_bf16 v[48:51], a[128:131], a[144:147], v[48:51]
    ds_read_b128 a[176:179], v42 offset:18432
    ds_read_b64_tr_b16 a[160:161], v16 offset:0
    v_mfma_f32_16x16x32_bf16 v[56:59], a[128:131], a[148:151], v[56:59]
    ds_read_b64_tr_b16 a[162:163], v16 offset:512
    v_mfma_f32_16x16x32_bf16 v[64:67], a[128:131], a[152:155], v[64:67]
    ds_read_b128 a[180:183], v42 offset:18688
    ds_read_b64_tr_b16 a[164:165], v17 offset:0
    v_mfma_f32_16x16x32_bf16 v[72:75], a[128:131], a[156:159], v[72:75]
    ds_read_b64_tr_b16 a[166:167], v17 offset:512
    v_mfma_f32_16x16x32_bf16 v[52:55], a[132:135], a[144:147], v[52:55]
    ds_read_b128 a[184:187], v43 offset:18432
    ds_read_b64_tr_b16 a[168:169], v18 offset:0
    v_mfma_f32_16x16x32_bf16 v[60:63], a[132:135], a[148:151], v[60:63]
    ds_read_b64_tr_b16 a[170:171], v18 offset:512
    v_mfma_f32_16x16x32_bf16 v[68:71], a[132:135], a[152:155], v[68:71]
    ds_read_b128 a[188:191], v43 offset:18688
    ds_read_b64_tr_b16 a[172:173], v19 offset:0
    v_mfma_f32_16x16x32_bf16 v[76:79], a[132:135], a[156:159], v[76:79]
    ds_read_b64_tr_b16 a[174:175], v19 offset:512
    s_add_u32 m0, s49, 28672
    v_mfma_f32_16x16x32_bf16 v[80:83], a[136:139], a[144:147], v[80:83]
    v_mfma_f32_16x16x32_bf16 v[88:91], a[136:139], a[148:151], v[88:91]
    buffer_load_dwordx4 v47, s[24:27], s44 offen offset:0 sc1 lds
    v_mfma_f32_16x16x32_bf16 v[96:99], a[136:139], a[152:155], v[96:99]
    v_mfma_f32_16x16x32_bf16 v[104:107], a[136:139], a[156:159], v[104:107]
    buffer_load_dwordx4 v47, s[24:27], s44 offen offset:1024 sc1 lds
    v_mfma_f32_16x16x32_bf16 v[84:87], a[140:143], a[144:147], v[84:87]
    v_mfma_f32_16x16x32_bf16 v[92:95], a[140:143], a[148:151], v[92:95]
    buffer_load_dwordx4 v47, s[24:27], s44 offen offset:2048 sc1 lds
    v_mfma_f32_16x16x32_bf16 v[100:103], a[140:143], a[152:155], v[100:103]
    v_mfma_f32_16x16x32_bf16 v[108:111], a[140:143], a[156:159], v[108:111]
    buffer_load_dwordx4 v47, s[24:27], s44 offen offset:3072 sc1 lds
    s_waitcnt vmcnt(16) lgkmcnt(0)
    s_barrier
    v_mfma_f32_16x16x32_bf16 v[48:51], a[160:163], a[176:179], v[48:51]
    ds_read_b128 a[144:147], v42 offset:20480
    ds_read_b64_tr_b16 a[128:129], v12 offset:4096
    v_mfma_f32_16x16x32_bf16 v[56:59], a[160:163], a[180:183], v[56:59]
    ds_read_b64_tr_b16 a[130:131], v12 offset:4608
    s_and_b32 s42, s100, 15
    v_mfma_f32_16x16x32_bf16 v[64:67], a[160:163], a[184:187], v[64:67]
    s_lshr_b64 s[100:101], s[100:101], 4
    ds_read_b128 a[148:151], v42 offset:20736
    v_mfma_f32_16x16x32_bf16 v[72:75], a[160:163], a[188:191], v[72:75]
    ds_read_b64_tr_b16 a[132:133], v13 offset:4096
    ds_read_b64_tr_b16 a[134:135], v13 offset:4608
    v_mfma_f32_16x16x32_bf16 v[52:55], a[164:167], a[176:179], v[52:55]
    s_lshl_b32 s45, s42, 17
    s_lshl_b32 s44, s42, 12
    v_mfma_f32_16x16x32_bf16 v[60:63], a[164:167], a[180:183], v[60:63]
    ds_read_b128 a[152:155], v43 offset:20480
    ds_read_b64_tr_b16 a[136:137], v14 offset:4096
    v_mfma_f32_16x16x32_bf16 v[68:71], a[164:167], a[184:187], v[68:71]
    ds_read_b64_tr_b16 a[138:139], v14 offset:4608
    s_add_u32 s45, s45, s40
    v_mfma_f32_16x16x32_bf16 v[76:79], a[164:167], a[188:191], v[76:79]
    s_add_u32 s44, s44, s41
    ds_read_b128 a[156:159], v43 offset:20736
    v_mfma_f32_16x16x32_bf16 v[80:83], a[168:171], a[176:179], v[80:83]
    ds_read_b64_tr_b16 a[140:141], v15 offset:4096
    v_mfma_f32_16x16x32_bf16 v[88:91], a[168:171], a[180:183], v[88:91]
    ds_read_b64_tr_b16 a[142:143], v15 offset:4608
    s_add_u32 m0, s49, 0
    v_mfma_f32_16x16x32_bf16 v[96:99], a[168:171], a[184:187], v[96:99]
    buffer_load_dwordx4 v248, s[96:99], s45 offen offset:0 lds
    v_mfma_f32_16x16x32_bf16 v[104:107], a[168:171], a[188:191], v[104:107]
    v_mfma_f32_16x16x32_bf16 v[84:87], a[172:175], a[176:179], v[84:87]
    buffer_load_dwordx4 v249, s[96:99], s45 offen offset:1024 lds
    v_mfma_f32_16x16x32_bf16 v[92:95], a[172:175], a[180:183], v[92:95]
    buffer_load_dwordx4 v250, s[96:99], s45 offen offset:2048 lds
    v_mfma_f32_16x16x32_bf16 v[100:103], a[172:175], a[184:187], v[100:103]
    v_mfma_f32_16x16x32_bf16 v[108:111], a[172:175], a[188:191], v[108:111]
    buffer_load_dwordx4 v251, s[96:99], s45 offen offset:3072 lds
    s_waitcnt lgkmcnt(0)
    v_mfma_f32_16x16x32_bf16 v[48:51], a[128:131], a[144:147], v[48:51]
    ds_read_b128 a[176:179], v42 offset:22528
    ds_read_b64_tr_b16 a[160:161], v16 offset:4096
    v_mfma_f32_16x16x32_bf16 v[56:59], a[128:131], a[148:151], v[56:59]
    ds_read_b64_tr_b16 a[162:163], v16 offset:4608
    v_mfma_f32_16x16x32_bf16 v[64:67], a[128:131], a[152:155], v[64:67]
    ds_read_b128 a[180:183], v42 offset:22784
    ds_read_b64_tr_b16 a[164:165], v17 offset:4096
    v_mfma_f32_16x16x32_bf16 v[72:75], a[128:131], a[156:159], v[72:75]
    ds_read_b64_tr_b16 a[166:167], v17 offset:4608
    v_mfma_f32_16x16x32_bf16 v[52:55], a[132:135], a[144:147], v[52:55]
    ds_read_b128 a[184:187], v43 offset:22528
    ds_read_b64_tr_b16 a[168:169], v18 offset:4096
    v_mfma_f32_16x16x32_bf16 v[60:63], a[132:135], a[148:151], v[60:63]
    ds_read_b64_tr_b16 a[170:171], v18 offset:4608
    v_mfma_f32_16x16x32_bf16 v[68:71], a[132:135], a[152:155], v[68:71]
    ds_read_b128 a[188:191], v43 offset:22784
    ds_read_b64_tr_b16 a[172:173], v19 offset:4096
    v_mfma_f32_16x16x32_bf16 v[76:79], a[132:135], a[156:159], v[76:79]
    ds_read_b64_tr_b16 a[174:175], v19 offset:4608
    s_add_u32 m0, s49, 16384
    v_mfma_f32_16x16x32_bf16 v[80:83], a[136:139], a[144:147], v[80:83]
    v_mfma_f32_16x16x32_bf16 v[88:91], a[136:139], a[148:151], v[88:91]
    buffer_load_dwordx4 v47, s[24:27], s44 offen offset:0 sc1 lds
    v_mfma_f32_16x16x32_bf16 v[96:99], a[136:139], a[152:155], v[96:99]
    v_mfma_f32_16x16x32_bf16 v[104:107], a[136:139], a[156:159], v[104:107]
    buffer_load_dwordx4 v47, s[24:27], s44 offen offset:1024 sc1 lds
    v_mfma_f32_16x16x32_bf16 v[84:87], a[140:143], a[144:147], v[84:87]
    v_mfma_f32_16x16x32_bf16 v[92:95], a[140:143], a[148:151], v[92:95]
    buffer_load_dwordx4 v47, s[24:27], s44 offen offset:2048 sc1 lds
    v_mfma_f32_16x16x32_bf16 v[100:103], a[140:143], a[152:155], v[100:103]
    v_mfma_f32_16x16x32_bf16 v[108:111], a[140:143], a[156:159], v[108:111]
    buffer_load_dwordx4 v47, s[24:27], s44 offen offset:3072 sc1 lds
    s_waitcnt vmcnt(16) lgkmcnt(0)
    s_barrier
    v_mfma_f32_16x16x32_bf16 v[48:51], a[160:163], a[176:179], v[48:51]
    ds_read_b128 a[144:147], v42 offset:24576
    ds_read_b64_tr_b16 a[128:129], v12 offset:8192
    v_mfma_f32_16x16x32_bf16 v[56:59], a[160:163], a[180:183], v[56:59]
    ds_read_b64_tr_b16 a[130:131], v12 offset:8704
    s_and_b32 s42, s100, 15
    v_mfma_f32_16x16x32_bf16 v[64:67], a[160:163], a[184:187], v[64:67]
    s_lshr_b64 s[100:101], s[100:101], 4
    ds_read_b128 a[148:151], v42 offset:24832
    v_mfma_f32_16x16x32_bf16 v[72:75], a[160:163], a[188:191], v[72:75]
    ds_read_b64_tr_b16 a[132:133], v13 offset:8192
    ds_read_b64_tr_b16 a[134:135], v13 offset:8704
    v_mfma_f32_16x16x32_bf16 v[52:55], a[164:167], a[176:179], v[52:55]
    s_lshl_b32 s45, s42, 17
    s_lshl_b32 s44, s42, 12
    v_mfma_f32_16x16x32_bf16 v[60:63], a[164:167], a[180:183], v[60:63]
    ds_read_b128 a[152:155], v43 offset:24576
    ds_read_b64_tr_b16 a[136:137], v14 offset:8192
    v_mfma_f32_16x16x32_bf16 v[68:71], a[164:167], a[184:187], v[68:71]
    ds_read_b64_tr_b16 a[138:139], v14 offset:8704
    s_add_u32 s45, s45, s40
    v_mfma_f32_16x16x32_bf16 v[76:79], a[164:167], a[188:191], v[76:79]
    s_add_u32 s44, s44, s41
    ds_read_b128 a[156:159], v43 offset:24832
    v_mfma_f32_16x16x32_bf16 v[80:83], a[168:171], a[176:179], v[80:83]
    ds_read_b64_tr_b16 a[140:141], v15 offset:8192
    v_mfma_f32_16x16x32_bf16 v[88:91], a[168:171], a[180:183], v[88:91]
    ds_read_b64_tr_b16 a[142:143], v15 offset:8704
    s_add_u32 m0, s49, 4096
    v_mfma_f32_16x16x32_bf16 v[96:99], a[168:171], a[184:187], v[96:99]
    buffer_load_dwordx4 v248, s[96:99], s45 offen offset:0 lds
    v_mfma_f32_16x16x32_bf16 v[104:107], a[168:171], a[188:191], v[104:107]
    v_mfma_f32_16x16x32_bf16 v[84:87], a[172:175], a[176:179], v[84:87]
    buffer_load_dwordx4 v249, s[96:99], s45 offen offset:1024 lds
    v_mfma_f32_16x16x32_bf16 v[92:95], a[172:175], a[180:183], v[92:95]
    buffer_load_dwordx4 v250, s[96:99], s45 offen offset:2048 lds
    v_mfma_f32_16x16x32_bf16 v[100:103], a[172:175], a[184:187], v[100:103]
    v_mfma_f32_16x16x32_bf16 v[108:111], a[172:175], a[188:191], v[108:111]
    buffer_load_dwordx4 v251, s[96:99], s45 offen offset:3072 lds
    s_waitcnt lgkmcnt(0)
    v_mfma_f32_16x16x32_bf16 v[48:51], a[128:131], a[144:147], v[48:51]
    ds_read_b128 a[176:179], v42 offset:26624
    ds_read_b64_tr_b16 a[160:161], v16 offset:8192
    v_mfma_f32_16x16x32_bf16 v[56:59], a[128:131], a[148:151], v[56:59]
    ds_read_b64_tr_b16 a[162:163], v16 offset:8704
    v_mfma_f32_16x16x32_bf16 v[64:67], a[128:131], a[152:155], v[64:67]
    ds_read_b128 a[180:183], v42 offset:26880
    ds_read_b64_tr_b16 a[164:165], v17 offset:8192
    v_mfma_f32_16x16x32_bf16 v[72:75], a[128:131], a[156:159], v[72:75]
    ds_read_b64_tr_b16 a[166:167], v17 offset:8704
    v_mfma_f32_16x16x32_bf16 v[52:55], a[132:135], a[144:147], v[52:55]
    ds_read_b128 a[184:187], v43 offset:26624
    ds_read_b64_tr_b16 a[168:169], v18 offset:8192
    v_mfma_f32_16x16x32_bf16 v[60:63], a[132:135], a[148:151], v[60:63]
    ds_read_b64_tr_b16 a[170:171], v18 offset:8704
    v_mfma_f32_16x16x32_bf16 v[68:71], a[132:135], a[152:155], v[68:71]
    ds_read_b128 a[188:191], v43 offset:26880
    ds_read_b64_tr_b16 a[172:173], v19 offset:8192
    v_mfma_f32_16x16x32_bf16 v[76:79], a[132:135], a[156:159], v[76:79]
    ds_read_b64_tr_b16 a[174:175], v19 offset:8704
    s_add_u32 m0, s49, 20480
    v_mfma_f32_16x16x32_bf16 v[80:83], a[136:139], a[144:147], v[80:83]
    v_mfma_f32_16x16x32_bf16 v[88:91], a[136:139], a[148:151], v[88:91]
    buffer_load_dwordx4 v47, s[24:27], s44 offen offset:0 sc1 lds
    v_mfma_f32_16x16x32_bf16 v[96:99], a[136:139], a[152:155], v[96:99]
    v_mfma_f32_16x16x32_bf16 v[104:107], a[136:139], a[156:159], v[104:107]
    buffer_load_dwordx4 v47, s[24:27], s44 offen offset:1024 sc1 lds
    v_mfma_f32_16x16x32_bf16 v[84:87], a[140:143], a[144:147], v[84:87]
    v_mfma_f32_16x16x32_bf16 v[92:95], a[140:143], a[148:151], v[92:95]
    buffer_load_dwordx4 v47, s[24:27], s44 offen offset:2048 sc1 lds
    v_mfma_f32_16x16x32_bf16 v[100:103], a[140:143], a[152:155], v[100:103]
    v_mfma_f32_16x16x32_bf16 v[108:111], a[140:143], a[156:159], v[108:111]
    buffer_load_dwordx4 v47, s[24:27], s44 offen offset:3072 sc1 lds
    s_waitcnt vmcnt(16) lgkmcnt(0)
    s_barrier
    v_mfma_f32_16x16x32_bf16 v[48:51], a[160:163], a[176:179], v[48:51]
    ds_read_b128 a[144:147], v42 offset:28672
    ds_read_b64_tr_b16 a[128:129], v12 offset:12288
    v_mfma_f32_16x16x32_bf16 v[56:59], a[160:163], a[180:183], v[56:59]
    ds_read_b64_tr_b16 a[130:131], v12 offset:12800
    s_and_b32 s42, s100, 15
    v_mfma_f32_16x16x32_bf16 v[64:67], a[160:163], a[184:187], v[64:67]
    s_lshr_b64 s[100:101], s[100:101], 4
    ds_read_b128 a[148:151], v42 offset:28928
    v_mfma_f32_16x16x32_bf16 v[72:75], a[160:163], a[188:191], v[72:75]
    ds_read_b64_tr_b16 a[132:133], v13 offset:12288
    ds_read_b64_tr_b16 a[134:135], v13 offset:12800
    v_mfma_f32_16x16x32_bf16 v[52:55], a[164:167], a[176:179], v[52:55]
    s_lshl_b32 s45, s42, 17
    s_lshl_b32 s44, s42, 12
    v_mfma_f32_16x16x32_bf16 v[60:63], a[164:167], a[180:183], v[60:63]
    ds_read_b128 a[152:155], v43 offset:28672
    ds_read_b64_tr_b16 a[136:137], v14 offset:12288
    v_mfma_f32_16x16x32_bf16 v[68:71], a[164:167], a[184:187], v[68:71]
    ds_read_b64_tr_b16 a[138:139], v14 offset:12800
    s_add_u32 s45, s45, s40
    v_mfma_f32_16x16x32_bf16 v[76:79], a[164:167], a[188:191], v[76:79]
    s_add_u32 s44, s44, s41
    ds_read_b128 a[156:159], v43 offset:28928
    v_mfma_f32_16x16x32_bf16 v[80:83], a[168:171], a[176:179], v[80:83]
    ds_read_b64_tr_b16 a[140:141], v15 offset:12288
    v_mfma_f32_16x16x32_bf16 v[88:91], a[168:171], a[180:183], v[88:91]
    ds_read_b64_tr_b16 a[142:143], v15 offset:12800
    s_add_u32 m0, s49, 8192
    v_mfma_f32_16x16x32_bf16 v[96:99], a[168:171], a[184:187], v[96:99]
    buffer_load_dwordx4 v248, s[96:99], s45 offen offset:0 lds
    v_mfma_f32_16x16x32_bf16 v[104:107], a[168:171], a[188:191], v[104:107]
    v_mfma_f32_16x16x32_bf16 v[84:87], a[172:175], a[176:179], v[84:87]
    buffer_load_dwordx4 v249, s[96:99], s45 offen offset:1024 lds
    v_mfma_f32_16x16x32_bf16 v[92:95], a[172:175], a[180:183], v[92:95]
    buffer_load_dwordx4 v250, s[96:99], s45 offen offset:2048 lds
    v_mfma_f32_16x16x32_bf16 v[100:103], a[172:175], a[184:187], v[100:103]
    v_mfma_f32_16x16x32_bf16 v[108:111], a[172:175], a[188:191], v[108:111]
    buffer_load_dwordx4 v251, s[96:99], s45 offen offset:3072 lds
    s_waitcnt lgkmcnt(0)
    v_mfma_f32_16x16x32_bf16 v[48:51], a[128:131], a[144:147], v[48:51]
    ds_read_b128 a[176:179], v42 offset:30720
    ds_read_b64_tr_b16 a[160:161], v16 offset:12288
    v_mfma_f32_16x16x32_bf16 v[56:59], a[128:131], a[148:151], v[56:59]
    ds_read_b64_tr_b16 a[162:163], v16 offset:12800
    v_mfma_f32_16x16x32_bf16 v[64:67], a[128:131], a[152:155], v[64:67]
    ds_read_b128 a[180:183], v42 offset:30976
    ds_read_b64_tr_b16 a[164:165], v17 offset:12288
    v_mfma_f32_16x16x32_bf16 v[72:75], a[128:131], a[156:159], v[72:75]
    ds_read_b64_tr_b16 a[166:167], v17 offset:12800
    v_mfma_f32_16x16x32_bf16 v[52:55], a[132:135], a[144:147], v[52:55]
    ds_read_b128 a[184:187], v43 offset:30720
    ds_read_b64_tr_b16 a[168:169], v18 offset:12288
    v_mfma_f32_16x16x32_bf16 v[60:63], a[132:135], a[148:151], v[60:63]
    ds_read_b64_tr_b16 a[170:171], v18 offset:12800
    v_mfma_f32_16x16x32_bf16 v[68:71], a[132:135], a[152:155], v[68:71]
    ds_read_b128 a[188:191], v43 offset:30976
    ds_read_b64_tr_b16 a[172:173], v19 offset:12288
    v_mfma_f32_16x16x32_bf16 v[76:79], a[132:135], a[156:159], v[76:79]
    ds_read_b64_tr_b16 a[174:175], v19 offset:12800
    s_add_u32 m0, s49, 24576
    v_mfma_f32_16x16x32_bf16 v[80:83], a[136:139], a[144:147], v[80:83]
    v_mfma_f32_16x16x32_bf16 v[88:91], a[136:139], a[148:151], v[88:91]
    buffer_load_dwordx4 v47, s[24:27], s44 offen offset:0 sc1 lds
    v_mfma_f32_16x16x32_bf16 v[96:99], a[136:139], a[152:155], v[96:99]
    v_mfma_f32_16x16x32_bf16 v[104:107], a[136:139], a[156:159], v[104:107]
    buffer_load_dwordx4 v47, s[24:27], s44 offen offset:1024 sc1 lds
    v_mfma_f32_16x16x32_bf16 v[84:87], a[140:143], a[144:147], v[84:87]
    v_mfma_f32_16x16x32_bf16 v[92:95], a[140:143], a[148:151], v[92:95]
    buffer_load_dwordx4 v47, s[24:27], s44 offen offset:2048 sc1 lds
    v_mfma_f32_16x16x32_bf16 v[100:103], a[140:143], a[152:155], v[100:103]
    v_mfma_f32_16x16x32_bf16 v[108:111], a[140:143], a[156:159], v[108:111]
    buffer_load_dwordx4 v47, s[24:27], s44 offen offset:3072 sc1 lds
    s_waitcnt vmcnt(16) lgkmcnt(0)
    s_barrier
    v_mfma_f32_16x16x32_bf16 v[48:51], a[160:163], a[176:179], v[48:51]
    ds_read_b128 a[144:147], v42 offset:16384
    ds_read_b64_tr_b16 a[128:129], v12 offset:0
    v_mfma_f32_16x16x32_bf16 v[56:59], a[160:163], a[180:183], v[56:59]
    ds_read_b64_tr_b16 a[130:131], v12 offset:512
    s_and_b32 s42, s100, 15
    v_mfma_f32_16x16x32_bf16 v[64:67], a[160:163], a[184:187], v[64:67]
    s_lshr_b64 s[100:101], s[100:101], 4
    ds_read_b128 a[148:151], v42 offset:16640
    v_mfma_f32_16x16x32_bf16 v[72:75], a[160:163], a[188:191], v[72:75]
    ds_read_b64_tr_b16 a[132:133], v13 offset:0
    ds_read_b64_tr_b16 a[134:135], v13 offset:512
    v_mfma_f32_16x16x32_bf16 v[52:55], a[164:167], a[176:179], v[52:55]
    s_lshl_b32 s45, s42, 17
    s_lshl_b32 s44, s42, 12
    v_mfma_f32_16x16x32_bf16 v[60:63], a[164:167], a[180:183], v[60:63]
    ds_read_b128 a[152:155], v43 offset:16384
    ds_read_b64_tr_b16 a[136:137], v14 offset:0
    v_mfma_f32_16x16x32_bf16 v[68:71], a[164:167], a[184:187], v[68:71]
    ds_read_b64_tr_b16 a[138:139], v14 offset:512
    s_add_u32 s45, s45, s40
    v_mfma_f32_16x16x32_bf16 v[76:79], a[164:167], a[188:191], v[76:79]
    s_add_u32 s44, s44, s41
    ds_read_b128 a[156:159], v43 offset:16640
    v_mfma_f32_16x16x32_bf16 v[80:83], a[168:171], a[176:179], v[80:83]
    ds_read_b64_tr_b16 a[140:141], v15 offset:0
    v_mfma_f32_16x16x32_bf16 v[88:91], a[168:171], a[180:183], v[88:91]
    ds_read_b64_tr_b16 a[142:143], v15 offset:512
    s_add_u32 m0, s49, 12288
    v_mfma_f32_16x16x32_bf16 v[96:99], a[168:171], a[184:187], v[96:99]
    buffer_load_dwordx4 v248, s[96:99], s45 offen offset:0 lds
    v_mfma_f32_16x16x32_bf16 v[104:107], a[168:171], a[188:191], v[104:107]
    v_mfma_f32_16x16x32_bf16 v[84:87], a[172:175], a[176:179], v[84:87]
    buffer_load_dwordx4 v249, s[96:99], s45 offen offset:1024 lds
    v_mfma_f32_16x16x32_bf16 v[92:95], a[172:175], a[180:183], v[92:95]
    buffer_load_dwordx4 v250, s[96:99], s45 offen offset:2048 lds
    v_mfma_f32_16x16x32_bf16 v[100:103], a[172:175], a[184:187], v[100:103]
    v_mfma_f32_16x16x32_bf16 v[108:111], a[172:175], a[188:191], v[108:111]
    buffer_load_dwordx4 v251, s[96:99], s45 offen offset:3072 lds
    s_waitcnt lgkmcnt(0)
    v_mfma_f32_16x16x32_bf16 v[48:51], a[128:131], a[144:147], v[48:51]
    ds_read_b128 a[176:179], v42 offset:18432
    ds_read_b64_tr_b16 a[160:161], v16 offset:0
    v_mfma_f32_16x16x32_bf16 v[56:59], a[128:131], a[148:151], v[56:59]
    ds_read_b64_tr_b16 a[162:163], v16 offset:512
    v_mfma_f32_16x16x32_bf16 v[64:67], a[128:131], a[152:155], v[64:67]
    ds_read_b128 a[180:183], v42 offset:18688
    ds_read_b64_tr_b16 a[164:165], v17 offset:0
    v_mfma_f32_16x16x32_bf16 v[72:75], a[128:131], a[156:159], v[72:75]
    ds_read_b64_tr_b16 a[166:167], v17 offset:512
    v_mfma_f32_16x16x32_bf16 v[52:55], a[132:135], a[144:147], v[52:55]
    ds_read_b128 a[184:187], v43 offset:18432
    ds_read_b64_tr_b16 a[168:169], v18 offset:0
    v_mfma_f32_16x16x32_bf16 v[60:63], a[132:135], a[148:151], v[60:63]
    ds_read_b64_tr_b16 a[170:171], v18 offset:512
    v_mfma_f32_16x16x32_bf16 v[68:71], a[132:135], a[152:155], v[68:71]
    ds_read_b128 a[188:191], v43 offset:18688
    ds_read_b64_tr_b16 a[172:173], v19 offset:0
    v_mfma_f32_16x16x32_bf16 v[76:79], a[132:135], a[156:159], v[76:79]
    ds_read_b64_tr_b16 a[174:175], v19 offset:512
    s_add_u32 m0, s49, 28672
    v_mfma_f32_16x16x32_bf16 v[80:83], a[136:139], a[144:147], v[80:83]
    v_mfma_f32_16x16x32_bf16 v[88:91], a[136:139], a[148:151], v[88:91]
    buffer_load_dwordx4 v47, s[24:27], s44 offen offset:0 sc1 lds
    v_mfma_f32_16x16x32_bf16 v[96:99], a[136:139], a[152:155], v[96:99]
    v_mfma_f32_16x16x32_bf16 v[104:107], a[136:139], a[156:159], v[104:107]
    buffer_load_dwordx4 v47, s[24:27], s44 offen offset:1024 sc1 lds
    v_mfma_f32_16x16x32_bf16 v[84:87], a[140:143], a[144:147], v[84:87]
    v_mfma_f32_16x16x32_bf16 v[92:95], a[140:143], a[148:151], v[92:95]
    buffer_load_dwordx4 v47, s[24:27], s44 offen offset:2048 sc1 lds
    v_mfma_f32_16x16x32_bf16 v[100:103], a[140:143], a[152:155], v[100:103]
    v_mfma_f32_16x16x32_bf16 v[108:111], a[140:143], a[156:159], v[108:111]
    buffer_load_dwordx4 v47, s[24:27], s44 offen offset:3072 sc1 lds
    s_waitcnt vmcnt(16) lgkmcnt(0)
    s_barrier
    v_mfma_f32_16x16x32_bf16 v[48:51], a[160:163], a[176:179], v[48:51]
    ds_read_b128 a[144:147], v42 offset:20480
    ds_read_b64_tr_b16 a[128:129], v12 offset:4096
    v_mfma_f32_16x16x32_bf16 v[56:59], a[160:163], a[180:183], v[56:59]
    ds_read_b64_tr_b16 a[130:131], v12 offset:4608
    s_xor_b32 s3, s2, 1
    v_mfma_f32_16x16x32_bf16 v[64:67], a[160:163], a[184:187], v[64:67]
    s_mul_i32 s3, s3, 12
    v_mfma_f32_16x16x32_bf16 v[72:75], a[160:163], a[188:191], v[72:75]
    ds_read_b128 a[148:151], v42 offset:20736
    ds_read_b64_tr_b16 a[132:133], v13 offset:4096
    v_mfma_f32_16x16x32_bf16 v[52:55], a[164:167], a[176:179], v[52:55]
    ds_read_b64_tr_b16 a[134:135], v13 offset:4608
    s_add_u32 s3, s3, s5
    v_mfma_f32_16x16x32_bf16 v[60:63], a[164:167], a[180:183], v[60:63]
    s_lshl_b32 s3, s3, 11
    ds_read_b128 a[152:155], v43 offset:20480
    v_mfma_f32_16x16x32_bf16 v[68:71], a[164:167], a[184:187], v[68:71]
    ds_read_b64_tr_b16 a[136:137], v14 offset:4096
    v_mfma_f32_16x16x32_bf16 v[76:79], a[164:167], a[188:191], v[76:79]
    ds_read_b64_tr_b16 a[138:139], v14 offset:4608
    s_add_u32 s64, s3, 16777216
    v_mfma_f32_16x16x32_bf16 v[80:83], a[168:171], a[176:179], v[80:83]
    s_xor_b32 s3, s2, 2
    ds_read_b128 a[156:159], v43 offset:20736
    v_mfma_f32_16x16x32_bf16 v[88:91], a[168:171], a[180:183], v[88:91]
    ds_read_b64_tr_b16 a[140:141], v15 offset:4096
    ds_read_b64_tr_b16 a[142:143], v15 offset:4608
    v_mfma_f32_16x16x32_bf16 v[96:99], a[168:171], a[184:187], v[96:99]
    s_mul_i32 s3, s3, 12
    v_mfma_f32_16x16x32_bf16 v[104:107], a[168:171], a[188:191], v[104:107]
    s_add_u32 s3, s3, s5
    s_lshl_b32 s3, s3, 11
    v_mfma_f32_16x16x32_bf16 v[84:87], a[172:175], a[176:179], v[84:87]
    s_add_u32 s65, s3, 16785408
    s_xor_b32 s3, s2, 3
    v_mfma_f32_16x16x32_bf16 v[92:95], a[172:175], a[180:183], v[92:95]
    s_mul_i32 s3, s3, 12
    s_add_u32 s3, s3, s5
    v_mfma_f32_16x16x32_bf16 v[100:103], a[172:175], a[184:187], v[100:103]
    s_lshl_b32 s3, s3, 11
    v_mfma_f32_16x16x32_bf16 v[108:111], a[172:175], a[188:191], v[108:111]
    s_add_u32 s66, s3, 16793600
    v_xor_b32 v30, s2, v1
    s_waitcnt lgkmcnt(0)
    v_mfma_f32_16x16x32_bf16 v[48:51], a[128:131], a[144:147], v[48:51]
    ds_read_b128 a[176:179], v42 offset:22528
    v_mfma_f32_16x16x32_bf16 v[56:59], a[128:131], a[148:151], v[56:59]
    ds_read_b64_tr_b16 a[160:161], v16 offset:4096
    v_mfma_f32_16x16x32_bf16 v[64:67], a[128:131], a[152:155], v[64:67]
    v_mfma_f32_16x16x32_bf16 v[72:75], a[128:131], a[156:159], v[72:75]
    ds_read_b64_tr_b16 a[162:163], v16 offset:4608
    v_mfma_f32_16x16x32_bf16 v[52:55], a[132:135], a[144:147], v[52:55]
    ds_read_b128 a[180:183], v42 offset:22784
    v_mfma_f32_16x16x32_bf16 v[60:63], a[132:135], a[148:151], v[60:63]
    ds_read_b64_tr_b16 a[164:165], v17 offset:4096
    v_mfma_f32_16x16x32_bf16 v[68:71], a[132:135], a[152:155], v[68:71]
    v_mfma_f32_16x16x32_bf16 v[76:79], a[132:135], a[156:159], v[76:79]
    ds_read_b64_tr_b16 a[166:167], v17 offset:4608
    v_mfma_f32_16x16x32_bf16 v[80:83], a[136:139], a[144:147], v[80:83]
    ds_read_b128 a[184:187], v43 offset:22528
    v_mfma_f32_16x16x32_bf16 v[88:91], a[136:139], a[148:151], v[88:91]
    ds_read_b64_tr_b16 a[168:169], v18 offset:4096
    v_mfma_f32_16x16x32_bf16 v[96:99], a[136:139], a[152:155], v[96:99]
    v_mfma_f32_16x16x32_bf16 v[104:107], a[136:139], a[156:159], v[104:107]
    ds_read_b64_tr_b16 a[170:171], v18 offset:4608
    v_mfma_f32_16x16x32_bf16 v[84:87], a[140:143], a[144:147], v[84:87]
    ds_read_b128 a[188:191], v43 offset:22784
    v_mfma_f32_16x16x32_bf16 v[92:95], a[140:143], a[148:151], v[92:95]
    ds_read_b64_tr_b16 a[172:173], v19 offset:4096
    v_mfma_f32_16x16x32_bf16 v[100:103], a[140:143], a[152:155], v[100:103]
    v_mfma_f32_16x16x32_bf16 v[108:111], a[140:143], a[156:159], v[108:111]
    ds_read_b64_tr_b16 a[174:175], v19 offset:4608
    s_waitcnt vmcnt(0) lgkmcnt(0)
    s_barrier
    v_mfma_f32_16x16x32_bf16 v[48:51], a[160:163], a[176:179], v[48:51]
    ds_read_b64_tr_b16 a[8:9], v14 offset:8192
    ds_read_b64_tr_b16 a[10:11], v14 offset:8704
    ds_read_b128 a[24:27], v43 offset:24576
    v_mfma_f32_16x16x32_bf16 v[56:59], a[160:163], a[180:183], v[56:59]
    v_lshlrev_b32 v30, 9, v30
    v_add_u32 v31, -1, v1
    v_cmp_gt_u32 vcc, 3, v31
    v_mfma_f32_16x16x32_bf16 v[64:67], a[160:163], a[184:187], v[64:67]
    v_mov_b32 v31, 0x40000000
    s_lshl_b32 s56, s5, 7
    ds_read_b128 a[28:31], v43 offset:24832
    v_mfma_f32_16x16x32_bf16 v[72:75], a[160:163], a[188:191], v[72:75]
    ds_read_b64_tr_b16 a[12:13], v15 offset:8192
    ds_read_b64_tr_b16 a[14:15], v15 offset:8704
    s_add_u32 s56, s56, 15990784
    v_mfma_f32_16x16x32_bf16 v[52:55], a[164:167], a[176:179], v[52:55]
    v_cndmask_b32 v30, v31, v30, vcc
    s_add_u32 s75, s75, 131072
    s_mul_i32 s3, s2, 12
    v_mfma_f32_16x16x32_bf16 v[60:63], a[164:167], a[180:183], v[60:63]
    s_add_u32 s3, s3, s5
    ds_read_b64_tr_b16 a[40:41], v18 offset:8192
    ds_read_b64_tr_b16 a[42:43], v18 offset:8704
    v_mfma_f32_16x16x32_bf16 v[68:71], a[164:167], a[184:187], v[68:71]
    ds_read_b128 a[56:59], v43 offset:26624
    s_lshl_b32 s3, s3, 11
    s_add_u32 s50, s3, 16777216
    v_mfma_f32_16x16x32_bf16 v[76:79], a[164:167], a[188:191], v[76:79]
    s_add_u32 s51, s3, 16785408
    s_add_u32 s52, s3, 16793600
    ds_read_b128 a[60:63], v43 offset:26880
    ds_read_b64_tr_b16 a[44:45], v19 offset:8192
    v_mfma_f32_16x16x32_bf16 v[80:83], a[168:171], a[176:179], v[80:83]
    ds_read_b64_tr_b16 a[46:47], v19 offset:8704
    v_and_b32 v24, 15, v1
    v_lshlrev_b32 v24, 12, v24
    v_mfma_f32_16x16x32_bf16 v[88:91], a[168:171], a[180:183], v[88:91]
    v_lshrrev_b32 v25, 5, v1
    v_lshl_add_u32 v24, v25, 4, v24
    v_bfe_u32 v25, v1, 4, 1
    v_mfma_f32_16x16x32_bf16 v[96:99], a[168:171], a[184:187], v[96:99]
    v_lshl_add_u32 v24, v25, 5, v24
    v_add_u32 v25, 0x10000, v24
    s_lshl_b32 s3, s28, 2
    v_mfma_f32_16x16x32_bf16 v[104:107], a[168:171], a[188:191], v[104:107]
    s_and_b32 s4, s5, 2
    s_add_u32 s3, s3, s4
    s_lshr_b32 s4, s6, 1
    v_mfma_f32_16x16x32_bf16 v[84:87], a[172:175], a[176:179], v[84:87]
    s_add_u32 s3, s3, s4
    s_lshl_b32 s57, s3, 17
    s_lshl_b32 s4, s29, 11
    v_mfma_f32_16x16x32_bf16 v[92:95], a[172:175], a[180:183], v[92:95]
    s_add_u32 s57, s57, s4
    s_lshl_b32 s4, s7, 8
    s_add_u32 s57, s57, s4
    v_mfma_f32_16x16x32_bf16 v[100:103], a[172:175], a[184:187], v[100:103]
    s_and_b32 s4, s5, 1
    s_lshl_b32 s4, s4, 7
    s_add_u32 s57, s57, s4
    v_mfma_f32_16x16x32_bf16 v[108:111], a[172:175], a[188:191], v[108:111]
    s_and_b32 s4, s6, 1
    s_lshl_b32 s4, s4, 6
    s_add_u32 s57, s57, s4
    s_waitcnt lgkmcnt(0)
    v_mfma_f32_16x16x32_bf16 v[96:99], a[8:11], a[24:27], v[96:99]
    ds_read_b64_tr_b16 a[72:73], v14 offset:12288
    ds_read_b64_tr_b16 a[74:75], v14 offset:12800
    v_mfma_f32_16x16x32_bf16 v[104:107], a[8:11], a[28:31], v[104:107]
    ds_read_b128 a[88:91], v43 offset:28672
    ds_read_b128 a[92:95], v43 offset:28928
    v_mfma_f32_16x16x32_bf16 v[108:111], a[12:15], a[28:31], v[108:111]
    ds_read_b64_tr_b16 a[76:77], v15 offset:12288
    ds_read_b64_tr_b16 a[78:79], v15 offset:12800
    v_mfma_f32_16x16x32_bf16 v[100:103], a[12:15], a[24:27], v[100:103]
    ds_read_b64_tr_b16 a[104:105], v18 offset:12288
    ds_read_b64_tr_b16 a[106:107], v18 offset:12800
    v_mfma_f32_16x16x32_bf16 v[96:99], a[40:43], a[56:59], v[96:99]
    ds_read_b128 a[120:123], v43 offset:30720
    ds_read_b128 a[124:127], v43 offset:30976
    v_mfma_f32_16x16x32_bf16 v[104:107], a[40:43], a[60:63], v[104:107]
    ds_read_b64_tr_b16 a[108:109], v19 offset:12288
    ds_read_b64_tr_b16 a[110:111], v19 offset:12800
    v_mfma_f32_16x16x32_bf16 v[108:111], a[44:47], a[60:63], v[108:111]
    ds_read_b128 a[16:19], v42 offset:24576
    ds_read_b128 a[20:23], v42 offset:24832
    v_mfma_f32_16x16x32_bf16 v[100:103], a[44:47], a[56:59], v[100:103]
    s_waitcnt lgkmcnt(11)
    v_mfma_f32_16x16x32_bf16 v[96:99], a[72:75], a[88:91], v[96:99]
    ds_read_b128 a[48:51], v42 offset:26624
    ds_read_b128 a[52:55], v42 offset:26880
    s_branch IP_sk8
IP_pg8:
    s_branch IP_ret5
IP_sk8:
    s_waitcnt lgkmcnt(12)
    v_mfma_f32_16x16x32_bf16 v[104:107], a[72:75], a[92:95], v[104:107]
    ds_read_b128 a[80:83], v42 offset:28672
    ds_read_b128 a[84:87], v42 offset:28928
    s_waitcnt lgkmcnt(12)
    v_mfma_f32_16x16x32_bf16 v[108:111], a[76:79], a[92:95], v[108:111]
    ds_read_b128 a[112:115], v42 offset:30720
    ds_read_b128 a[116:119], v42 offset:30976
    v_mfma_f32_16x16x32_bf16 v[100:103], a[76:79], a[88:91], v[100:103]
    s_waitcnt lgkmcnt(11)
    v_mfma_f32_16x16x32_bf16 v[96:99], a[104:107], a[120:123], v[96:99]
    ds_read_b64_tr_b16 a[0:1], v12 offset:8192
    ds_read_b64_tr_b16 a[2:3], v12 offset:8704
    s_waitcnt lgkmcnt(12)
    v_mfma_f32_16x16x32_bf16 v[104:107], a[104:107], a[124:127], v[104:107]
    ds_read_b64_tr_b16 a[4:5], v13 offset:8192
    ds_read_b64_tr_b16 a[6:7], v13 offset:8704
    s_waitcnt lgkmcnt(12)
    v_mfma_f32_16x16x32_bf16 v[108:111], a[108:111], a[124:127], v[108:111]
    ds_read_b64_tr_b16 a[32:33], v16 offset:8192
    ds_read_b64_tr_b16 a[34:35], v16 offset:8704
    v_mfma_f32_16x16x32_bf16 v[100:103], a[108:111], a[120:123], v[100:103]
    s_nop 0
    s_waitcnt lgkmcnt(13)
    v_mfma_f32_16x16x32_bf16 v[80:83], a[8:11], a[16:19], v[80:83]
    ds_read_b64_tr_b16 a[36:37], v17 offset:8192
    s_waitcnt lgkmcnt(13)
    v_mfma_f32_16x16x32_bf16 v[88:91], a[8:11], a[20:23], v[88:91]
    ds_read_b64_tr_b16 a[38:39], v17 offset:8704
    v_mfma_f32_16x16x32_bf16 v[92:95], a[12:15], a[20:23], v[92:95]
    v_cvt_pk_bf16_f32 v168, v96, v97
    v_cvt_pk_bf16_f32 v169, v98, v99
    v_mfma_f32_16x16x32_bf16 v[84:87], a[12:15], a[16:19], v[84:87]
    v_cvt_pk_bf16_f32 v170, v100, v101
    v_cvt_pk_bf16_f32 v171, v102, v103
    s_waitcnt lgkmcnt(13)
    v_mfma_f32_16x16x32_bf16 v[80:83], a[40:43], a[48:51], v[80:83]
    ds_read_b64_tr_b16 a[64:65], v12 offset:12288
    buffer_store_dwordx4 v[168:171], v47, s[24:27], s66 offen offset:0 sc1
    s_waitcnt lgkmcnt(13)
    v_mfma_f32_16x16x32_bf16 v[88:91], a[40:43], a[52:55], v[88:91]
    ds_read_b64_tr_b16 a[66:67], v12 offset:12800
    v_cvt_pk_bf16_f32 v172, v104, v105
    v_mfma_f32_16x16x32_bf16 v[92:95], a[44:47], a[52:55], v[92:95]
    v_cvt_pk_bf16_f32 v173, v106, v107
    v_cvt_pk_bf16_f32 v174, v108, v109
    v_mfma_f32_16x16x32_bf16 v[84:87], a[44:47], a[48:51], v[84:87]
    v_cvt_pk_bf16_f32 v175, v110, v111
    buffer_store_dwordx4 v[172:175], v47, s[24:27], s66 offen offset:1024 sc1
    s_waitcnt lgkmcnt(13)
    v_mfma_f32_16x16x32_bf16 v[80:83], a[72:75], a[80:83], v[80:83]
    ds_read_b64_tr_b16 a[68:69], v13 offset:12288
    s_waitcnt lgkmcnt(13)
    v_mfma_f32_16x16x32_bf16 v[88:91], a[72:75], a[84:87], v[88:91]
    ds_read_b64_tr_b16 a[70:71], v13 offset:12800
    v_mfma_f32_16x16x32_bf16 v[92:95], a[76:79], a[84:87], v[92:95]
    v_mfma_f32_16x16x32_bf16 v[84:87], a[76:79], a[80:83], v[84:87]
    s_waitcnt lgkmcnt(13)
    v_mfma_f32_16x16x32_bf16 v[80:83], a[104:107], a[112:115], v[80:83]
    ds_read_b64_tr_b16 a[96:97], v16 offset:12288
    s_waitcnt lgkmcnt(13)
    v_mfma_f32_16x16x32_bf16 v[88:91], a[104:107], a[116:119], v[88:91]
    ds_read_b64_tr_b16 a[98:99], v16 offset:12800
    v_mfma_f32_16x16x32_bf16 v[92:95], a[108:111], a[116:119], v[92:95]
    v_mfma_f32_16x16x32_bf16 v[84:87], a[108:111], a[112:115], v[84:87]
    s_nop 0
    s_waitcnt lgkmcnt(12)
    v_mfma_f32_16x16x32_bf16 v[64:67], a[0:3], a[24:27], v[64:67]
    ds_read_b64_tr_b16 a[100:101], v17 offset:12288
    ds_read_b64_tr_b16 a[102:103], v17 offset:12800
    v_mfma_f32_16x16x32_bf16 v[72:75], a[0:3], a[28:31], v[72:75]
    s_nop 0
    s_waitcnt lgkmcnt(12)
    v_mfma_f32_16x16x32_bf16 v[76:79], a[4:7], a[28:31], v[76:79]
    v_cvt_pk_bf16_f32 v152, v80, v81
    v_cvt_pk_bf16_f32 v153, v82, v83
    v_mfma_f32_16x16x32_bf16 v[68:71], a[4:7], a[24:27], v[68:71]
    v_cvt_pk_bf16_f32 v154, v84, v85
    v_cvt_pk_bf16_f32 v155, v86, v87
    s_waitcnt lgkmcnt(10)
    v_mfma_f32_16x16x32_bf16 v[64:67], a[32:35], a[56:59], v[64:67]
    buffer_store_dwordx4 v[152:155], v47, s[24:27], s64 offen offset:0 sc1
    v_cvt_pk_bf16_f32 v156, v88, v89
    v_mfma_f32_16x16x32_bf16 v[72:75], a[32:35], a[60:63], v[72:75]
    v_cvt_pk_bf16_f32 v157, v90, v91
    v_cvt_pk_bf16_f32 v158, v92, v93
    s_waitcnt lgkmcnt(8)
    v_mfma_f32_16x16x32_bf16 v[76:79], a[36:39], a[60:63], v[76:79]
    v_cvt_pk_bf16_f32 v159, v94, v95
    buffer_store_dwordx4 v[156:159], v47, s[24:27], s64 offen offset:1024 sc1
    v_mfma_f32_16x16x32_bf16 v[68:71], a[36:39], a[56:59], v[68:71]
    s_waitcnt lgkmcnt(6)
    v_mfma_f32_16x16x32_bf16 v[64:67], a[64:67], a[88:91], v[64:67]
    v_mfma_f32_16x16x32_bf16 v[72:75], a[64:67], a[92:95], v[72:75]
    s_waitcnt lgkmcnt(4)
    v_mfma_f32_16x16x32_bf16 v[76:79], a[68:71], a[92:95], v[76:79]
    v_mfma_f32_16x16x32_bf16 v[68:71], a[68:71], a[88:91], v[68:71]
    s_waitcnt lgkmcnt(2)
    v_mfma_f32_16x16x32_bf16 v[64:67], a[96:99], a[120:123], v[64:67]
    v_mfma_f32_16x16x32_bf16 v[72:75], a[96:99], a[124:127], v[72:75]
    s_waitcnt lgkmcnt(0)
    v_mfma_f32_16x16x32_bf16 v[76:79], a[100:103], a[124:127], v[76:79]
    v_mfma_f32_16x16x32_bf16 v[68:71], a[100:103], a[120:123], v[68:71]
    s_nop 0
    v_mfma_f32_16x16x32_bf16 v[48:51], a[0:3], a[16:19], v[48:51]
    s_nop 0
    v_mfma_f32_16x16x32_bf16 v[56:59], a[0:3], a[20:23], v[56:59]
    s_nop 0
    v_mfma_f32_16x16x32_bf16 v[60:63], a[4:7], a[20:23], v[60:63]
    s_nop 0
    v_mfma_f32_16x16x32_bf16 v[52:55], a[4:7], a[16:19], v[52:55]
    v_cvt_pk_bf16_f32 v160, v64, v65
    v_cvt_pk_bf16_f32 v161, v66, v67
    v_mfma_f32_16x16x32_bf16 v[48:51], a[32:35], a[48:51], v[48:51]
    v_cvt_pk_bf16_f32 v162, v68, v69
    v_cvt_pk_bf16_f32 v163, v70, v71
    v_mfma_f32_16x16x32_bf16 v[56:59], a[32:35], a[52:55], v[56:59]
    buffer_store_dwordx4 v[160:163], v47, s[24:27], s65 offen offset:0 sc1
    v_cvt_pk_bf16_f32 v164, v72, v73
    v_mfma_f32_16x16x32_bf16 v[60:63], a[36:39], a[52:55], v[60:63]
    v_cvt_pk_bf16_f32 v165, v74, v75
    v_cvt_pk_bf16_f32 v166, v76, v77
    v_mfma_f32_16x16x32_bf16 v[52:55], a[36:39], a[48:51], v[52:55]
    v_cvt_pk_bf16_f32 v167, v78, v79
    buffer_store_dwordx4 v[164:167], v47, s[24:27], s65 offen offset:1024 sc1
    v_mfma_f32_16x16x32_bf16 v[48:51], a[64:67], a[80:83], v[48:51]
    v_mfma_f32_16x16x32_bf16 v[56:59], a[64:67], a[84:87], v[56:59]
    v_mfma_f32_16x16x32_bf16 v[60:63], a[68:71], a[84:87], v[60:63]
    v_mfma_f32_16x16x32_bf16 v[52:55], a[68:71], a[80:83], v[52:55]
    v_mfma_f32_16x16x32_bf16 v[48:51], a[96:99], a[112:115], v[48:51]
    v_mfma_f32_16x16x32_bf16 v[56:59], a[96:99], a[116:119], v[56:59]
    v_mfma_f32_16x16x32_bf16 v[60:63], a[100:103], a[116:119], v[60:63]
    v_mfma_f32_16x16x32_bf16 v[52:55], a[100:103], a[112:115], v[52:55]
    s_waitcnt vmcnt(0) lgkmcnt(0)
    buffer_store_dword v33, v32, s[24:27], s75 offen sc1
    s_mov_b32 s58, 0x40000
P_poll:
    buffer_load_dword v31, v30, s[24:27], s56 offen sc1
    s_sub_u32 s58, s58, 1
    s_cbranch_scc1 P_go
    s_waitcnt vmcnt(0)
    v_cmp_ne_u32 vcc, 0, v31
    s_cmp_eq_u32 vcc_lo, 14
    s_cbranch_scc0 P_poll
P_go:
    buffer_load_dwordx4 v[112:115], v47, s[24:27], s50 offen offset:0 sc1
    buffer_load_dwordx4 v[116:119], v47, s[24:27], s50 offen offset:1024 sc1
    buffer_load_dwordx4 v[120:123], v47, s[24:27], s51 offen offset:0 sc1
    buffer_load_dwordx4 v[124:127], v47, s[24:27], s51 offen offset:1024 sc1
    buffer_load_dwordx4 v[128:131], v47, s[24:27], s52 offen offset:0 sc1
    buffer_load_dwordx4 v[132:135], v47, s[24:27], s52 offen offset:1024 sc1
    s_waitcnt vmcnt(4)
    v_lshlrev_b32 v34, 16, v112
    v_and_b32 v35, 0xffff0000, v112
    v_add_f32 v48, v48, v34
    v_add_f32 v49, v49, v35
    v_lshlrev_b32 v34, 16, v113
    v_and_b32 v35, 0xffff0000, v113
    v_add_f32 v50, v50, v34
    v_add_f32 v51, v51, v35
    v_lshlrev_b32 v34, 16, v114
    v_and_b32 v35, 0xffff0000, v114
    v_add_f32 v52, v52, v34
    v_add_f32 v53, v53, v35
    v_lshlrev_b32 v34, 16, v115
    v_and_b32 v35, 0xffff0000, v115
    v_add_f32 v54, v54, v34
    v_add_f32 v55, v55, v35
    v_lshlrev_b32 v34, 16, v116
    v_and_b32 v35, 0xffff0000, v116
    v_add_f32 v56, v56, v34
    v_add_f32 v57, v57, v35
    v_lshlrev_b32 v34, 16, v117
    v_and_b32 v35, 0xffff0000, v117
    v_add_f32 v58, v58, v34
    v_add_f32 v59, v59, v35
    v_lshlrev_b32 v34, 16, v118
    v_and_b32 v35, 0xffff0000, v118
    v_add_f32 v60, v60, v34
    v_add_f32 v61, v61, v35
    v_lshlrev_b32 v34, 16, v119
    v_and_b32 v35, 0xffff0000, v119
    v_add_f32 v62, v62, v34
    v_add_f32 v63, v63, v35
    s_waitcnt vmcnt(2)
    v_lshlrev_b32 v34, 16, v120
    v_and_b32 v35, 0xffff0000, v120
    v_add_f32 v48, v48, v34
    v_add_f32 v49, v49, v35
    v_lshlrev_b32 v34, 16, v121
    v_and_b32 v35, 0xffff0000, v121
    v_add_f32 v50, v50, v34
    v_add_f32 v51, v51, v35
    v_lshlrev_b32 v34, 16, v122
    v_and_b32 v35, 0xffff0000, v122
    v_add_f32 v52, v52, v34
    v_add_f32 v53, v53, v35
    v_lshlrev_b32 v34, 16, v123
    v_and_b32 v35, 0xffff0000, v123
    v_add_f32 v54, v54, v34
    v_add_f32 v55, v55, v35
    v_lshlrev_b32 v34, 16, v124
    v_and_b32 v35, 0xffff0000, v124
    v_add_f32 v56, v56, v34
    v_add_f32 v57, v57, v35
    v_lshlrev_b32 v34, 16, v125
    v_and_b32 v35, 0xffff0000, v125
    v_add_f32 v58, v58, v34
    v_add_f32 v59, v59, v35
    v_lshlrev_b32 v34, 16, v126
    v_and_b32 v35, 0xffff0000, v126
    v_add_f32 v60, v60, v34
    v_add_f32 v61, v61, v35
    v_lshlrev_b32 v34, 16, v127
    v_and_b32 v35, 0xffff0000, v127
    v_add_f32 v62, v62, v34
    v_add_f32 v63, v63, v35
    s_waitcnt vmcnt(0)
    v_lshlrev_b32 v34, 16, v128
    v_and_b32 v35, 0xffff0000, v128
    v_add_f32 v48, v48, v34
    v_add_f32 v49, v49, v35
    v_lshlrev_b32 v34, 16, v129
    v_and_b32 v35, 0xffff0000, v129
    v_add_f32 v50, v50, v34
    v_add_f32 v51, v51, v35
    v_lshlrev_b32 v34, 16, v130
    v_and_b32 v35, 0xffff0000, v130
    v_add_f32 v52, v52, v34
    v_add_f32 v53, v53, v35
    v_lshlrev_b32 v34, 16, v131
    v_and_b32 v35, 0xffff0000, v131
    v_add_f32 v54, v54, v34
    v_add_f32 v55, v55, v35
    v_lshlrev_b32 v34, 16, v132
    v_and_b32 v35, 0xffff0000, v132
    v_add_f32 v56, v56, v34
    v_add_f32 v57, v57, v35
    v_lshlrev_b32 v34, 16, v133
    v_and_b32 v35, 0xffff0000, v133
    v_add_f32 v58, v58, v34
    v_add_f32 v59, v59, v35
    v_lshlrev_b32 v34, 16, v134
    v_and_b32 v35, 0xffff0000, v134
    v_add_f32 v60, v60, v34
    v_add_f32 v61, v61, v35
    v_lshlrev_b32 v34, 16, v135
    v_and_b32 v35, 0xffff0000, v135
    v_add_f32 v62, v62, v34
    v_add_f32 v63, v63, v35
    v_cvt_pk_bf16_f32 v64, v48, v49
    v_cvt_pk_bf16_f32 v65, v50, v51
    v_cvt_pk_bf16_f32 v66, v52, v53
    v_cvt_pk_bf16_f32 v67, v54, v55
    v_cvt_pk_bf16_f32 v68, v56, v57
    v_cvt_pk_bf16_f32 v69, v58, v59
    v_cvt_pk_bf16_f32 v70, v60, v61
    v_cvt_pk_bf16_f32 v71, v62, v63
    v_permlane16_swap_b32 v64, v66
    v_permlane16_swap_b32 v65, v67
    v_permlane16_swap_b32 v68, v70
    v_permlane16_swap_b32 v69, v71
    buffer_store_dwordx4 v[64:67], v24, s[32:35], s57 offen
    buffer_store_dwordx4 v[68:71], v25, s[32:35], s57 offen
K_end:
    s_endpgm
M_s_5:
    buffer_store_dwordx4 v[144:147], v44, s[24:27], s68 offen offset:0 sc1
    s_branch M_t_6
M_s_7:
    buffer_store_dwordx4 v[148:151], v44, s[24:27], s68 offen offset:256 sc1
    s_branch M_t_8
M_s_9:
    buffer_store_dwordx4 v[152:155], v44, s[24:27], s69 offen offset:0 sc1
    s_branch M_t_10
M_s_11:
    buffer_store_dwordx4 v[156:159], v44, s[24:27], s69 offen offset:256 sc1
    s_branch M_t_12
M_s_13:
    buffer_store_dwordx4 v[168:171], v44, s[24:27], s69 offen offset:2048 sc1
    s_branch M_t_14
M_s_15:
    buffer_store_dwordx4 v[172:175], v44, s[24:27], s69 offen offset:2304 sc1
    s_branch M_t_16
M_s_17:
    buffer_store_dwordx4 v[160:163], v44, s[24:27], s68 offen offset:2048 sc1
    s_branch M_t_18
M_s_19:
    buffer_store_dwordx4 v[164:167], v44, s[24:27], s68 offen offset:2304 sc1
    s_branch M_t_20
M_s_21:
    buffer_store_dword v33, v32, s[24:27], s75 offen sc1
    s_branch M_t_22
M_s_37:
    buffer_store_dwordx4 v[112:115], v44, s[24:27], s74 offen offset:0 sc1
    s_branch M_t_38
M_s_39:
    buffer_store_dwordx4 v[116:119], v44, s[24:27], s74 offen offset:256 sc1
    s_branch M_t_40
M_s_41:
    buffer_store_dwordx4 v[120:123], v44, s[24:27], s74 offen offset:2048 sc1
    s_branch M_t_42
M_s_43:
    buffer_store_dwordx4 v[124:127], v44, s[24:27], s74 offen offset:2304 sc1
    s_branch M_t_44
M_s_45:
    buffer_store_dwordx4 v[128:131], v44, s[24:27], s4 offen offset:0 sc1
    s_branch M_t_46
M_s_47:
    buffer_store_dwordx4 v[132:135], v44, s[24:27], s4 offen offset:256 sc1
    s_branch M_t_48
M_s_49:
    buffer_store_dwordx4 v[136:139], v44, s[24:27], s4 offen offset:2048 sc1
    s_branch M_t_50
M_s_51:
    buffer_store_dwordx4 v[140:143], v44, s[24:27], s4 offen offset:2304 sc1
    s_branch M_t_52
M_s_53:
    buffer_store_dword v33, v32, s[24:27], s75 offen sc1
    s_branch M_t_54
M_rdy2:
    s_sub_u32 s58, s58, 1
    s_cbranch_scc1 M_rdy3
    buffer_load_dword v2, v3, s[36:39], 0 offen sc1
    s_waitcnt vmcnt(0)
    s_branch M_rdy
K_rs_23:
    s_call_b64 s[60:61], K_rare1
    s_branch K_bk_24
K_rs_25:
    s_call_b64 s[60:61], K_rare0
    s_branch K_bk_26
K_rs_27:
    s_call_b64 s[60:61], K_rare1
    s_branch K_bk_28
K_rs_29:
    s_call_b64 s[60:61], K_rare0
    s_branch K_bk_30
K_rs_31:
    s_call_b64 s[60:61], K_rare1
    s_branch K_bk_32
K_rs_33:
    s_call_b64 s[60:61], K_rare0
    s_branch K_bk_34
K_rs_35:
    s_call_b64 s[60:61], K_rare1
    s_branch K_bk_36
K_rare0:
    s_nop 15
    v_max3_f32 v34, v48, v49, v50
    v_max3_f32 v35, v56, v57, v58
    v_max3_f32 v36, v64, v65, v66
    v_max3_f32 v37, v72, v73, v74
    v_max3_f32 v34, v34, v51, v52
    v_max3_f32 v35, v35, v59, v60
    v_max3_f32 v36, v36, v67, v68
    v_max3_f32 v37, v37, v75, v76
    v_max3_f32 v34, v34, v53, v54
    v_max3_f32 v35, v35, v61, v62
    v_max3_f32 v36, v36, v69, v70
    v_max3_f32 v37, v37, v77, v78
    v_max_f32 v34, v34, v55
    v_max_f32 v35, v35, v63
    v_max_f32 v36, v36, v71
    v_max_f32 v37, v37, v79
    v_mov_b32 v38, v34
    v_mov_b32 v39, v35
    v_mov_b32 v40, v36
    v_mov_b32 v41, v37
    v_permlane16_swap_b32 v34, v38
    v_permlane16_swap_b32 v35, v39
    v_permlane16_swap_b32 v36, v40
    v_permlane16_swap_b32 v37, v41
    v_max_f32 v34, v34, v38
    v_max_f32 v35, v35, v39
    v_max_f32 v36, v36, v40
    v_max_f32 v37, v37, v41
    v_mov_b32 v38, v34
    v_mov_b32 v39, v35
    v_mov_b32 v40, v36
    v_mov_b32 v41, v37
    v_permlane32_swap_b32 v34, v38
    v_permlane32_swap_b32 v35, v39
    v_permlane32_swap_b32 v36, v40
    v_permlane32_swap_b32 v37, v41
    v_max_f32 v34, v34, v38
    v_max_f32 v35, v35, v39
    v_max_f32 v36, v36, v40
    v_max_f32 v37, v37, v41
    v_max_f32 v34, 0, v34
    v_max_f32 v35, 0, v35
    v_max_f32 v36, 0, v36
    v_max_f32 v37, 0, v37
    v_sub_f32 v48, v48, v34
    v_sub_f32 v80, v80, v34
    v_sub_f32 v49, v49, v34
    v_sub_f32 v81, v81, v34
    v_sub_f32 v50, v50, v34
    v_sub_f32 v82, v82, v34
    v_sub_f32 v51, v51, v34
    v_sub_f32 v83, v83, v34
    v_sub_f32 v52, v52, v34
    v_sub_f32 v84, v84, v34
    v_sub_f32 v53, v53, v34
    v_sub_f32 v85, v85, v34
    v_sub_f32 v54, v54, v34
    v_sub_f32 v86, v86, v34
    v_sub_f32 v55, v55, v34
    v_sub_f32 v87, v87, v34
    v_sub_f32 v112, v112, v34
    v_sub_f32 v113, v113, v34
    v_sub_f32 v114, v114, v34
    v_sub_f32 v115, v115, v34
    v_sub_f32 v38, 0, v34
    v_exp_f32 v38, v38
    s_nop 0
    v_mul_f32 v128, v128, v38
    v_mul_f32 v176, v176, v38
    v_mul_f32 v177, v177, v38
    v_mul_f32 v178, v178, v38
    v_mul_f32 v179, v179, v38
    v_mul_f32 v180, v180, v38
    v_mul_f32 v181, v181, v38
    v_mul_f32 v182, v182, v38
    v_mul_f32 v183, v183, v38
    v_mul_f32 v192, v192, v38
    v_mul_f32 v193, v193, v38
    v_mul_f32 v194, v194, v38
    v_mul_f32 v195, v195, v38
    v_mul_f32 v196, v196, v38
    v_mul_f32 v197, v197, v38
    v_mul_f32 v198, v198, v38
    v_mul_f32 v199, v199, v38
    v_mul_f32 v208, v208, v38
    v_mul_f32 v209, v209, v38
    v_mul_f32 v210, v210, v38
    v_mul_f32 v211, v211, v38
    v_mul_f32 v212, v212, v38
    v_mul_f32 v213, v213, v38
    v_mul_f32 v214, v214, v38
    v_mul_f32 v215, v215, v38
    v_mul_f32 v224, v224, v38
    v_mul_f32 v225, v225, v38
    v_mul_f32 v226, v226, v38
    v_mul_f32 v227, v227, v38
    v_mul_f32 v228, v228, v38
    v_mul_f32 v229, v229, v38
    v_mul_f32 v230, v230, v38
    v_mul_f32 v231, v231, v38
    v_sub_f32 v56, v56, v35
    v_sub_f32 v88, v88, v35
    v_sub_f32 v57, v57, v35
    v_sub_f32 v89, v89, v35
    v_sub_f32 v58, v58, v35
    v_sub_f32 v90, v90, v35
    v_sub_f32 v59, v59, v35
    v_sub_f32 v91, v91, v35
    v_sub_f32 v60, v60, v35
    v_sub_f32 v92, v92, v35
    v_sub_f32 v61, v61, v35
    v_sub_f32 v93, v93, v35
    v_sub_f32 v62, v62, v35
    v_sub_f32 v94, v94, v35
    v_sub_f32 v63, v63, v35
    v_sub_f32 v95, v95, v35
    v_sub_f32 v116, v116, v35
    v_sub_f32 v117, v117, v35
    v_sub_f32 v118, v118, v35
    v_sub_f32 v119, v119, v35
    v_sub_f32 v38, 0, v35
    v_exp_f32 v38, v38
    s_nop 0
    v_mul_f32 v129, v129, v38
    v_mul_f32 v184, v184, v38
    v_mul_f32 v185, v185, v38
    v_mul_f32 v186, v186, v38
    v_mul_f32 v187, v187, v38
    v_mul_f32 v188, v188, v38
    v_mul_f32 v189, v189, v38
    v_mul_f32 v190, v190, v38
    v_mul_f32 v191, v191, v38
    v_mul_f32 v200, v200, v38
    v_mul_f32 v201, v201, v38
    v_mul_f32 v202, v202, v38
    v_mul_f32 v203, v203, v38
    v_mul_f32 v204, v204, v38
    v_mul_f32 v205, v205, v38
    v_mul_f32 v206, v206, v38
    v_mul_f32 v207, v207, v38
    v_mul_f32 v216, v216, v38
    v_mul_f32 v217, v217, v38
    v_mul_f32 v218, v218, v38
    v_mul_f32 v219, v219, v38
    v_mul_f32 v220, v220, v38
    v_mul_f32 v221, v221, v38
    v_mul_f32 v222, v222, v38
    v_mul_f32 v223, v223, v38
    v_mul_f32 v232, v232, v38
    v_mul_f32 v233, v233, v38
    v_mul_f32 v234, v234, v38
    v_mul_f32 v235, v235, v38
    v_mul_f32 v236, v236, v38
    v_mul_f32 v237, v237, v38
    v_mul_f32 v238, v238, v38
    v_mul_f32 v239, v239, v38
    v_sub_f32 v64, v64, v36
    v_sub_f32 v96, v96, v36
    v_sub_f32 v65, v65, v36
    v_sub_f32 v97, v97, v36
    v_sub_f32 v66, v66, v36
    v_sub_f32 v98, v98, v36
    v_sub_f32 v67, v67, v36
    v_sub_f32 v99, v99, v36
    v_sub_f32 v68, v68, v36
    v_sub_f32 v100, v100, v36
    v_sub_f32 v69, v69, v36
    v_sub_f32 v101, v101, v36
    v_sub_f32 v70, v70, v36
    v_sub_f32 v102, v102, v36
    v_sub_f32 v71, v71, v36
    v_sub_f32 v103, v103, v36
    v_sub_f32 v120, v120, v36
    v_sub_f32 v121, v121, v36
    v_sub_f32 v122, v122, v36
    v_sub_f32 v123, v123, v36
    v_sub_f32 v38, 0, v36
    v_exp_f32 v38, v38
    s_nop 0
    v_mul_f32 v130, v130, v38
    v_accvgpr_read_b32 v39, a0
    v_mul_f32 v39, v39, v38
    v_accvgpr_write_b32 a0, v39
    v_accvgpr_read_b32 v39, a1
    v_mul_f32 v39, v39, v38
    v_accvgpr_write_b32 a1, v39
    v_accvgpr_read_b32 v39, a2
    v_mul_f32 v39, v39, v38
    v_accvgpr_write_b32 a2, v39
    v_accvgpr_read_b32 v39, a3
    v_mul_f32 v39, v39, v38
    v_accvgpr_write_b32 a3, v39
    v_accvgpr_read_b32 v39, a4
    v_mul_f32 v39, v39, v38
    v_accvgpr_write_b32 a4, v39
    v_accvgpr_read_b32 v39, a5
    v_mul_f32 v39, v39, v38
    v_accvgpr_write_b32 a5, v39
    v_accvgpr_read_b32 v39, a6
    v_mul_f32 v39, v39, v38
    v_accvgpr_write_b32 a6, v39
    v_accvgpr_read_b32 v39, a7
    v_mul_f32 v39, v39, v38
    v_accvgpr_write_b32 a7, v39
    v_accvgpr_read_b32 v39, a16
    v_mul_f32 v39, v39, v38
    v_accvgpr_write_b32 a16, v39
    v_accvgpr_read_b32 v39, a17
    v_mul_f32 v39, v39, v38
    v_accvgpr_write_b32 a17, v39
    v_accvgpr_read_b32 v39, a18
    v_mul_f32 v39, v39, v38
    v_accvgpr_write_b32 a18, v39
    v_accvgpr_read_b32 v39, a19
    v_mul_f32 v39, v39, v38
    v_accvgpr_write_b32 a19, v39
    v_accvgpr_read_b32 v39, a20
    v_mul_f32 v39, v39, v38
    v_accvgpr_write_b32 a20, v39
    v_accvgpr_read_b32 v39, a21
    v_mul_f32 v39, v39, v38
    v_accvgpr_write_b32 a21, v39
    v_accvgpr_read_b32 v39, a22
    v_mul_f32 v39, v39, v38
    v_accvgpr_write_b32 a22, v39
    v_accvgpr_read_b32 v39, a23
    v_mul_f32 v39, v39, v38
    v_accvgpr_write_b32 a23, v39
    v_accvgpr_read_b32 v39, a32
    v_mul_f32 v39, v39, v38
    v_accvgpr_write_b32 a32, v39
    v_accvgpr_read_b32 v39, a33
    v_mul_f32 v39, v39, v38
    v_accvgpr_write_b32 a33, v39
    v_accvgpr_read_b32 v39, a34
    v_mul_f32 v39, v39, v38
    v_accvgpr_write_b32 a34, v39
    v_accvgpr_read_b32 v39, a35
    v_mul_f32 v39, v39, v38
    v_accvgpr_write_b32 a35, v39
    v_accvgpr_read_b32 v39, a36
    v_mul_f32 v39, v39, v38
    v_accvgpr_write_b32 a36, v39
    v_accvgpr_read_b32 v39, a37
    v_mul_f32 v39, v39, v38
    v_accvgpr_write_b32 a37, v39
    v_accvgpr_read_b32 v39, a38
    v_mul_f32 v39, v39, v38
    v_accvgpr_write_b32 a38, v39
    v_accvgpr_read_b32 v39, a39
    v_mul_f32 v39, v39, v38
    v_accvgpr_write_b32 a39, v39
    v_accvgpr_read_b32 v39, a48
    v_mul_f32 v39, v39, v38
    v_accvgpr_write_b32 a48, v39
    v_accvgpr_read_b32 v39, a49
    v_mul_f32 v39, v39, v38
    v_accvgpr_write_b32 a49, v39
    v_accvgpr_read_b32 v39, a50
    v_mul_f32 v39, v39, v38
    v_accvgpr_write_b32 a50, v39
    v_accvgpr_read_b32 v39, a51
    v_mul_f32 v39, v39, v38
    v_accvgpr_write_b32 a51, v39
    v_accvgpr_read_b32 v39, a52
    v_mul_f32 v39, v39, v38
    v_accvgpr_write_b32 a52, v39
    v_accvgpr_read_b32 v39, a53
    v_mul_f32 v39, v39, v38
    v_accvgpr_write_b32 a53, v39
    v_accvgpr_read_b32 v39, a54
    v_mul_f32 v39, v39, v38
    v_accvgpr_write_b32 a54, v39
    v_accvgpr_read_b32 v39, a55
    v_mul_f32 v39, v39, v38
    v_accvgpr_write_b32 a55, v39
    v_sub_f32 v72, v72, v37
    v_sub_f32 v104, v104, v37
    v_sub_f32 v73, v73, v37
    v_sub_f32 v105, v105, v37
    v_sub_f32 v74, v74, v37
    v_sub_f32 v106, v106, v37
    v_sub_f32 v75, v75, v37
    v_sub_f32 v107, v107, v37
    v_sub_f32 v76, v76, v37
    v_sub_f32 v108, v108, v37
    v_sub_f32 v77, v77, v37
    v_sub_f32 v109, v109, v37
    v_sub_f32 v78, v78, v37
    v_sub_f32 v110, v110, v37
    v_sub_f32 v79, v79, v37
    v_sub_f32 v111, v111, v37
    v_sub_f32 v124, v124, v37
    v_sub_f32 v125, v125, v37
    v_sub_f32 v126, v126, v37
    v_sub_f32 v127, v127, v37
    v_sub_f32 v38, 0, v37
    v_exp_f32 v38, v38
    s_nop 0
    v_mul_f32 v131, v131, v38
    v_accvgpr_read_b32 v39, a8
    v_mul_f32 v39, v39, v38
    v_accvgpr_write_b32 a8, v39
    v_accvgpr_read_b32 v39, a9
    v_mul_f32 v39, v39, v38
    v_accvgpr_write_b32 a9, v39
    v_accvgpr_read_b32 v39, a10
    v_mul_f32 v39, v39, v38
    v_accvgpr_write_b32 a10, v39
    v_accvgpr_read_b32 v39, a11
    v_mul_f32 v39, v39, v38
    v_accvgpr_write_b32 a11, v39
    v_accvgpr_read_b32 v39, a12
    v_mul_f32 v39, v39, v38
    v_accvgpr_write_b32 a12, v39
    v_accvgpr_read_b32 v39, a13
    v_mul_f32 v39, v39, v38
    v_accvgpr_write_b32 a13, v39
    v_accvgpr_read_b32 v39, a14
    v_mul_f32 v39, v39, v38
    v_accvgpr_write_b32 a14, v39
    v_accvgpr_read_b32 v39, a15
    v_mul_f32 v39, v39, v38
    v_accvgpr_write_b32 a15, v39
    v_accvgpr_read_b32 v39, a24
    v_mul_f32 v39, v39, v38
    v_accvgpr_write_b32 a24, v39
    v_accvgpr_read_b32 v39, a25
    v_mul_f32 v39, v39, v38
    v_accvgpr_write_b32 a25, v39
    v_accvgpr_read_b32 v39, a26
    v_mul_f32 v39, v39, v38
    v_accvgpr_write_b32 a26, v39
    v_accvgpr_read_b32 v39, a27
    v_mul_f32 v39, v39, v38
    v_accvgpr_write_b32 a27, v39
    v_accvgpr_read_b32 v39, a28
    v_mul_f32 v39, v39, v38
    v_accvgpr_write_b32 a28, v39
    v_accvgpr_read_b32 v39, a29
    v_mul_f32 v39, v39, v38
    v_accvgpr_write_b32 a29, v39
    v_accvgpr_read_b32 v39, a30
    v_mul_f32 v39, v39, v38
    v_accvgpr_write_b32 a30, v39
    v_accvgpr_read_b32 v39, a31
    v_mul_f32 v39, v39, v38
    v_accvgpr_write_b32 a31, v39
    v_accvgpr_read_b32 v39, a40
    v_mul_f32 v39, v39, v38
    v_accvgpr_write_b32 a40, v39
    v_accvgpr_read_b32 v39, a41
    v_mul_f32 v39, v39, v38
    v_accvgpr_write_b32 a41, v39
    v_accvgpr_read_b32 v39, a42
    v_mul_f32 v39, v39, v38
    v_accvgpr_write_b32 a42, v39
    v_accvgpr_read_b32 v39, a43
    v_mul_f32 v39, v39, v38
    v_accvgpr_write_b32 a43, v39
    v_accvgpr_read_b32 v39, a44
    v_mul_f32 v39, v39, v38
    v_accvgpr_write_b32 a44, v39
    v_accvgpr_read_b32 v39, a45
    v_mul_f32 v39, v39, v38
    v_accvgpr_write_b32 a45, v39
    v_accvgpr_read_b32 v39, a46
    v_mul_f32 v39, v39, v38
    v_accvgpr_write_b32 a46, v39
    v_accvgpr_read_b32 v39, a47
    v_mul_f32 v39, v39, v38
    v_accvgpr_write_b32 a47, v39
    v_accvgpr_read_b32 v39, a56
    v_mul_f32 v39, v39, v38
    v_accvgpr_write_b32 a56, v39
    v_accvgpr_read_b32 v39, a57
    v_mul_f32 v39, v39, v38
    v_accvgpr_write_b32 a57, v39
    v_accvgpr_read_b32 v39, a58
    v_mul_f32 v39, v39, v38
    v_accvgpr_write_b32 a58, v39
    v_accvgpr_read_b32 v39, a59
    v_mul_f32 v39, v39, v38
    v_accvgpr_write_b32 a59, v39
    v_accvgpr_read_b32 v39, a60
    v_mul_f32 v39, v39, v38
    v_accvgpr_write_b32 a60, v39
    v_accvgpr_read_b32 v39, a61
    v_mul_f32 v39, v39, v38
    v_accvgpr_write_b32 a61, v39
    v_accvgpr_read_b32 v39, a62
    v_mul_f32 v39, v39, v38
    v_accvgpr_write_b32 a62, v39
    v_accvgpr_read_b32 v39, a63
    v_mul_f32 v39, v39, v38
    v_accvgpr_write_b32 a63, v39
    v_exp_f32 v240, v48
    v_exp_f32 v241, v49
    v_exp_f32 v242, v56
    v_exp_f32 v243, v57
    v_add_f32 v132, v240, v241
    v_cvt_pk_bf16_f32 v144, v240, v241
    v_exp_f32 v244, v64
    v_exp_f32 v245, v65
    v_add_f32 v133, v242, v243
    v_cvt_pk_bf16_f32 v148, v242, v243
    v_exp_f32 v240, v72
    v_exp_f32 v241, v73
    v_add_f32 v134, v244, v245
    v_cvt_pk_bf16_f32 v152, v244, v245
    v_exp_f32 v242, v50
    v_exp_f32 v243, v51
    v_add_f32 v135, v240, v241
    v_cvt_pk_bf16_f32 v156, v240, v241
    v_exp_f32 v244, v58
    v_exp_f32 v245, v59
    v_add_f32 v132, v132, v242
    v_add_f32 v132, v132, v243
    v_cvt_pk_bf16_f32 v145, v242, v243
    v_exp_f32 v240, v66
    v_exp_f32 v241, v67
    v_add_f32 v133, v133, v244
    v_add_f32 v133, v133, v245
    v_cvt_pk_bf16_f32 v149, v244, v245
    v_exp_f32 v242, v74
    v_exp_f32 v243, v75
    v_add_f32 v134, v134, v240
    v_add_f32 v134, v134, v241
    v_cvt_pk_bf16_f32 v153, v240, v241
    v_exp_f32 v244, v52
    v_exp_f32 v245, v53
    v_add_f32 v135, v135, v242
    v_add_f32 v135, v135, v243
    v_cvt_pk_bf16_f32 v157, v242, v243
    v_exp_f32 v240, v60
    v_exp_f32 v241, v61
    v_add_f32 v132, v132, v244
    v_add_f32 v132, v132, v245
    v_cvt_pk_bf16_f32 v146, v244, v245
    v_exp_f32 v242, v68
    v_exp_f32 v243, v69
    v_add_f32 v133, v133, v240
    v_add_f32 v133, v133, v241
    v_cvt_pk_bf16_f32 v150, v240, v241
    v_exp_f32 v244, v76
    v_exp_f32 v245, v77
    v_add_f32 v134, v134, v242
    v_add_f32 v134, v134, v243
    v_cvt_pk_bf16_f32 v154, v242, v243
    v_exp_f32 v240, v54
    v_exp_f32 v241, v55
    v_add_f32 v135, v135, v244
    v_add_f32 v135, v135, v245
    v_cvt_pk_bf16_f32 v158, v244, v245
    v_exp_f32 v242, v62
    v_exp_f32 v243, v63
    v_add_f32 v132, v132, v240
    v_add_f32 v132, v132, v241
    v_cvt_pk_bf16_f32 v147, v240, v241
    v_exp_f32 v244, v70
    v_exp_f32 v245, v71
    v_add_f32 v133, v133, v242
    v_add_f32 v133, v133, v243
    v_cvt_pk_bf16_f32 v151, v242, v243
    v_exp_f32 v240, v78
    v_exp_f32 v241, v79
    v_add_f32 v134, v134, v244
    v_add_f32 v134, v134, v245
    v_cvt_pk_bf16_f32 v155, v244, v245
    s_nop 0
    v_add_f32 v135, v135, v240
    v_add_f32 v135, v135, v241
    v_cvt_pk_bf16_f32 v159, v240, v241
    s_nop 1
    s_setpc_b64 s[60:61]
K_rare1:
    s_nop 15
    v_max3_f32 v34, v80, v81, v82
    v_max3_f32 v35, v88, v89, v90
    v_max3_f32 v36, v96, v97, v98
    v_max3_f32 v37, v104, v105, v106
    v_max3_f32 v34, v34, v83, v84
    v_max3_f32 v35, v35, v91, v92
    v_max3_f32 v36, v36, v99, v100
    v_max3_f32 v37, v37, v107, v108
    v_max3_f32 v34, v34, v85, v86
    v_max3_f32 v35, v35, v93, v94
    v_max3_f32 v36, v36, v101, v102
    v_max3_f32 v37, v37, v109, v110
    v_max_f32 v34, v34, v87
    v_max_f32 v35, v35, v95
    v_max_f32 v36, v36, v103
    v_max_f32 v37, v37, v111
    v_mov_b32 v38, v34
    v_mov_b32 v39, v35
    v_mov_b32 v40, v36
    v_mov_b32 v41, v37
    v_permlane16_swap_b32 v34, v38
    v_permlane16_swap_b32 v35, v39
    v_permlane16_swap_b32 v36, v40
    v_permlane16_swap_b32 v37, v41
    v_max_f32 v34, v34, v38
    v_max_f32 v35, v35, v39
    v_max_f32 v36, v36, v40
    v_max_f32 v37, v37, v41
    v_mov_b32 v38, v34
    v_mov_b32 v39, v35
    v_mov_b32 v40, v36
    v_mov_b32 v41, v37
    v_permlane32_swap_b32 v34, v38
    v_permlane32_swap_b32 v35, v39
    v_permlane32_swap_b32 v36, v40
    v_permlane32_swap_b32 v37, v41
    v_max_f32 v34, v34, v38
    v_max_f32 v35, v35, v39
    v_max_f32 v36, v36, v40
    v_max_f32 v37, v37, v41
    v_max_f32 v34, 0, v34
    v_max_f32 v35, 0, v35
    v_max_f32 v36, 0, v36
    v_max_f32 v37, 0, v37
    v_sub_f32 v80, v80, v34
    v_sub_f32 v48, v48, v34
    v_sub_f32 v81, v81, v34
    v_sub_f32 v49, v49, v34
    v_sub_f32 v82, v82, v34
    v_sub_f32 v50, v50, v34
    v_sub_f32 v83, v83, v34
    v_sub_f32 v51, v51, v34
    v_sub_f32 v84, v84, v34
    v_sub_f32 v52, v52, v34
    v_sub_f32 v85, v85, v34
    v_sub_f32 v53, v53, v34
    v_sub_f32 v86, v86, v34
    v_sub_f32 v54, v54, v34
    v_sub_f32 v87, v87, v34
    v_sub_f32 v55, v55, v34
    v_sub_f32 v112, v112, v34
    v_sub_f32 v113, v113, v34
    v_sub_f32 v114, v114, v34
    v_sub_f32 v115, v115, v34
    v_sub_f32 v38, 0, v34
    v_exp_f32 v38, v38
    s_nop 0
    v_mul_f32 v128, v128, v38
    v_mul_f32 v176, v176, v38
    v_mul_f32 v177, v177, v38
    v_mul_f32 v178, v178, v38
    v_mul_f32 v179, v179, v38
    v_mul_f32 v180, v180, v38
    v_mul_f32 v181, v181, v38
    v_mul_f32 v182, v182, v38
    v_mul_f32 v183, v183, v38
    v_mul_f32 v192, v192, v38
    v_mul_f32 v193, v193, v38
    v_mul_f32 v194, v194, v38
    v_mul_f32 v195, v195, v38
    v_mul_f32 v196, v196, v38
    v_mul_f32 v197, v197, v38
    v_mul_f32 v198, v198, v38
    v_mul_f32 v199, v199, v38
    v_mul_f32 v208, v208, v38
    v_mul_f32 v209, v209, v38
    v_mul_f32 v210, v210, v38
    v_mul_f32 v211, v211, v38
    v_mul_f32 v212, v212, v38
    v_mul_f32 v213, v213, v38
    v_mul_f32 v214, v214, v38
    v_mul_f32 v215, v215, v38
    v_mul_f32 v224, v224, v38
    v_mul_f32 v225, v225, v38
    v_mul_f32 v226, v226, v38
    v_mul_f32 v227, v227, v38
    v_mul_f32 v228, v228, v38
    v_mul_f32 v229, v229, v38
    v_mul_f32 v230, v230, v38
    v_mul_f32 v231, v231, v38
    v_sub_f32 v88, v88, v35
    v_sub_f32 v56, v56, v35
    v_sub_f32 v89, v89, v35
    v_sub_f32 v57, v57, v35
    v_sub_f32 v90, v90, v35
    v_sub_f32 v58, v58, v35
    v_sub_f32 v91, v91, v35
    v_sub_f32 v59, v59, v35
    v_sub_f32 v92, v92, v35
    v_sub_f32 v60, v60, v35
    v_sub_f32 v93, v93, v35
    v_sub_f32 v61, v61, v35
    v_sub_f32 v94, v94, v35
    v_sub_f32 v62, v62, v35
    v_sub_f32 v95, v95, v35
    v_sub_f32 v63, v63, v35
    v_sub_f32 v116, v116, v35
    v_sub_f32 v117, v117, v35
    v_sub_f32 v118, v118, v35
    v_sub_f32 v119, v119, v35
    v_sub_f32 v38, 0, v35
    v_exp_f32 v38, v38
    s_nop 0
    v_mul_f32 v129, v129, v38
    v_mul_f32 v184, v184, v38
    v_mul_f32 v185, v185, v38
    v_mul_f32 v186, v186, v38
    v_mul_f32 v187, v187, v38
    v_mul_f32 v188, v188, v38
    v_mul_f32 v189, v189, v38
    v_mul_f32 v190, v190, v38
    v_mul_f32 v191, v191, v38
    v_mul_f32 v200, v200, v38
    v_mul_f32 v201, v201, v38
    v_mul_f32 v202, v202, v38
    v_mul_f32 v203, v203, v38
    v_mul_f32 v204, v204, v38
    v_mul_f32 v205, v205, v38
    v_mul_f32 v206, v206, v38
    v_mul_f32 v207, v207, v38
    v_mul_f32 v216, v216, v38
    v_mul_f32 v217, v217, v38
    v_mul_f32 v218, v218, v38
    v_mul_f32 v219, v219, v38
    v_mul_f32 v220, v220, v38
    v_mul_f32 v221, v221, v38
    v_mul_f32 v222, v222, v38
    v_mul_f32 v223, v223, v38
    v_mul_f32 v232, v232, v38
    v_mul_f32 v233, v233, v38
    v_mul_f32 v234, v234, v38
    v_mul_f32 v235, v235, v38
    v_mul_f32 v236, v236, v38
    v_mul_f32 v237, v237, v38
    v_mul_f32 v238, v238, v38
    v_mul_f32 v239, v239, v38
    v_sub_f32 v96, v96, v36
    v_sub_f32 v64, v64, v36
    v_sub_f32 v97, v97, v36
    v_sub_f32 v65, v65, v36
    v_sub_f32 v98, v98, v36
    v_sub_f32 v66, v66, v36
    v_sub_f32 v99, v99, v36
    v_sub_f32 v67, v67, v36
    v_sub_f32 v100, v100, v36
    v_sub_f32 v68, v68, v36
    v_sub_f32 v101, v101, v36
    v_sub_f32 v69, v69, v36
    v_sub_f32 v102, v102, v36
    v_sub_f32 v70, v70, v36
    v_sub_f32 v103, v103, v36
    v_sub_f32 v71, v71, v36
    v_sub_f32 v120, v120, v36
    v_sub_f32 v121, v121, v36
    v_sub_f32 v122, v122, v36
    v_sub_f32 v123, v123, v36
    v_sub_f32 v38, 0, v36
    v_exp_f32 v38, v38
    s_nop 0
    v_mul_f32 v130, v130, v38
    v_accvgpr_read_b32 v39, a0
    v_mul_f32 v39, v39, v38
    v_accvgpr_write_b32 a0, v39
    v_accvgpr_read_b32 v39, a1
    v_mul_f32 v39, v39, v38
    v_accvgpr_write_b32 a1, v39
    v_accvgpr_read_b32 v39, a2
    v_mul_f32 v39, v39, v38
    v_accvgpr_write_b32 a2, v39
    v_accvgpr_read_b32 v39, a3
    v_mul_f32 v39, v39, v38
    v_accvgpr_write_b32 a3, v39
    v_accvgpr_read_b32 v39, a4
    v_mul_f32 v39, v39, v38
    v_accvgpr_write_b32 a4, v39
    v_accvgpr_read_b32 v39, a5
    v_mul_f32 v39, v39, v38
    v_accvgpr_write_b32 a5, v39
    v_accvgpr_read_b32 v39, a6
    v_mul_f32 v39, v39, v38
    v_accvgpr_write_b32 a6, v39
    v_accvgpr_read_b32 v39, a7
    v_mul_f32 v39, v39, v38
    v_accvgpr_write_b32 a7, v39
    v_accvgpr_read_b32 v39, a16
    v_mul_f32 v39, v39, v38
    v_accvgpr_write_b32 a16, v39
    v_accvgpr_read_b32 v39, a17
    v_mul_f32 v39, v39, v38
    v_accvgpr_write_b32 a17, v39
    v_accvgpr_read_b32 v39, a18
    v_mul_f32 v39, v39, v38
    v_accvgpr_write_b32 a18, v39
    v_accvgpr_read_b32 v39, a19
    v_mul_f32 v39, v39, v38
    v_accvgpr_write_b32 a19, v39
    v_accvgpr_read_b32 v39, a20
    v_mul_f32 v39, v39, v38
    v_accvgpr_write_b32 a20, v39
    v_accvgpr_read_b32 v39, a21
    v_mul_f32 v39, v39, v38
    v_accvgpr_write_b32 a21, v39
    v_accvgpr_read_b32 v39, a22
    v_mul_f32 v39, v39, v38
    v_accvgpr_write_b32 a22, v39
    v_accvgpr_read_b32 v39, a23
    v_mul_f32 v39, v39, v38
    v_accvgpr_write_b32 a23, v39
    v_accvgpr_read_b32 v39, a32
    v_mul_f32 v39, v39, v38
    v_accvgpr_write_b32 a32, v39
    v_accvgpr_read_b32 v39, a33
    v_mul_f32 v39, v39, v38
    v_accvgpr_write_b32 a33, v39
    v_accvgpr_read_b32 v39, a34
    v_mul_f32 v39, v39, v38
    v_accvgpr_write_b32 a34, v39
    v_accvgpr_read_b32 v39, a35
    v_mul_f32 v39, v39, v38
    v_accvgpr_write_b32 a35, v39
    v_accvgpr_read_b32 v39, a36
    v_mul_f32 v39, v39, v38
    v_accvgpr_write_b32 a36, v39
    v_accvgpr_read_b32 v39, a37
    v_mul_f32 v39, v39, v38
    v_accvgpr_write_b32 a37, v39
    v_accvgpr_read_b32 v39, a38
    v_mul_f32 v39, v39, v38
    v_accvgpr_write_b32 a38, v39
    v_accvgpr_read_b32 v39, a39
    v_mul_f32 v39, v39, v38
    v_accvgpr_write_b32 a39, v39
    v_accvgpr_read_b32 v39, a48
    v_mul_f32 v39, v39, v38
    v_accvgpr_write_b32 a48, v39
    v_accvgpr_read_b32 v39, a49
    v_mul_f32 v39, v39, v38
    v_accvgpr_write_b32 a49, v39
    v_accvgpr_read_b32 v39, a50
    v_mul_f32 v39, v39, v38
    v_accvgpr_write_b32 a50, v39
    v_accvgpr_read_b32 v39, a51
    v_mul_f32 v39, v39, v38
    v_accvgpr_write_b32 a51, v39
    v_accvgpr_read_b32 v39, a52
    v_mul_f32 v39, v39, v38
    v_accvgpr_write_b32 a52, v39
    v_accvgpr_read_b32 v39, a53
    v_mul_f32 v39, v39, v38
    v_accvgpr_write_b32 a53, v39
    v_accvgpr_read_b32 v39, a54
    v_mul_f32 v39, v39, v38
    v_accvgpr_write_b32 a54, v39
    v_accvgpr_read_b32 v39, a55
    v_mul_f32 v39, v39, v38
    v_accvgpr_write_b32 a55, v39
    v_sub_f32 v104, v104, v37
    v_sub_f32 v72, v72, v37
    v_sub_f32 v105, v105, v37
    v_sub_f32 v73, v73, v37
    v_sub_f32 v106, v106, v37
    v_sub_f32 v74, v74, v37
    v_sub_f32 v107, v107, v37
    v_sub_f32 v75, v75, v37
    v_sub_f32 v108, v108, v37
    v_sub_f32 v76, v76, v37
    v_sub_f32 v109, v109, v37
    v_sub_f32 v77, v77, v37
    v_sub_f32 v110, v110, v37
    v_sub_f32 v78, v78, v37
    v_sub_f32 v111, v111, v37
    v_sub_f32 v79, v79, v37
    v_sub_f32 v124, v124, v37
    v_sub_f32 v125, v125, v37
    v_sub_f32 v126, v126, v37
    v_sub_f32 v127, v127, v37
    v_sub_f32 v38, 0, v37
    v_exp_f32 v38, v38
    s_nop 0
    v_mul_f32 v131, v131, v38
    v_accvgpr_read_b32 v39, a8
    v_mul_f32 v39, v39, v38
    v_accvgpr_write_b32 a8, v39
    v_accvgpr_read_b32 v39, a9
    v_mul_f32 v39, v39, v38
    v_accvgpr_write_b32 a9, v39
    v_accvgpr_read_b32 v39, a10
    v_mul_f32 v39, v39, v38
    v_accvgpr_write_b32 a10, v39
    v_accvgpr_read_b32 v39, a11
    v_mul_f32 v39, v39, v38
    v_accvgpr_write_b32 a11, v39
    v_accvgpr_read_b32 v39, a12
    v_mul_f32 v39, v39, v38
    v_accvgpr_write_b32 a12, v39
    v_accvgpr_read_b32 v39, a13
    v_mul_f32 v39, v39, v38
    v_accvgpr_write_b32 a13, v39
    v_accvgpr_read_b32 v39, a14
    v_mul_f32 v39, v39, v38
    v_accvgpr_write_b32 a14, v39
    v_accvgpr_read_b32 v39, a15
    v_mul_f32 v39, v39, v38
    v_accvgpr_write_b32 a15, v39
    v_accvgpr_read_b32 v39, a24
    v_mul_f32 v39, v39, v38
    v_accvgpr_write_b32 a24, v39
    v_accvgpr_read_b32 v39, a25
    v_mul_f32 v39, v39, v38
    v_accvgpr_write_b32 a25, v39
    v_accvgpr_read_b32 v39, a26
    v_mul_f32 v39, v39, v38
    v_accvgpr_write_b32 a26, v39
    v_accvgpr_read_b32 v39, a27
    v_mul_f32 v39, v39, v38
    v_accvgpr_write_b32 a27, v39
    v_accvgpr_read_b32 v39, a28
    v_mul_f32 v39, v39, v38
    v_accvgpr_write_b32 a28, v39
    v_accvgpr_read_b32 v39, a29
    v_mul_f32 v39, v39, v38
    v_accvgpr_write_b32 a29, v39
    v_accvgpr_read_b32 v39, a30
    v_mul_f32 v39, v39, v38
    v_accvgpr_write_b32 a30, v39
    v_accvgpr_read_b32 v39, a31
    v_mul_f32 v39, v39, v38
    v_accvgpr_write_b32 a31, v39
    v_accvgpr_read_b32 v39, a40
    v_mul_f32 v39, v39, v38
    v_accvgpr_write_b32 a40, v39
    v_accvgpr_read_b32 v39, a41
    v_mul_f32 v39, v39, v38
    v_accvgpr_write_b32 a41, v39
    v_accvgpr_read_b32 v39, a42
    v_mul_f32 v39, v39, v38
    v_accvgpr_write_b32 a42, v39
    v_accvgpr_read_b32 v39, a43
    v_mul_f32 v39, v39, v38
    v_accvgpr_write_b32 a43, v39
    v_accvgpr_read_b32 v39, a44
    v_mul_f32 v39, v39, v38
    v_accvgpr_write_b32 a44, v39
    v_accvgpr_read_b32 v39, a45
    v_mul_f32 v39, v39, v38
    v_accvgpr_write_b32 a45, v39
    v_accvgpr_read_b32 v39, a46
    v_mul_f32 v39, v39, v38
    v_accvgpr_write_b32 a46, v39
    v_accvgpr_read_b32 v39, a47
    v_mul_f32 v39, v39, v38
    v_accvgpr_write_b32 a47, v39
    v_accvgpr_read_b32 v39, a56
    v_mul_f32 v39, v39, v38
    v_accvgpr_write_b32 a56, v39
    v_accvgpr_read_b32 v39, a57
    v_mul_f32 v39, v39, v38
    v_accvgpr_write_b32 a57, v39
    v_accvgpr_read_b32 v39, a58
    v_mul_f32 v39, v39, v38
    v_accvgpr_write_b32 a58, v39
    v_accvgpr_read_b32 v39, a59
    v_mul_f32 v39, v39, v38
    v_accvgpr_write_b32 a59, v39
    v_accvgpr_read_b32 v39, a60
    v_mul_f32 v39, v39, v38
    v_accvgpr_write_b32 a60, v39
    v_accvgpr_read_b32 v39, a61
    v_mul_f32 v39, v39, v38
    v_accvgpr_write_b32 a61, v39
    v_accvgpr_read_b32 v39, a62
    v_mul_f32 v39, v39, v38
    v_accvgpr_write_b32 a62, v39
    v_accvgpr_read_b32 v39, a63
    v_mul_f32 v39, v39, v38
    v_accvgpr_write_b32 a63, v39
    v_exp_f32 v240, v80
    v_exp_f32 v241, v81
    v_exp_f32 v242, v88
    v_exp_f32 v243, v89
    v_add_f32 v132, v240, v241
    v_cvt_pk_bf16_f32 v160, v240, v241
    v_exp_f32 v244, v96
    v_exp_f32 v245, v97
    v_add_f32 v133, v242, v243
    v_cvt_pk_bf16_f32 v164, v242, v243
    v_exp_f32 v240, v104
    v_exp_f32 v241, v105
    v_add_f32 v134, v244, v245
    v_cvt_pk_bf16_f32 v168, v244, v245
    v_exp_f32 v242, v82
    v_exp_f32 v243, v83
    v_add_f32 v135, v240, v241
    v_cvt_pk_bf16_f32 v172, v240, v241
    v_exp_f32 v244, v90
    v_exp_f32 v245, v91
    v_add_f32 v132, v132, v242
    v_add_f32 v132, v132, v243
    v_cvt_pk_bf16_f32 v161, v242, v243
    v_exp_f32 v240, v98
    v_exp_f32 v241, v99
    v_add_f32 v133, v133, v244
    v_add_f32 v133, v133, v245
    v_cvt_pk_bf16_f32 v165, v244, v245
    v_exp_f32 v242, v106
    v_exp_f32 v243, v107
    v_add_f32 v134, v134, v240
    v_add_f32 v134, v134, v241
    v_cvt_pk_bf16_f32 v169, v240, v241
    v_exp_f32 v244, v84
    v_exp_f32 v245, v85
    v_add_f32 v135, v135, v242
    v_add_f32 v135, v135, v243
    v_cvt_pk_bf16_f32 v173, v242, v243
    v_exp_f32 v240, v92
    v_exp_f32 v241, v93
    v_add_f32 v132, v132, v244
    v_add_f32 v132, v132, v245
    v_cvt_pk_bf16_f32 v162, v244, v245
    v_exp_f32 v242, v100
    v_exp_f32 v243, v101
    v_add_f32 v133, v133, v240
    v_add_f32 v133, v133, v241
    v_cvt_pk_bf16_f32 v166, v240, v241
    v_exp_f32 v244, v108
    v_exp_f32 v245, v109
    v_add_f32 v134, v134, v242
    v_add_f32 v134, v134, v243
    v_cvt_pk_bf16_f32 v170, v242, v243
    v_exp_f32 v240, v86
    v_exp_f32 v241, v87
    v_add_f32 v135, v135, v244
    v_add_f32 v135, v135, v245
    v_cvt_pk_bf16_f32 v174, v244, v245
    v_exp_f32 v242, v94
    v_exp_f32 v243, v95
    v_add_f32 v132, v132, v240
    v_add_f32 v132, v132, v241
    v_cvt_pk_bf16_f32 v163, v240, v241
    v_exp_f32 v244, v102
    v_exp_f32 v245, v103
    v_add_f32 v133, v133, v242
    v_add_f32 v133, v133, v243
    v_cvt_pk_bf16_f32 v167, v242, v243
    v_exp_f32 v240, v110
    v_exp_f32 v241, v111
    v_add_f32 v134, v134, v244
    v_add_f32 v134, v134, v245
    v_cvt_pk_bf16_f32 v171, v244, v245
    s_nop 0
    v_add_f32 v135, v135, v240
    v_add_f32 v135, v135, v241
    v_cvt_pk_bf16_f32 v175, v240, v241
    s_nop 1
    s_setpc_b64 s[60:61]
.section .rodata,"a"
.p2align 6
.amdhsa_kernel concat_heads__gqa_block_cached__gqa_block_cached__near_ridge_kernel
  .amdhsa_next_free_vgpr 512
  .amdhsa_next_free_sgpr 102
  .amdhsa_accum_offset 256
  .amdhsa_group_segment_fixed_size 0
  .amdhsa_kernarg_size 104
  .amdhsa_user_sgpr_count 2
  .amdhsa_user_sgpr_kernarg_segment_ptr 1
  .amdhsa_system_sgpr_workgroup_id_x 1
.end_amdhsa_kernel
```
